```python
import torch

def _softmax(x, axis=-1):
    return torch.softmax(x, dim=axis)
def _gelu(x):
    return torch.nn.functional.gelu(x, approximate="tanh")
def _silu(x):
    return torch.nn.functional.silu(x)
def _sigmoid(x):
    return torch.sigmoid(x)
def _layernorm(x, axis=-1, eps=1e-5):
    m = x.mean(dim=axis, keepdim=True)
    v = x.var(dim=axis, keepdim=True, unbiased=False)
    return (x - m) / torch.sqrt(v + eps)
def _scatter_add(tgt, idx, src, axis=0):
    return tgt.clone().index_add_(axis, idx, src)
def _segment_sum(src, seg, n):
    out = torch.zeros((n,) + src.shape[1:], dtype=src.dtype)
    return out.index_add_(0, seg, src)
def _pad(x, pw):
    flat = tuple(v for pair in reversed(pw) for v in pair)
    return torch.nn.functional.pad(x, flat)

kernel_name = 'interleave_layers__linear_attn_block__glu_gated_reglu__prompt'

def setup_inputs():

    _w = (lambda a: (lambda t: t.to(torch.bfloat16) if t.is_floating_point() else t)(torch.as_tensor(a)))
    def _A_setup():
        B, S, D = 1, 2048, 512
        return {
            "x": _w((lambda *s: torch.randn(*s, dtype=torch.bfloat16) * 0.05)(B, S, D)),
            "wqkv": _w((lambda *s: torch.randn(*s, dtype=torch.bfloat16) * 0.05)(D, 3 * D)),
            "wo": _w((lambda *s: torch.randn(*s, dtype=torch.bfloat16) * 0.05)(D, D)),
        }
    _A_in = _A_setup()

    def _B_setup():
        B, S, D, F = 1, 2048, 512, 1376
        return {
            "x": _w((lambda *s: torch.randn(*s, dtype=torch.bfloat16) * 0.05)(B, S, D)),
            "W_gate": _w((lambda *s: torch.randn(*s, dtype=torch.bfloat16) * 0.4)(D, F) * (2.0 / D) ** 0.5),
            "W_up": _w((lambda *s: torch.randn(*s, dtype=torch.bfloat16) * 0.4)(D, F) * (2.0 / D) ** 0.5),
            "W_down": _w((lambda *s: torch.randn(*s, dtype=torch.bfloat16) * 0.4)(F, D) * (1.0 / F) ** 0.5),
        }
    _B_in = _B_setup()

    return {
        "A_x": _A_in["x"],
        "A_wqkv": _A_in["wqkv"],
        "A_wo": _A_in["wo"],
        "B_x": _B_in["x"],
        "B_W_gate": _B_in["W_gate"],
        "B_W_up": _B_in["W_up"],
        "B_W_down": _B_in["W_down"],
    }

def reference(A_x, A_wqkv, A_wo, B_x, B_W_gate, B_W_up, B_W_down):
    def _A_ref(x, wqkv, wo):
        B, S, D = x.shape
        H = 32; Dh = D // H
        qkv = (lambda x, *d: x.permute(*d))((x @ wqkv).reshape(B, S, 3, H, Dh), 2, 0, 3, 1, 4)
        q, k, v = qkv[0], qkv[1], qkv[2]
        phi = lambda t: torch.where(t > 0, t + 1, torch.exp(t)) + 1e-6
        pq, pk = phi(q), phi(k)
        kv = torch.einsum("bhsd,bhse->bhde", pk, v)
        z = torch.einsum("bhsd->bhd", pk)
        num = torch.einsum("bhqd,bhde->bhqe", pq, kv)
        den = torch.einsum("bhqd,bhd->bhq", pq, z)[..., None] + 1e-6
        o = num / den
        return (lambda x, *d: x.permute(*d))(o, 0, 2, 1, 3).reshape(B, S, D) @ wo

    def _B_ref(x, W_gate, W_up, W_down):
        gate = torch.einsum("bsd,df->bsf", x, W_gate)
        up = torch.einsum("bsd,df->bsf", x, W_up)
        gate = gate * (lambda x, dt: x.to(dt))(gate > 0, gate.dtype)
        h = gate * up
        return torch.einsum("bsf,fd->bsd", h, W_down)

    x = A_x
    x = x + _A_ref(_layernorm(x, axis=-1), A_wqkv, A_wo)
    x = x + _B_ref(_layernorm(x, axis=-1), B_W_gate, B_W_up, B_W_down)
    x = x + _A_ref(_layernorm(x, axis=-1), A_wqkv, A_wo)
    x = x + _B_ref(_layernorm(x, axis=-1), B_W_gate, B_W_up, B_W_down)
    return x
```

```asm
; @launch grid=(256,1,1) block=(256,1,1) lds=163840
.amdgcn_target "amdgcn-amd-amdhsa--gfx950"
.text
.globl interleave_layers__linear_attn_block__glu_gated_reglu__prompt_kernel
.p2align 8
.type interleave_layers__linear_attn_block__glu_gated_reglu__prompt_kernel,@function
interleave_layers__linear_attn_block__glu_gated_reglu__prompt_kernel:
    s_load_dwordx16 s[60:75], s[0:1], 0
    s_load_dwordx4 s[76:79], s[0:1], 64
    s_cmp_ge_u32 s2, 256
    s_cbranch_scc1 L_END
    v_lshrrev_b32 v1, 6, v0
    v_and_b32 v0, 63, v0
    v_readfirstlane_b32 s48, v1
    s_lshr_b32 s101, s2, 3
    s_lshl_b32 s101, s101, 2
    s_getpc_b64 s[96:97]
L_PC:
    s_add_u32 s3, s101, s48
    s_lshl_b32 s3, s3, 9
    v_lshlrev_b32 v2, 7, v0
    v_add_u32 v2, s3, v2
    v_min_u32 v2, L_END-L_PC, v2
    s_mov_b64 exec, 15
    global_load_dword a224, v2, s[96:97]
    s_mov_b64 exec, -1
    s_and_b32 s49, s2, 7
    s_lshr_b32 s50, s2, 3
    s_and_b32 s54, s50, 3
    s_lshr_b32 s55, s50, 2
    s_lshl_b32 s57, s49, 4
    s_lshl_b32 s3, s54, 2
    s_add_u32 s57, s57, s3
    s_and_b32 s49, s2, 7
    s_lshr_b32 s50, s2, 3
    s_and_b32 s3, s49, 1
    s_and_b32 s49, s49, 6
    s_and_b32 s52, s50, 1
    s_or_b32 s49, s49, s52
    s_lshr_b32 s50, s50, 1
    s_lshl_b32 s3, s3, 4
    s_or_b32 s50, s50, s3
    s_and_b32 s52, s50, 1
    s_lshr_b32 s53, s50, 1
    s_mov_b32 s51, 0
    s_lshl_b32 s58, s48, 13
    s_lshl_b32 s56, s49, 4
    s_lshl_b32 s3, s52, 3
    s_add_u32 s56, s56, s3
    s_lshl_b32 s3, s48, 1
    s_add_u32 s56, s56, s3
    s_add_u32 s81, s48, s53
    s_and_b32 s81, s81, 3
    s_mul_i32 s80, s81, 393216
    s_lshl_b32 s3, s53, 6
    s_add_u32 s80, s80, s3
    s_mul_i32 s81, s81, 352256
    s_mul_i32 s100, s53, 192
    s_lshl_b32 s3, s53, 7
    s_add_u32 s3, s3, 768
    s_min_u32 s54, s100, s3
    s_add_u32 s81, s81, s54
    s_lshl_b32 s3, s55, 7
    s_lshl_b32 s82, s48, 17
    s_add_u32 s82, s82, s3
    s_mul_i32 s83, s48, 98304
    s_add_u32 s83, s83, s3
    s_lshl_b32 s50, s48, 16
    s_add_u32 s50, s50, s3
    s_and_b32 s42, s53, 7
    s_lshl_b32 s3, s48, 1
    s_add_u32 s3, s3, s42
    s_add_u32 s3, s3, 0
    s_and_b32 s3, s3, 7
    s_mul_i32 s40, s3, 196608
    s_lshl_b32 s3, s53, 6
    s_add_u32 s40, s40, s3
    s_lshl_b32 s3, s48, 1
    s_add_u32 s3, s3, s42
    s_add_u32 s3, s3, 1
    s_and_b32 s3, s3, 7
    s_mul_i32 s41, s3, 196608
    s_lshl_b32 s3, s53, 6
    s_add_u32 s41, s41, s3
    s_lshl_b32 s42, s42, 7
    s_lshl_b32 s90, s56, 14
    s_add_u32 s91, s48, 1
    s_and_b32 s91, s91, 3
    s_add_u32 s91, s91, s57
    s_add_u32 s92, s48, 2
    s_and_b32 s92, s92, 3
    s_add_u32 s92, s92, s57
    s_add_u32 s93, s48, 3
    s_and_b32 s93, s93, 3
    s_add_u32 s93, s93, s57
    s_add_u32 s94, s48, 4
    s_and_b32 s94, s94, 3
    s_add_u32 s94, s94, s57
    s_add_u32 s101, s101, s48
    s_lshr_b32 s98, s101, 5
    s_mul_i32 s98, s98, 96
    s_and_b32 s99, s101, 31
    s_add_u32 s98, s98, s99
    s_lshl_b32 s98, s98, 10
    s_mul_i32 s99, s101, 12288
    s_mul_i32 s87, s101, 11008
    s_lshl_b32 s86, s101, 12
    s_and_b32 s3, s2, 1
    s_mul_i32 s100, s3, 1536
    s_add_u32 s87, s87, s100
    s_lshl_b32 s3, s3, 9
    s_add_u32 s99, s99, s3
    v_and_b32 v40, 15, v0
    v_lshrrev_b32 v41, 4, v0
    v_lshrrev_b32 v42, 2, v40
    v_and_b32 v43, 3, v0
    v_lshlrev_b32 v1, 4, v0
    v_add_u32 v2, 0x4000, v1
    v_lshlrev_b32 v28, 2, v0
    v_lshlrev_b32 v30, 4, v41
    v_lshlrev_b32 v31, 2, v40
    v_lshrrev_b32 v44, 2, v0
    v_lshrrev_b32 v45, 4, v0
    v_and_b32 v45, 2, v45
    v_xor_b32 v45, v45, v43
    v_lshlrev_b32 v45, 4, v45
    v_mul_u32_u24 v17, 3072, v44
    v_add_u32 v17, v17, v45
    v_mul_u32_u24 v18, 2752, v44
    v_add_u32 v18, v18, v45
    v_add_u32 v32, 43008, v18
    v_add_u32 v33, 86016, v18
    v_lshrrev_b32 v44, 3, v0
    v_and_b32 v46, 7, v0
    v_lshlrev_b32 v45, 4, v46
    v_lshlrev_b32 v19, 12, v44
    v_add_u32 v19, v19, v45
    s_mov_b32 s6, 2097152
    s_mov_b32 s7, 0x20000
    s_mov_b32 s10, 1572864
    s_mov_b32 s11, 0x20000
    s_mov_b32 s14, 524288
    s_mov_b32 s15, 0x20000
    s_mov_b32 s18, 1409024
    s_mov_b32 s19, 0x20000
    s_mov_b32 s22, 1409024
    s_mov_b32 s23, 0x20000
    s_mov_b32 s26, 1409024
    s_mov_b32 s27, 0x20000
    s_mov_b32 s30, 2097152
    s_mov_b32 s31, 0x20000
    s_mov_b32 s34, 256
    s_mov_b32 s35, 0x20000
    s_mov_b32 s38, 67108864
    s_mov_b32 s39, 0x20000
    v_lshrrev_b32 v44, 2, v0
    v_xor_b32 v45, v43, v41
    v_lshlrev_b32 v45, 4, v45
    v_lshlrev_b32 v52, 10, v44
    v_add_u32 v52, v52, v45
    s_waitcnt lgkmcnt(0)
    s_mov_b64 s[4:5], s[60:61]
    s_add_u32 s43, s90, s42
    s_add_u32 s42, s42, 128
    s_and_b32 s42, s42, 1023
    s_add_u32 m0, s58, 98304
    s_add_u32 s60, s43, 0
    buffer_load_dwordx4 v52, s[4:7], s60 offen lds
    s_add_u32 m0, s58, 100352
    s_add_u32 s60, s43, 64
    buffer_load_dwordx4 v52, s[4:7], s60 offen lds
    s_add_u32 m0, s58, 99328
    s_add_u32 s60, s43, 16384
    buffer_load_dwordx4 v52, s[4:7], s60 offen lds
    s_add_u32 m0, s58, 101376
    s_add_u32 s60, s43, 16448
    buffer_load_dwordx4 v52, s[4:7], s60 offen lds
    s_add_u32 s43, s90, s42
    s_add_u32 s42, s42, 128
    s_and_b32 s42, s42, 1023
    s_add_u32 m0, s58, 102400
    s_add_u32 s60, s43, 0
    buffer_load_dwordx4 v52, s[4:7], s60 offen lds
    s_add_u32 m0, s58, 104448
    s_add_u32 s60, s43, 64
    buffer_load_dwordx4 v52, s[4:7], s60 offen lds
    s_add_u32 m0, s58, 103424
    s_add_u32 s60, s43, 16384
    buffer_load_dwordx4 v52, s[4:7], s60 offen lds
    s_add_u32 m0, s58, 105472
    s_add_u32 s60, s43, 16448
    buffer_load_dwordx4 v52, s[4:7], s60 offen lds
    s_mov_b64 s[8:9], s[62:63]
    s_mov_b64 s[12:13], s[64:65]
    s_mov_b64 s[16:17], s[68:69]
    s_mov_b64 s[20:21], s[70:71]
    s_mov_b64 s[24:25], s[72:73]
    s_mov_b64 s[28:29], s[74:75]
    s_mov_b64 s[32:33], s[76:77]
    s_mov_b64 s[36:37], s[78:79]
    v_lshrrev_b32 v62, 2, v0
    v_mul_u32_u24 v62, 3072, v62
    v_and_b32 v63, 3, v0
    v_lshl_add_u32 v62, v63, 7, v62
    s_add_u32 s60, s99, 1024
    s_mov_b64 exec, 65535
    buffer_load_dword a224, v62, s[8:11], s60 offen
    s_mov_b64 exec, -1
    v_lshrrev_b32 v62, 2, v0
    v_mul_u32_u24 v62, 3072, v62
    v_and_b32 v63, 3, v0
    v_lshl_add_u32 v62, v63, 7, v62
    s_add_u32 s60, s99, 2048
    s_mov_b64 exec, 65535
    buffer_load_dword a224, v62, s[8:11], s60 offen
    s_mov_b64 exec, -1
    v_lshrrev_b32 v62, 2, v0
    v_mul_u32_u24 v62, 3072, v62
    v_and_b32 v63, 3, v0
    v_lshl_add_u32 v62, v63, 7, v62
    s_add_u32 s60, s99, 0
    s_mov_b64 exec, 65535
    buffer_load_dword a224, v62, s[8:11], s60 offen
    s_mov_b64 exec, -1
    s_cmp_ge_u32 s2, 16
    s_cbranch_scc1 SK_1
    v_mov_b32 v48, 0
    v_mov_b32 v49, 0
    v_mov_b32 v50, 0
    v_mov_b32 v51, 0
    s_lshl_b32 s61, s2, 2
    s_add_u32 s61, s61, s48
    s_mul_i32 s61, s61, 3072
    buffer_store_dwordx4 v[48:51], v1, s[36:39], s61 offen offset:0 sc1
    buffer_store_dwordx4 v[48:51], v1, s[36:39], s61 offen offset:1024 sc1
    buffer_store_dwordx4 v[48:51], v1, s[36:39], s61 offen offset:2048 sc1
SK_1:
    s_add_u32 m0, s58, 0
    s_add_u32 s60, s40, 1024
    buffer_load_dwordx4 v17, s[8:11], s60 offen lds
    s_add_u32 m0, s58, 1024
    s_add_u32 s60, s40, 50176
    buffer_load_dwordx4 v17, s[8:11], s60 offen lds
    s_add_u32 m0, s58, 2048
    s_add_u32 s60, s40, 99328
    buffer_load_dwordx4 v17, s[8:11], s60 offen lds
    s_add_u32 m0, s58, 3072
    s_add_u32 s60, s40, 148480
    buffer_load_dwordx4 v17, s[8:11], s60 offen lds
    s_add_u32 m0, s58, 4096
    s_add_u32 s60, s41, 1024
    buffer_load_dwordx4 v17, s[8:11], s60 offen lds
    s_add_u32 m0, s58, 5120
    s_add_u32 s60, s41, 50176
    buffer_load_dwordx4 v17, s[8:11], s60 offen lds
    s_add_u32 m0, s58, 6144
    s_add_u32 s60, s41, 99328
    buffer_load_dwordx4 v17, s[8:11], s60 offen lds
    s_add_u32 m0, s58, 7168
    s_add_u32 s60, s41, 148480
    buffer_load_dwordx4 v17, s[8:11], s60 offen lds
    s_add_u32 s43, s90, s42
    s_add_u32 s42, s42, 128
    s_and_b32 s42, s42, 1023
    s_add_u32 m0, s58, 131072
    s_add_u32 s60, s43, 0
    buffer_load_dwordx4 v52, s[4:7], s60 offen lds
    s_add_u32 m0, s58, 133120
    s_add_u32 s60, s43, 64
    buffer_load_dwordx4 v52, s[4:7], s60 offen lds
    s_add_u32 m0, s58, 132096
    s_add_u32 s60, s43, 16384
    buffer_load_dwordx4 v52, s[4:7], s60 offen lds
    s_add_u32 m0, s58, 134144
    s_add_u32 s60, s43, 16448
    buffer_load_dwordx4 v52, s[4:7], s60 offen lds
    s_add_u32 s43, s90, s42
    s_add_u32 s42, s42, 128
    s_and_b32 s42, s42, 1023
    s_add_u32 m0, s58, 135168
    s_add_u32 s60, s43, 0
    buffer_load_dwordx4 v52, s[4:7], s60 offen lds
    s_add_u32 m0, s58, 137216
    s_add_u32 s60, s43, 64
    buffer_load_dwordx4 v52, s[4:7], s60 offen lds
    s_add_u32 m0, s58, 136192
    s_add_u32 s60, s43, 16384
    buffer_load_dwordx4 v52, s[4:7], s60 offen lds
    s_add_u32 m0, s58, 138240
    s_add_u32 s60, s43, 16448
    buffer_load_dwordx4 v52, s[4:7], s60 offen lds
    s_add_u32 m0, s58, 32768
    s_add_u32 s60, s40, 2048
    buffer_load_dwordx4 v17, s[8:11], s60 offen lds
    s_add_u32 m0, s58, 33792
    s_add_u32 s60, s40, 51200
    buffer_load_dwordx4 v17, s[8:11], s60 offen lds
    s_add_u32 m0, s58, 34816
    s_add_u32 s60, s40, 100352
    buffer_load_dwordx4 v17, s[8:11], s60 offen lds
    s_add_u32 m0, s58, 35840
    s_add_u32 s60, s40, 149504
    buffer_load_dwordx4 v17, s[8:11], s60 offen lds
    s_add_u32 m0, s58, 36864
    s_add_u32 s60, s41, 2048
    buffer_load_dwordx4 v17, s[8:11], s60 offen lds
    s_add_u32 m0, s58, 37888
    s_add_u32 s60, s41, 51200
    buffer_load_dwordx4 v17, s[8:11], s60 offen lds
    s_add_u32 m0, s58, 38912
    s_add_u32 s60, s41, 100352
    buffer_load_dwordx4 v17, s[8:11], s60 offen lds
    s_add_u32 m0, s58, 39936
    s_add_u32 s60, s41, 149504
    buffer_load_dwordx4 v17, s[8:11], s60 offen lds
    v_xor_b32 v45, v41, v42
    v_lshlrev_b32 v45, 4, v45
    v_lshlrev_b32 v53, 6, v40
    v_add_u32 v53, v53, v45
    s_add_u32 s61, s58, 98304
    v_add_u32 v53, s61, v53
    s_mov_b32 s76, 0x3fb8aa3b
    s_mov_b32 s78, 0x358637bd
    s_mov_b32 s75, 0x3f803f80
    s_lshl_b32 s84, s2, 2
    s_add_u32 s84, s84, s48
    s_lshl_b32 s84, s84, 8
    s_add_u32 s84, s84, 33554432
    s_lshl_b32 s61, s2, 2
    s_add_u32 s61, s61, s48
    s_and_b32 s62, s61, 7
    s_lshr_b32 s63, s61, 4
    s_bitcmp1_b32 s61, 3
    s_cselect_b32 s44, s20, s16
    s_cselect_b32 s45, s21, s17
    s_cselect_b32 s65, 0x2000, 0
    s_mov_b32 s46, 1409024
    s_mov_b32 s47, 0x20000
    s_mul_i32 s62, s62, 176128
    s_lshl_b32 s64, s63, 6
    s_add_u32 s62, s62, s64
    s_cmp_ge_u32 s63, 43
    s_cselect_b32 s77, 0x1000000, s62
    v_lshlrev_b32 v44, 2, v41
    v_add_u32 v44, v44, v42
    v_mul_u32_u24 v44, 2752, v44
    v_lshlrev_b32 v45, 4, v43
    v_add_u32 v4, v44, v45
    s_lshl_b32 s64, s63, 7
    s_add_u32 s64, s64, s65
    s_add_u32 s64, s64, 98304
    v_lshlrev_b32 v45, 3, v43
    v_add_u32 v45, v45, v42
    v_and_b32 v46, 1, v41
    v_lshlrev_b32 v46, 2, v46
    v_add_u32 v45, v45, v46
    v_lshlrev_b32 v45, 2, v45
    v_add_u32 v39, s64, v45
    v_lshlrev_b32 v37, 10, v40
    v_add_u32 v37, v37, v30
    v_add_u32 v3, 0x4000, v37
    v_lshlrev_b32 v44, 3, v41
    v_add_u32 v44, v44, v42
    v_lshlrev_b32 v44, 6, v44
    v_and_b32 v45, 1, v41
    v_lshlrev_b32 v45, 5, v45
    v_add_u32 v44, v44, v45
    v_lshlrev_b32 v45, 3, v43
    v_add_u32 v5, v44, v45
    v_xor_b32 v6, 32, v5
    v_lshlrev_b32 v44, 7, v41
    v_lshlrev_b32 v45, 10, v42
    v_add_u32 v44, v44, v45
    v_lshlrev_b32 v45, 4, v43
    v_add_u32 v44, v44, v45
    v_add_u32 v11, s58, v44
    v_xor_b32 v12, 64, v11
    v_add_u32 v7, 65536, v5
    v_add_u32 v8, 65536, v6
    v_add_u32 v9, 131072, v5
    v_add_u32 v10, 131072, v6
    v_add_u32 v13, 65536, v11
    v_add_u32 v14, 65536, v12
    v_add_u32 v15, 131072, v11
    v_add_u32 v16, 131072, v12
    v_lshlrev_b32 v29, 8, v41
    v_lshlrev_b32 v44, 3, v40
    v_add_u32 v29, v29, v44
    v_and_b32 v44, 1, v0
    v_mul_u32_u24 v34, 1280, v44
    v_add_u32 v34, v34, v30
    v_add_u32 v34, 1024, v34
    v_add_u32 v35, -1, v44
    v_not_b32 v36, v35
    v_mov_b32 v44, s75
    v_accvgpr_write_b32 a228, v44
    v_accvgpr_write_b32 a229, v44
    v_accvgpr_write_b32 a230, v44
    v_accvgpr_write_b32 a231, v44
    v_and_b32 v44, 1, v40
    v_lshlrev_b32 v44, 4, v44
    v_mov_b32 v45, 0x3f80
    v_lshlrev_b32 v45, v44, v45
    v_lshrrev_b32 v46, 1, v40
    v_cmp_eq_u32 vcc, 0, v46
    s_nop 1
    v_cndmask_b32 v47, 0, v45, vcc
    v_accvgpr_write_b32 a80, v47
    v_cmp_eq_u32 vcc, 1, v46
    s_nop 1
    v_cndmask_b32 v47, 0, v45, vcc
    v_accvgpr_write_b32 a81, v47
    v_cmp_eq_u32 vcc, 2, v46
    s_nop 1
    v_cndmask_b32 v47, 0, v45, vcc
    v_accvgpr_write_b32 a82, v47
    v_cmp_eq_u32 vcc, 3, v46
    s_nop 1
    v_cndmask_b32 v47, 0, v45, vcc
    v_accvgpr_write_b32 a83, v47
    s_waitcnt vmcnt(8)
    ds_read_b128 v[128:131], v53 offset:0
    ds_read_b128 v[132:135], v53 offset:1024
    ds_read_b128 v[136:139], v53 offset:2048
    ds_read_b128 v[140:143], v53 offset:3072
    ds_read_b128 v[144:147], v53 offset:4096
    ds_read_b128 v[148:151], v53 offset:5120
    ds_read_b128 v[152:155], v53 offset:6144
    ds_read_b128 v[156:159], v53 offset:7168
    ds_read_b128 v[160:163], v53 offset:32768
    ds_read_b128 v[164:167], v53 offset:33792
    ds_read_b128 v[168:171], v53 offset:34816
    ds_read_b128 v[172:175], v53 offset:35840
    ds_read_b128 v[176:179], v53 offset:36864
    ds_read_b128 v[180:183], v53 offset:37888
    ds_read_b128 v[184:187], v53 offset:38912
    ds_read_b128 v[188:191], v53 offset:39936
    s_waitcnt vmcnt(0)
    s_barrier
    s_lshr_b32 s61, s2, 4
    s_or_b32 s61, s61, s48
    s_cmp_lg_u32 s61, 0
    s_cbranch_scc1 SK_2
    v_mov_b32 v62, 0
    v_mov_b32 v63, 1
    s_lshl_b32 s61, s2, 2
    s_mov_b64 exec, 1
    buffer_store_dword v63, v62, s[32:35], s61 offen sc1
    s_mov_b64 exec, -1
SK_2:
    s_and_b32 s61, s48, 1
    s_lshl_b32 s61, s61, 5
    v_xor_b32 v58, s61, v5
    s_lshr_b32 s61, s48, 1
    s_lshl_b32 s61, s61, 15
    v_add_u32 v58, s61, v58
    ds_read_b64_tr_b16 a[96:97], v58 offset:0
    ds_read_b64_tr_b16 a[98:99], v58 offset:256
    ds_read_b64_tr_b16 a[100:101], v58 offset:2048
    ds_read_b64_tr_b16 a[102:103], v58 offset:2304
    ds_read_b64_tr_b16 a[104:105], v58 offset:4096
    ds_read_b64_tr_b16 a[106:107], v58 offset:4352
    ds_read_b64_tr_b16 a[0:1], v5 offset:0
    ds_read_b64_tr_b16 a[2:3], v5 offset:256
    ds_read_b64_tr_b16 a[4:5], v6 offset:0
    ds_read_b64_tr_b16 a[6:7], v6 offset:256
    ds_read_b64_tr_b16 a[8:9], v5 offset:32768
    ds_read_b64_tr_b16 a[10:11], v5 offset:33024
    ds_read_b64_tr_b16 a[12:13], v6 offset:32768
    ds_read_b64_tr_b16 a[14:15], v6 offset:33024
    ds_read_b64_tr_b16 a[16:17], v5 offset:2048
    ds_read_b64_tr_b16 a[18:19], v5 offset:2304
    ds_read_b64_tr_b16 a[20:21], v6 offset:2048
    ds_read_b64_tr_b16 a[22:23], v6 offset:2304
    ds_read_b64_tr_b16 a[24:25], v5 offset:34816
    ds_read_b64_tr_b16 a[26:27], v5 offset:35072
    ds_read_b64_tr_b16 a[28:29], v6 offset:34816
    ds_read_b64_tr_b16 a[30:31], v6 offset:35072
    s_waitcnt lgkmcnt(8)
    v_mfma_f32_16x16x32_bf16 v[64:67], v[128:131], a[0:3], 0
    ds_read_b64_tr_b16 a[32:33], v5 offset:4096
    v_mfma_f32_16x16x32_bf16 v[80:83], v[132:135], a[0:3], 0
    ds_read_b64_tr_b16 a[34:35], v5 offset:4352
    v_mfma_f32_16x16x32_bf16 v[68:71], v[128:131], a[4:7], 0
    ds_read_b64_tr_b16 a[36:37], v6 offset:4096
    v_mfma_f32_16x16x32_bf16 v[84:87], v[132:135], a[4:7], 0
    ds_read_b64_tr_b16 a[38:39], v6 offset:4352
    s_add_u32 s43, s90, s42
    s_add_u32 s42, s42, 128
    s_and_b32 s42, s42, 1023
    s_add_u32 m0, s58, 98304
    s_add_u32 s60, s43, 0
    buffer_load_dwordx4 v52, s[4:7], s60 offen lds
    v_mfma_f32_16x16x32_bf16 v[72:75], v[128:131], a[8:11], 0
    ds_read_b64_tr_b16 a[40:41], v5 offset:36864
    v_mfma_f32_16x16x32_bf16 v[88:91], v[132:135], a[8:11], 0
    ds_read_b64_tr_b16 a[42:43], v5 offset:37120
    s_add_u32 m0, s58, 100352
    s_add_u32 s60, s43, 64
    buffer_load_dwordx4 v52, s[4:7], s60 offen lds
    v_mfma_f32_16x16x32_bf16 v[76:79], v[128:131], a[12:15], 0
    ds_read_b64_tr_b16 a[44:45], v6 offset:36864
    v_mfma_f32_16x16x32_bf16 v[92:95], v[132:135], a[12:15], 0
    ds_read_b64_tr_b16 a[46:47], v6 offset:37120
    s_add_u32 m0, s58, 99328
    s_add_u32 s60, s43, 16384
    buffer_load_dwordx4 v52, s[4:7], s60 offen lds
    v_mfma_f32_16x16x32_bf16 a[232:235], a[228:231], a[96:99], 0
    v_mfma_f32_16x16x32_bf16 a[48:51], a[228:231], v[128:131], 0
    ds_read_b64_tr_b16 a[108:109], v58 offset:6144
    v_mfma_f32_16x16x32_bf16 a[52:55], v[128:131], v[128:131], 0
    ds_read_b64_tr_b16 a[110:111], v58 offset:6400
    v_mfma_f32_16x16x32_bf16 a[56:59], a[228:231], v[132:135], 0
    v_mfma_f32_16x16x32_bf16 a[60:63], v[132:135], v[132:135], 0
    s_waitcnt lgkmcnt(10)
    v_mfma_f32_16x16x32_bf16 v[64:67], v[136:139], a[16:19], v[64:67]
    ds_read_b64_tr_b16 a[0:1], v5 offset:6144
    v_mfma_f32_16x16x32_bf16 v[80:83], v[140:143], a[16:19], v[80:83]
    ds_read_b64_tr_b16 a[2:3], v5 offset:6400
    s_add_u32 m0, s58, 101376
    s_add_u32 s60, s43, 16448
    buffer_load_dwordx4 v52, s[4:7], s60 offen lds
    v_mfma_f32_16x16x32_bf16 v[68:71], v[136:139], a[20:23], v[68:71]
    ds_read_b64_tr_b16 a[4:5], v6 offset:6144
    v_mfma_f32_16x16x32_bf16 v[84:87], v[140:143], a[20:23], v[84:87]
    ds_read_b64_tr_b16 a[6:7], v6 offset:6400
    s_add_u32 s43, s90, s42
    s_add_u32 s42, s42, 128
    s_and_b32 s42, s42, 1023
    s_add_u32 m0, s58, 102400
    s_add_u32 s60, s43, 0
    buffer_load_dwordx4 v52, s[4:7], s60 offen lds
    v_mfma_f32_16x16x32_bf16 v[72:75], v[136:139], a[24:27], v[72:75]
    ds_read_b64_tr_b16 a[8:9], v5 offset:38912
    v_mfma_f32_16x16x32_bf16 v[88:91], v[140:143], a[24:27], v[88:91]
    ds_read_b64_tr_b16 a[10:11], v5 offset:39168
    s_add_u32 m0, s58, 104448
    s_add_u32 s60, s43, 64
    buffer_load_dwordx4 v52, s[4:7], s60 offen lds
    v_mfma_f32_16x16x32_bf16 v[76:79], v[136:139], a[28:31], v[76:79]
    ds_read_b64_tr_b16 a[12:13], v6 offset:38912
    v_mfma_f32_16x16x32_bf16 v[92:95], v[140:143], a[28:31], v[92:95]
    ds_read_b64_tr_b16 a[14:15], v6 offset:39168
    s_add_u32 m0, s58, 103424
    s_add_u32 s60, s43, 16384
    buffer_load_dwordx4 v52, s[4:7], s60 offen lds
    v_mfma_f32_16x16x32_bf16 a[232:235], a[228:231], a[100:103], a[232:235]
    v_mfma_f32_16x16x32_bf16 a[48:51], a[228:231], v[136:139], a[48:51]
    ds_read_b64_tr_b16 a[96:97], v58 offset:8192
    v_mfma_f32_16x16x32_bf16 a[52:55], v[136:139], v[136:139], a[52:55]
    ds_read_b64_tr_b16 a[98:99], v58 offset:8448
    v_mfma_f32_16x16x32_bf16 a[56:59], a[228:231], v[140:143], a[56:59]
    v_mfma_f32_16x16x32_bf16 a[60:63], v[140:143], v[140:143], a[60:63]
    s_waitcnt lgkmcnt(12)
    v_mfma_f32_16x16x32_bf16 v[64:67], v[144:147], a[32:35], v[64:67]
    ds_read_b64_tr_b16 a[16:17], v5 offset:8192
    v_mfma_f32_16x16x32_bf16 v[80:83], v[148:151], a[32:35], v[80:83]
    ds_read_b64_tr_b16 a[18:19], v5 offset:8448
    s_add_u32 m0, s58, 105472
    s_add_u32 s60, s43, 16448
    buffer_load_dwordx4 v52, s[4:7], s60 offen lds
    v_mfma_f32_16x16x32_bf16 v[68:71], v[144:147], a[36:39], v[68:71]
    ds_read_b64_tr_b16 a[20:21], v6 offset:8192
    v_mfma_f32_16x16x32_bf16 v[84:87], v[148:151], a[36:39], v[84:87]
    ds_read_b64_tr_b16 a[22:23], v6 offset:8448
    s_add_u32 s43, s90, s42
    s_add_u32 s42, s42, 128
    s_and_b32 s42, s42, 1023
    s_add_u32 m0, s58, 131072
    s_add_u32 s60, s43, 0
    buffer_load_dwordx4 v52, s[4:7], s60 offen lds
    v_mfma_f32_16x16x32_bf16 v[72:75], v[144:147], a[40:43], v[72:75]
    ds_read_b64_tr_b16 a[24:25], v5 offset:40960
    v_mfma_f32_16x16x32_bf16 v[88:91], v[148:151], a[40:43], v[88:91]
    ds_read_b64_tr_b16 a[26:27], v5 offset:41216
    s_add_u32 m0, s58, 133120
    s_add_u32 s60, s43, 64
    buffer_load_dwordx4 v52, s[4:7], s60 offen lds
    v_mfma_f32_16x16x32_bf16 v[76:79], v[144:147], a[44:47], v[76:79]
    ds_read_b64_tr_b16 a[28:29], v6 offset:40960
    v_mfma_f32_16x16x32_bf16 v[92:95], v[148:151], a[44:47], v[92:95]
    ds_read_b64_tr_b16 a[30:31], v6 offset:41216
    s_add_u32 m0, s58, 132096
    s_add_u32 s60, s43, 16384
    buffer_load_dwordx4 v52, s[4:7], s60 offen lds
    v_mfma_f32_16x16x32_bf16 a[232:235], a[228:231], a[104:107], a[232:235]
    v_mfma_f32_16x16x32_bf16 a[48:51], a[228:231], v[144:147], a[48:51]
    ds_read_b64_tr_b16 a[100:101], v58 offset:10240
    v_mfma_f32_16x16x32_bf16 a[52:55], v[144:147], v[144:147], a[52:55]
    ds_read_b64_tr_b16 a[102:103], v58 offset:10496
    v_mfma_f32_16x16x32_bf16 a[56:59], a[228:231], v[148:151], a[56:59]
    v_mfma_f32_16x16x32_bf16 a[60:63], v[148:151], v[148:151], a[60:63]
    s_waitcnt lgkmcnt(12)
    v_mfma_f32_16x16x32_bf16 v[64:67], v[152:155], a[0:3], v[64:67]
    ds_read_b64_tr_b16 a[32:33], v5 offset:10240
    v_mfma_f32_16x16x32_bf16 v[80:83], v[156:159], a[0:3], v[80:83]
    ds_read_b64_tr_b16 a[34:35], v5 offset:10496
    s_add_u32 m0, s58, 134144
    s_add_u32 s60, s43, 16448
    buffer_load_dwordx4 v52, s[4:7], s60 offen lds
    v_mfma_f32_16x16x32_bf16 v[68:71], v[152:155], a[4:7], v[68:71]
    ds_read_b64_tr_b16 a[36:37], v6 offset:10240
    v_mfma_f32_16x16x32_bf16 v[84:87], v[156:159], a[4:7], v[84:87]
    ds_read_b64_tr_b16 a[38:39], v6 offset:10496
    s_add_u32 s43, s90, s42
    s_add_u32 s42, s42, 128
    s_and_b32 s42, s42, 1023
    s_add_u32 m0, s58, 135168
    s_add_u32 s60, s43, 0
    buffer_load_dwordx4 v52, s[4:7], s60 offen lds
    v_mfma_f32_16x16x32_bf16 v[72:75], v[152:155], a[8:11], v[72:75]
    ds_read_b64_tr_b16 a[40:41], v5 offset:43008
    v_mfma_f32_16x16x32_bf16 v[88:91], v[156:159], a[8:11], v[88:91]
    ds_read_b64_tr_b16 a[42:43], v5 offset:43264
    s_add_u32 m0, s58, 137216
    s_add_u32 s60, s43, 64
    buffer_load_dwordx4 v52, s[4:7], s60 offen lds
    v_mfma_f32_16x16x32_bf16 v[76:79], v[152:155], a[12:15], v[76:79]
    ds_read_b64_tr_b16 a[44:45], v6 offset:43008
    v_mfma_f32_16x16x32_bf16 v[92:95], v[156:159], a[12:15], v[92:95]
    ds_read_b64_tr_b16 a[46:47], v6 offset:43264
    s_add_u32 m0, s58, 136192
    s_add_u32 s60, s43, 16384
    buffer_load_dwordx4 v52, s[4:7], s60 offen lds
    v_mfma_f32_16x16x32_bf16 a[232:235], a[228:231], a[108:111], a[232:235]
    v_mfma_f32_16x16x32_bf16 a[48:51], a[228:231], v[152:155], a[48:51]
    ds_read_b64_tr_b16 a[104:105], v58 offset:12288
    v_mfma_f32_16x16x32_bf16 a[52:55], v[152:155], v[152:155], a[52:55]
    ds_read_b64_tr_b16 a[106:107], v58 offset:12544
    v_mfma_f32_16x16x32_bf16 a[56:59], a[228:231], v[156:159], a[56:59]
    v_mfma_f32_16x16x32_bf16 a[60:63], v[156:159], v[156:159], a[60:63]
    s_waitcnt lgkmcnt(12)
    v_mfma_f32_16x16x32_bf16 v[64:67], v[160:163], a[16:19], v[64:67]
    ds_read_b64_tr_b16 a[0:1], v5 offset:12288
    v_mfma_f32_16x16x32_bf16 v[80:83], v[164:167], a[16:19], v[80:83]
    ds_read_b64_tr_b16 a[2:3], v5 offset:12544
    s_add_u32 m0, s58, 138240
    s_add_u32 s60, s43, 16448
    buffer_load_dwordx4 v52, s[4:7], s60 offen lds
    v_mfma_f32_16x16x32_bf16 v[68:71], v[160:163], a[20:23], v[68:71]
    ds_read_b64_tr_b16 a[4:5], v6 offset:12288
    v_mfma_f32_16x16x32_bf16 v[84:87], v[164:167], a[20:23], v[84:87]
    ds_read_b64_tr_b16 a[6:7], v6 offset:12544
    v_mfma_f32_16x16x32_bf16 v[72:75], v[160:163], a[24:27], v[72:75]
    ds_read_b64_tr_b16 a[8:9], v5 offset:45056
    v_mfma_f32_16x16x32_bf16 v[88:91], v[164:167], a[24:27], v[88:91]
    ds_read_b64_tr_b16 a[10:11], v5 offset:45312
    s_add_u32 m0, s58, 65536
    s_add_u32 s60, s40, 0
    buffer_load_dwordx4 v17, s[8:11], s60 offen lds
    v_mfma_f32_16x16x32_bf16 v[76:79], v[160:163], a[28:31], v[76:79]
    ds_read_b64_tr_b16 a[12:13], v6 offset:45056
    v_mfma_f32_16x16x32_bf16 v[92:95], v[164:167], a[28:31], v[92:95]
    ds_read_b64_tr_b16 a[14:15], v6 offset:45312
    s_add_u32 m0, s58, 66560
    s_add_u32 s60, s40, 49152
    buffer_load_dwordx4 v17, s[8:11], s60 offen lds
    v_mfma_f32_16x16x32_bf16 a[232:235], a[228:231], a[96:99], a[232:235]
    v_mfma_f32_16x16x32_bf16 a[48:51], a[228:231], v[160:163], a[48:51]
    ds_read_b64_tr_b16 a[108:109], v58 offset:14336
    v_mfma_f32_16x16x32_bf16 a[52:55], v[160:163], v[160:163], a[52:55]
    ds_read_b64_tr_b16 a[110:111], v58 offset:14592
    v_mfma_f32_16x16x32_bf16 a[56:59], a[228:231], v[164:167], a[56:59]
    v_mfma_f32_16x16x32_bf16 a[60:63], v[164:167], v[164:167], a[60:63]
    v_lshrrev_b32 v62, 3, v0
    v_mul_u32_u24 v62, 1024, v62
    v_and_b32 v63, 7, v0
    v_lshl_add_u32 v62, v63, 7, v62
    s_add_u32 s60, s86, 0
    s_mov_b32 exec_hi, 0
    buffer_load_dword a224, v62, s[12:15], s60 offen
    s_mov_b64 exec, -1
    s_waitcnt lgkmcnt(12)
    v_mfma_f32_16x16x32_bf16 v[64:67], v[168:171], a[32:35], v[64:67]
    ds_read_b64_tr_b16 a[16:17], v5 offset:14336
    v_mfma_f32_16x16x32_bf16 v[80:83], v[172:175], a[32:35], v[80:83]
    ds_read_b64_tr_b16 a[18:19], v5 offset:14592
    s_add_u32 m0, s58, 67584
    s_add_u32 s60, s40, 98304
    buffer_load_dwordx4 v17, s[8:11], s60 offen lds
    v_mfma_f32_16x16x32_bf16 v[68:71], v[168:171], a[36:39], v[68:71]
    ds_read_b64_tr_b16 a[20:21], v6 offset:14336
    v_mfma_f32_16x16x32_bf16 v[84:87], v[172:175], a[36:39], v[84:87]
    ds_read_b64_tr_b16 a[22:23], v6 offset:14592
    s_add_u32 m0, s58, 68608
    s_add_u32 s60, s40, 147456
    buffer_load_dwordx4 v17, s[8:11], s60 offen lds
    v_mfma_f32_16x16x32_bf16 v[72:75], v[168:171], a[40:43], v[72:75]
    ds_read_b64_tr_b16 a[24:25], v5 offset:47104
    v_mfma_f32_16x16x32_bf16 v[88:91], v[172:175], a[40:43], v[88:91]
    ds_read_b64_tr_b16 a[26:27], v5 offset:47360
    s_add_u32 m0, s58, 69632
    s_add_u32 s60, s41, 0
    buffer_load_dwordx4 v17, s[8:11], s60 offen lds
    v_mfma_f32_16x16x32_bf16 v[76:79], v[168:171], a[44:47], v[76:79]
    ds_read_b64_tr_b16 a[28:29], v6 offset:47104
    v_mfma_f32_16x16x32_bf16 v[92:95], v[172:175], a[44:47], v[92:95]
    ds_read_b64_tr_b16 a[30:31], v6 offset:47360
    s_add_u32 m0, s58, 70656
    s_add_u32 s60, s41, 49152
    buffer_load_dwordx4 v17, s[8:11], s60 offen lds
    v_mfma_f32_16x16x32_bf16 a[232:235], a[228:231], a[100:103], a[232:235]
    v_mfma_f32_16x16x32_bf16 a[48:51], a[228:231], v[168:171], a[48:51]
    ds_read_b64_tr_b16 a[96:97], v58 offset:16384
    v_mfma_f32_16x16x32_bf16 a[52:55], v[168:171], v[168:171], a[52:55]
    ds_read_b64_tr_b16 a[98:99], v58 offset:16640
    v_mfma_f32_16x16x32_bf16 a[56:59], a[228:231], v[172:175], a[56:59]
    v_mfma_f32_16x16x32_bf16 a[60:63], v[172:175], v[172:175], a[60:63]
    s_waitcnt lgkmcnt(12)
    v_mfma_f32_16x16x32_bf16 v[64:67], v[176:179], a[0:3], v[64:67]
    ds_read_b64_tr_b16 a[32:33], v5 offset:16384
    v_mfma_f32_16x16x32_bf16 v[80:83], v[180:183], a[0:3], v[80:83]
    ds_read_b64_tr_b16 a[34:35], v5 offset:16640
    s_add_u32 m0, s58, 71680
    s_add_u32 s60, s41, 98304
    buffer_load_dwordx4 v17, s[8:11], s60 offen lds
    v_mfma_f32_16x16x32_bf16 v[68:71], v[176:179], a[4:7], v[68:71]
    ds_read_b64_tr_b16 a[36:37], v6 offset:16384
    v_mfma_f32_16x16x32_bf16 v[84:87], v[180:183], a[4:7], v[84:87]
    ds_read_b64_tr_b16 a[38:39], v6 offset:16640
    s_add_u32 m0, s58, 72704
    s_add_u32 s60, s41, 147456
    buffer_load_dwordx4 v17, s[8:11], s60 offen lds
    v_mfma_f32_16x16x32_bf16 v[72:75], v[176:179], a[8:11], v[72:75]
    ds_read_b64_tr_b16 a[40:41], v5 offset:49152
    v_mfma_f32_16x16x32_bf16 v[88:91], v[180:183], a[8:11], v[88:91]
    ds_read_b64_tr_b16 a[42:43], v5 offset:49408
    v_mfma_f32_16x16x32_bf16 v[76:79], v[176:179], a[12:15], v[76:79]
    ds_read_b64_tr_b16 a[44:45], v6 offset:49152
    v_mfma_f32_16x16x32_bf16 v[92:95], v[180:183], a[12:15], v[92:95]
    ds_read_b64_tr_b16 a[46:47], v6 offset:49408
    buffer_load_dwordx4 a[64:67], v4, s[44:47], s77 offen
    s_add_u32 s77, s77, 44032
    v_mfma_f32_16x16x32_bf16 a[232:235], a[228:231], a[104:107], a[232:235]
    v_mfma_f32_16x16x32_bf16 a[48:51], a[228:231], v[176:179], a[48:51]
    ds_read_b64_tr_b16 a[100:101], v58 offset:18432
    v_mfma_f32_16x16x32_bf16 a[52:55], v[176:179], v[176:179], a[52:55]
    ds_read_b64_tr_b16 a[102:103], v58 offset:18688
    v_mfma_f32_16x16x32_bf16 a[56:59], a[228:231], v[180:183], a[56:59]
    v_mfma_f32_16x16x32_bf16 a[60:63], v[180:183], v[180:183], a[60:63]
    s_waitcnt vmcnt(10)
    ds_read_b128 v[192:195], v53 offset:0
    ds_read_b128 v[196:199], v53 offset:1024
    ds_read_b128 v[200:203], v53 offset:2048
    ds_read_b128 v[204:207], v53 offset:3072
    ds_read_b128 v[208:211], v53 offset:4096
    ds_read_b128 v[212:215], v53 offset:5120
    ds_read_b128 v[216:219], v53 offset:6144
    ds_read_b128 v[220:223], v53 offset:7168
    s_waitcnt lgkmcnt(15)
    v_mfma_f32_16x16x32_bf16 v[64:67], v[184:187], a[16:19], v[64:67]
    ds_read_b64_tr_b16 a[0:1], v5 offset:18432
    v_mfma_f32_16x16x32_bf16 v[80:83], v[188:191], a[16:19], v[80:83]
    ds_read_b64_tr_b16 a[2:3], v5 offset:18688
    buffer_load_dwordx4 a[68:71], v4, s[44:47], s77 offen
    s_add_u32 s77, s77, 44032
    v_mfma_f32_16x16x32_bf16 v[68:71], v[184:187], a[20:23], v[68:71]
    ds_read_b64_tr_b16 a[4:5], v6 offset:18432
    v_mfma_f32_16x16x32_bf16 v[84:87], v[188:191], a[20:23], v[84:87]
    ds_read_b64_tr_b16 a[6:7], v6 offset:18688
    buffer_load_dwordx4 a[72:75], v4, s[44:47], s77 offen
    s_add_u32 s77, s77, 44032
    v_mfma_f32_16x16x32_bf16 v[72:75], v[184:187], a[24:27], v[72:75]
    ds_read_b64_tr_b16 a[8:9], v5 offset:51200
    v_mfma_f32_16x16x32_bf16 v[88:91], v[188:191], a[24:27], v[88:91]
    ds_read_b64_tr_b16 a[10:11], v5 offset:51456
    buffer_load_dwordx4 a[76:79], v4, s[44:47], s77 offen
    v_mfma_f32_16x16x32_bf16 v[76:79], v[184:187], a[28:31], v[76:79]
    ds_read_b64_tr_b16 a[12:13], v6 offset:51200
    v_mfma_f32_16x16x32_bf16 v[92:95], v[188:191], a[28:31], v[92:95]
    ds_read_b64_tr_b16 a[14:15], v6 offset:51456
    v_mfma_f32_16x16x32_bf16 a[232:235], a[228:231], a[108:111], a[232:235]
    v_mfma_f32_16x16x32_bf16 a[48:51], a[228:231], v[184:187], a[48:51]
    ds_read_b64_tr_b16 a[104:105], v58 offset:20480
    v_mfma_f32_16x16x32_bf16 a[52:55], v[184:187], v[184:187], a[52:55]
    ds_read_b64_tr_b16 a[106:107], v58 offset:20736
    v_mfma_f32_16x16x32_bf16 a[56:59], a[228:231], v[188:191], a[56:59]
    v_mfma_f32_16x16x32_bf16 a[60:63], v[188:191], v[188:191], a[60:63]
    ds_read_b128 v[224:227], v53 offset:32768
    ds_read_b128 v[228:231], v53 offset:33792
    ds_read_b128 v[232:235], v53 offset:34816
    ds_read_b128 v[236:239], v53 offset:35840
    ds_read_b128 v[240:243], v53 offset:36864
    ds_read_b128 v[244:247], v53 offset:37888
    ds_read_b128 v[248:251], v53 offset:38912
    ds_read_b128 v[252:255], v53 offset:39936
    s_waitcnt lgkmcnt(15)
    v_mfma_f32_16x16x32_bf16 v[64:67], v[192:195], a[32:35], v[64:67]
    ds_read_b64_tr_b16 a[16:17], v5 offset:20480
    v_mfma_f32_16x16x32_bf16 v[80:83], v[196:199], a[32:35], v[80:83]
    ds_read_b64_tr_b16 a[18:19], v5 offset:20736
    v_mfma_f32_16x16x32_bf16 v[68:71], v[192:195], a[36:39], v[68:71]
    ds_read_b64_tr_b16 a[20:21], v6 offset:20480
    v_mfma_f32_16x16x32_bf16 v[84:87], v[196:199], a[36:39], v[84:87]
    ds_read_b64_tr_b16 a[22:23], v6 offset:20736
    v_mfma_f32_16x16x32_bf16 v[72:75], v[192:195], a[40:43], v[72:75]
    ds_read_b64_tr_b16 a[24:25], v5 offset:53248
    v_mfma_f32_16x16x32_bf16 v[88:91], v[196:199], a[40:43], v[88:91]
    ds_read_b64_tr_b16 a[26:27], v5 offset:53504
    v_mfma_f32_16x16x32_bf16 v[76:79], v[192:195], a[44:47], v[76:79]
    ds_read_b64_tr_b16 a[28:29], v6 offset:53248
    v_mfma_f32_16x16x32_bf16 v[92:95], v[196:199], a[44:47], v[92:95]
    ds_read_b64_tr_b16 a[30:31], v6 offset:53504
    v_mfma_f32_16x16x32_bf16 a[232:235], a[228:231], a[96:99], a[232:235]
    v_mfma_f32_16x16x32_bf16 a[48:51], a[228:231], v[192:195], a[48:51]
    ds_read_b64_tr_b16 a[108:109], v58 offset:22528
    v_mfma_f32_16x16x32_bf16 a[52:55], v[192:195], v[192:195], a[52:55]
    ds_read_b64_tr_b16 a[110:111], v58 offset:22784
    v_mfma_f32_16x16x32_bf16 a[56:59], a[228:231], v[196:199], a[56:59]
    v_mfma_f32_16x16x32_bf16 a[60:63], v[196:199], v[196:199], a[60:63]
    s_waitcnt lgkmcnt(15)
    v_mfma_f32_16x16x32_bf16 v[64:67], v[200:203], a[0:3], v[64:67]
    ds_read_b64_tr_b16 a[32:33], v5 offset:22528
    v_mfma_f32_16x16x32_bf16 v[80:83], v[204:207], a[0:3], v[80:83]
    ds_read_b64_tr_b16 a[34:35], v5 offset:22784
    v_mfma_f32_16x16x32_bf16 v[68:71], v[200:203], a[4:7], v[68:71]
    ds_read_b64_tr_b16 a[36:37], v6 offset:22528
    v_mfma_f32_16x16x32_bf16 v[84:87], v[204:207], a[4:7], v[84:87]
    ds_read_b64_tr_b16 a[38:39], v6 offset:22784
    v_mfma_f32_16x16x32_bf16 v[72:75], v[200:203], a[8:11], v[72:75]
    ds_read_b64_tr_b16 a[40:41], v5 offset:55296
    v_mfma_f32_16x16x32_bf16 v[88:91], v[204:207], a[8:11], v[88:91]
    ds_read_b64_tr_b16 a[42:43], v5 offset:55552
    v_mfma_f32_16x16x32_bf16 v[76:79], v[200:203], a[12:15], v[76:79]
    ds_read_b64_tr_b16 a[44:45], v6 offset:55296
    v_mfma_f32_16x16x32_bf16 v[92:95], v[204:207], a[12:15], v[92:95]
    ds_read_b64_tr_b16 a[46:47], v6 offset:55552
    v_mfma_f32_16x16x32_bf16 a[232:235], a[228:231], a[100:103], a[232:235]
    v_mfma_f32_16x16x32_bf16 a[48:51], a[228:231], v[200:203], a[48:51]
    ds_read_b64_tr_b16 a[96:97], v58 offset:24576
    v_mfma_f32_16x16x32_bf16 a[52:55], v[200:203], v[200:203], a[52:55]
    ds_read_b64_tr_b16 a[98:99], v58 offset:24832
    v_mfma_f32_16x16x32_bf16 a[56:59], a[228:231], v[204:207], a[56:59]
    v_mfma_f32_16x16x32_bf16 a[60:63], v[204:207], v[204:207], a[60:63]
    s_waitcnt lgkmcnt(12)
    v_mfma_f32_16x16x32_bf16 v[64:67], v[208:211], a[16:19], v[64:67]
    ds_read_b64_tr_b16 a[0:1], v5 offset:24576
    v_mfma_f32_16x16x32_bf16 v[80:83], v[212:215], a[16:19], v[80:83]
    ds_read_b64_tr_b16 a[2:3], v5 offset:24832
    v_mfma_f32_16x16x32_bf16 v[68:71], v[208:211], a[20:23], v[68:71]
    ds_read_b64_tr_b16 a[4:5], v6 offset:24576
    v_mfma_f32_16x16x32_bf16 v[84:87], v[212:215], a[20:23], v[84:87]
    ds_read_b64_tr_b16 a[6:7], v6 offset:24832
    v_mfma_f32_16x16x32_bf16 v[72:75], v[208:211], a[24:27], v[72:75]
    ds_read_b64_tr_b16 a[8:9], v5 offset:57344
    v_mfma_f32_16x16x32_bf16 v[88:91], v[212:215], a[24:27], v[88:91]
    ds_read_b64_tr_b16 a[10:11], v5 offset:57600
    v_mfma_f32_16x16x32_bf16 v[76:79], v[208:211], a[28:31], v[76:79]
    ds_read_b64_tr_b16 a[12:13], v6 offset:57344
    v_mfma_f32_16x16x32_bf16 v[92:95], v[212:215], a[28:31], v[92:95]
    ds_read_b64_tr_b16 a[14:15], v6 offset:57600
    v_mfma_f32_16x16x32_bf16 a[232:235], a[228:231], a[104:107], a[232:235]
    v_mfma_f32_16x16x32_bf16 a[48:51], a[228:231], v[208:211], a[48:51]
    ds_read_b64_tr_b16 a[100:101], v58 offset:26624
    v_mfma_f32_16x16x32_bf16 a[52:55], v[208:211], v[208:211], a[52:55]
    ds_read_b64_tr_b16 a[102:103], v58 offset:26880
    v_mfma_f32_16x16x32_bf16 a[56:59], a[228:231], v[212:215], a[56:59]
    v_mfma_f32_16x16x32_bf16 a[60:63], v[212:215], v[212:215], a[60:63]
    s_waitcnt lgkmcnt(12)
    v_mfma_f32_16x16x32_bf16 v[64:67], v[216:219], a[32:35], v[64:67]
    ds_read_b64_tr_b16 a[16:17], v5 offset:26624
    v_mfma_f32_16x16x32_bf16 v[80:83], v[220:223], a[32:35], v[80:83]
    ds_read_b64_tr_b16 a[18:19], v5 offset:26880
    v_mfma_f32_16x16x32_bf16 v[68:71], v[216:219], a[36:39], v[68:71]
    ds_read_b64_tr_b16 a[20:21], v6 offset:26624
    v_mfma_f32_16x16x32_bf16 v[84:87], v[220:223], a[36:39], v[84:87]
    ds_read_b64_tr_b16 a[22:23], v6 offset:26880
    v_mfma_f32_16x16x32_bf16 v[72:75], v[216:219], a[40:43], v[72:75]
    ds_read_b64_tr_b16 a[24:25], v5 offset:59392
    v_mfma_f32_16x16x32_bf16 v[88:91], v[220:223], a[40:43], v[88:91]
    ds_read_b64_tr_b16 a[26:27], v5 offset:59648
    v_mfma_f32_16x16x32_bf16 v[76:79], v[216:219], a[44:47], v[76:79]
    ds_read_b64_tr_b16 a[28:29], v6 offset:59392
    v_mfma_f32_16x16x32_bf16 v[92:95], v[220:223], a[44:47], v[92:95]
    ds_read_b64_tr_b16 a[30:31], v6 offset:59648
    v_mfma_f32_16x16x32_bf16 a[232:235], a[228:231], a[108:111], a[232:235]
    v_mfma_f32_16x16x32_bf16 a[48:51], a[228:231], v[216:219], a[48:51]
    ds_read_b64_tr_b16 a[104:105], v58 offset:28672
    v_mfma_f32_16x16x32_bf16 a[52:55], v[216:219], v[216:219], a[52:55]
    ds_read_b64_tr_b16 a[106:107], v58 offset:28928
    v_mfma_f32_16x16x32_bf16 a[56:59], a[228:231], v[220:223], a[56:59]
    v_mfma_f32_16x16x32_bf16 a[60:63], v[220:223], v[220:223], a[60:63]
    s_waitcnt lgkmcnt(12)
    v_mfma_f32_16x16x32_bf16 v[64:67], v[224:227], a[0:3], v[64:67]
    ds_read_b64_tr_b16 a[32:33], v5 offset:28672
    v_mfma_f32_16x16x32_bf16 v[80:83], v[228:231], a[0:3], v[80:83]
    ds_read_b64_tr_b16 a[34:35], v5 offset:28928
    v_mfma_f32_16x16x32_bf16 v[68:71], v[224:227], a[4:7], v[68:71]
    ds_read_b64_tr_b16 a[36:37], v6 offset:28672
    v_mfma_f32_16x16x32_bf16 v[84:87], v[228:231], a[4:7], v[84:87]
    ds_read_b64_tr_b16 a[38:39], v6 offset:28928
    v_mfma_f32_16x16x32_bf16 v[72:75], v[224:227], a[8:11], v[72:75]
    ds_read_b64_tr_b16 a[40:41], v5 offset:61440
    v_mfma_f32_16x16x32_bf16 v[88:91], v[228:231], a[8:11], v[88:91]
    ds_read_b64_tr_b16 a[42:43], v5 offset:61696
    v_mfma_f32_16x16x32_bf16 v[76:79], v[224:227], a[12:15], v[76:79]
    ds_read_b64_tr_b16 a[44:45], v6 offset:61440
    v_mfma_f32_16x16x32_bf16 v[92:95], v[228:231], a[12:15], v[92:95]
    ds_read_b64_tr_b16 a[46:47], v6 offset:61696
    v_mfma_f32_16x16x32_bf16 a[232:235], a[228:231], a[96:99], a[232:235]
    v_mfma_f32_16x16x32_bf16 a[48:51], a[228:231], v[224:227], a[48:51]
    ds_read_b64_tr_b16 a[108:109], v58 offset:30720
    v_mfma_f32_16x16x32_bf16 a[52:55], v[224:227], v[224:227], a[52:55]
    ds_read_b64_tr_b16 a[110:111], v58 offset:30976
    v_mfma_f32_16x16x32_bf16 a[56:59], a[228:231], v[228:231], a[56:59]
    v_mfma_f32_16x16x32_bf16 a[60:63], v[228:231], v[228:231], a[60:63]
    s_waitcnt lgkmcnt(12)
    v_mfma_f32_16x16x32_bf16 v[64:67], v[232:235], a[16:19], v[64:67]
    ds_read_b64_tr_b16 a[0:1], v5 offset:30720
    v_mfma_f32_16x16x32_bf16 v[80:83], v[236:239], a[16:19], v[80:83]
    ds_read_b64_tr_b16 a[2:3], v5 offset:30976
    v_mfma_f32_16x16x32_bf16 v[68:71], v[232:235], a[20:23], v[68:71]
    ds_read_b64_tr_b16 a[4:5], v6 offset:30720
    v_mfma_f32_16x16x32_bf16 v[84:87], v[236:239], a[20:23], v[84:87]
    ds_read_b64_tr_b16 a[6:7], v6 offset:30976
    v_mfma_f32_16x16x32_bf16 v[72:75], v[232:235], a[24:27], v[72:75]
    ds_read_b64_tr_b16 a[8:9], v5 offset:63488
    v_mfma_f32_16x16x32_bf16 v[88:91], v[236:239], a[24:27], v[88:91]
    ds_read_b64_tr_b16 a[10:11], v5 offset:63744
    v_mfma_f32_16x16x32_bf16 v[76:79], v[232:235], a[28:31], v[76:79]
    ds_read_b64_tr_b16 a[12:13], v6 offset:63488
    v_mfma_f32_16x16x32_bf16 v[92:95], v[236:239], a[28:31], v[92:95]
    ds_read_b64_tr_b16 a[14:15], v6 offset:63744
    v_mfma_f32_16x16x32_bf16 a[232:235], a[228:231], a[100:103], a[232:235]
    v_mfma_f32_16x16x32_bf16 a[48:51], a[228:231], v[232:235], a[48:51]
    v_mfma_f32_16x16x32_bf16 a[52:55], v[232:235], v[232:235], a[52:55]
    v_mfma_f32_16x16x32_bf16 a[56:59], a[228:231], v[236:239], a[56:59]
    v_mfma_f32_16x16x32_bf16 a[60:63], v[236:239], v[236:239], a[60:63]
    s_waitcnt lgkmcnt(10)
    v_mfma_f32_16x16x32_bf16 v[64:67], v[240:243], a[32:35], v[64:67]
    v_mfma_f32_16x16x32_bf16 v[80:83], v[244:247], a[32:35], v[80:83]
    v_mfma_f32_16x16x32_bf16 v[68:71], v[240:243], a[36:39], v[68:71]
    v_mfma_f32_16x16x32_bf16 v[84:87], v[244:247], a[36:39], v[84:87]
    v_mfma_f32_16x16x32_bf16 v[72:75], v[240:243], a[40:43], v[72:75]
    v_mfma_f32_16x16x32_bf16 v[88:91], v[244:247], a[40:43], v[88:91]
    v_mfma_f32_16x16x32_bf16 v[76:79], v[240:243], a[44:47], v[76:79]
    v_mfma_f32_16x16x32_bf16 v[92:95], v[244:247], a[44:47], v[92:95]
    v_mfma_f32_16x16x32_bf16 a[232:235], a[228:231], a[104:107], a[232:235]
    v_mfma_f32_16x16x32_bf16 a[48:51], a[228:231], v[240:243], a[48:51]
    v_mfma_f32_16x16x32_bf16 a[52:55], v[240:243], v[240:243], a[52:55]
    v_mfma_f32_16x16x32_bf16 a[56:59], a[228:231], v[244:247], a[56:59]
    v_mfma_f32_16x16x32_bf16 a[60:63], v[244:247], v[244:247], a[60:63]
    v_mov_b32 v48, -1
    v_mov_b32 v49, -1
    v_mov_b32 v50, -1
    v_mov_b32 v51, -1
    s_lshl_b32 s61, s94, 14
    s_lshl_b32 s62, s55, 11
    s_add_u32 s61, s61, s62
    s_add_u32 s62, s61, 6291456
    buffer_store_dwordx4 v[48:51], v1, s[36:39], s62 offen offset:0 sc1
    buffer_store_dwordx4 v[48:51], v1, s[36:39], s62 offen offset:1024 sc1
    s_lshr_b32 s61, s61, 4
    s_mov_b64 exec, 0xff
    s_add_u32 s62, s61, 1048576
    buffer_store_dwordx4 v[48:51], v1, s[36:39], s62 offen sc1
    s_mov_b64 exec, -1
    s_waitcnt lgkmcnt(0)
    v_mfma_f32_16x16x32_bf16 v[64:67], v[248:251], a[0:3], v[64:67]
    v_mfma_f32_16x16x32_bf16 v[80:83], v[252:255], a[0:3], v[80:83]
    v_mfma_f32_16x16x32_bf16 v[68:71], v[248:251], a[4:7], v[68:71]
    v_mfma_f32_16x16x32_bf16 v[84:87], v[252:255], a[4:7], v[84:87]
    v_mfma_f32_16x16x32_bf16 v[72:75], v[248:251], a[8:11], v[72:75]
    v_mfma_f32_16x16x32_bf16 v[88:91], v[252:255], a[8:11], v[88:91]
    v_mfma_f32_16x16x32_bf16 v[76:79], v[248:251], a[12:15], v[76:79]
    v_mfma_f32_16x16x32_bf16 v[92:95], v[252:255], a[12:15], v[92:95]
    v_mfma_f32_16x16x32_bf16 a[232:235], a[228:231], a[108:111], a[232:235]
    v_mfma_f32_16x16x32_bf16 a[48:51], a[228:231], v[248:251], a[48:51]
    v_mfma_f32_16x16x32_bf16 a[52:55], v[248:251], v[248:251], a[52:55]
    v_mfma_f32_16x16x32_bf16 a[56:59], a[228:231], v[252:255], a[56:59]
    v_mfma_f32_16x16x32_bf16 a[60:63], v[252:255], v[252:255], a[60:63]
    s_add_u32 s61, s58, 98304
    v_add_u32 v58, s61, v28
    s_nop 1
    v_accvgpr_read_b32 v59, a232
    ds_write_b32 v58, v59
    v_add_u32 v58, 98304, v28
    s_waitcnt lgkmcnt(0)
    s_barrier
    ds_read_b32 v40, v58 offset:0
    ds_read_b32 v41, v58 offset:8192
    ds_read_b32 v42, v58 offset:16384
    ds_read_b32 v43, v58 offset:24576
    v_lshrrev_b32 v52, 2, v31
    v_lshrrev_b32 v53, 2, v30
    v_sub_u32 v52, v52, v53
    v_accvgpr_read_b32 v44, a48
    v_mov_b32 v45, 0
    v_accvgpr_read_b32 v48, a52
    v_accvgpr_read_b32 v49, a53
    v_accvgpr_read_b32 v50, a54
    v_accvgpr_read_b32 v51, a55
    v_mul_f32 v44, 0.25, v44
    v_accvgpr_read_b32 v46, a56
    v_mov_b32 v47, 0
    v_accvgpr_read_b32 v54, a60
    v_accvgpr_read_b32 v55, a61
    v_accvgpr_read_b32 v56, a62
    v_accvgpr_read_b32 v57, a63
    v_mul_f32 v46, 0.25, v46
    v_cmp_eq_u32 vcc, 0, v52
    s_nop 1
    v_cndmask_b32 v45, v45, v48, vcc
    v_cndmask_b32 v47, v47, v54, vcc
    v_cmp_eq_u32 vcc, 1, v52
    s_nop 1
    v_cndmask_b32 v45, v45, v49, vcc
    v_cndmask_b32 v47, v47, v55, vcc
    v_cmp_eq_u32 vcc, 2, v52
    s_nop 1
    v_cndmask_b32 v45, v45, v50, vcc
    v_cndmask_b32 v47, v47, v56, vcc
    v_cmp_eq_u32 vcc, 3, v52
    s_nop 1
    v_cndmask_b32 v45, v45, v51, vcc
    v_cndmask_b32 v47, v47, v57, vcc
    v_mov_b32 v48, v44
    v_mov_b32 v49, v45
    v_mov_b32 v50, v46
    v_mov_b32 v51, v47
    v_permlane16_swap_b32 v44, v48
    v_permlane16_swap_b32 v45, v49
    v_permlane16_swap_b32 v46, v50
    v_permlane16_swap_b32 v47, v51
    v_add_f32 v44, v44, v48
    v_add_f32 v45, v45, v49
    v_add_f32 v46, v46, v50
    v_add_f32 v47, v47, v51
    v_mov_b32 v48, v44
    v_mov_b32 v49, v45
    v_mov_b32 v50, v46
    v_mov_b32 v51, v47
    v_permlane32_swap_b32 v44, v48
    v_permlane32_swap_b32 v45, v49
    v_permlane32_swap_b32 v46, v50
    v_permlane32_swap_b32 v47, v51
    v_add_f32 v44, v44, v48
    v_add_f32 v45, v45, v49
    v_add_f32 v46, v46, v50
    v_add_f32 v47, v47, v51
    v_mul_f32 v57, 0xbb000000, v44
    v_mul_f32 v59, 0xbb000000, v46
    v_mul_f32 v45, 0x3b000000, v45
    v_mul_f32 v47, 0x3b000000, v47
    v_fma_f32 v45, -v57, v57, v45
    v_fma_f32 v47, -v59, v59, v47
    v_max_f32 v45, 0, v45
    v_max_f32 v47, 0, v47
    v_add_f32 v45, 0x3727c5ac, v45
    v_add_f32 v47, 0x3727c5ac, v47
    v_rsq_f32 v56, v45
    v_rsq_f32 v58, v47
    ds_bpermute_b32 v96, v30, v56 offset:0
    ds_bpermute_b32 v97, v30, v56 offset:4
    ds_bpermute_b32 v98, v30, v56 offset:8
    ds_bpermute_b32 v99, v30, v56 offset:12
    ds_bpermute_b32 v100, v30, v58 offset:0
    ds_bpermute_b32 v101, v30, v58 offset:4
    ds_bpermute_b32 v102, v30, v58 offset:8
    ds_bpermute_b32 v103, v30, v58 offset:12
    ds_bpermute_b32 v104, v30, v57 offset:0
    ds_bpermute_b32 v105, v30, v57 offset:4
    ds_bpermute_b32 v106, v30, v57 offset:8
    ds_bpermute_b32 v107, v30, v57 offset:12
    ds_bpermute_b32 v108, v30, v59 offset:0
    ds_bpermute_b32 v109, v30, v59 offset:4
    ds_bpermute_b32 v110, v30, v59 offset:8
    ds_bpermute_b32 v111, v30, v59 offset:12
    s_waitcnt lgkmcnt(0)
    s_waitcnt vmcnt(7)
    s_barrier
    v_accvgpr_write_b32 a232, v40
    v_accvgpr_write_b32 a236, v41
    v_accvgpr_write_b32 a240, v42
    v_accvgpr_write_b32 a244, v43
    buffer_load_dword v47, v31, s[32:35], 0 offen sc1
    v_pk_fma_f32 v[64:65], v[40:41], v[104:105], v[64:65] op_sel:[0,0,0] op_sel_hi:[0,1,1]
    v_pk_fma_f32 v[66:67], v[40:41], v[106:107], v[66:67] op_sel:[0,0,0] op_sel_hi:[0,1,1]
    v_pk_fma_f32 v[64:65], v[64:65], v[96:97], s[78:79] op_sel:[0,0,0] op_sel_hi:[1,1,0]
    v_pk_fma_f32 v[66:67], v[66:67], v[98:99], s[78:79] op_sel:[0,0,0] op_sel_hi:[1,1,0]
    v_pk_mul_f32 v[48:49], s[76:77], v[64:65] op_sel:[0,0] op_sel_hi:[0,1]
    v_pk_mul_f32 v[50:51], s[76:77], v[66:67] op_sel:[0,0] op_sel_hi:[0,1]
    v_exp_f32 v48, v48 clamp
    v_exp_f32 v50, v50 clamp
    v_exp_f32 v49, v49 clamp
    v_exp_f32 v51, v51 clamp
    v_max_f32 v64, s78, v64
    v_max_f32 v66, s78, v66
    s_add_u32 m0, s58, 98304
    s_add_u32 s100, s82, 0
    buffer_load_dwordx4 v19, s[12:15], s100 offen offset:0 lds
    v_max_f32 v65, s78, v65
    v_max_f32 v67, s78, v67
    v_pk_add_f32 v[64:65], v[64:65], v[48:49] op_sel:[0,0] op_sel_hi:[1,1]
    v_pk_add_f32 v[66:67], v[66:67], v[50:51] op_sel:[0,0] op_sel_hi:[1,1]
    v_cvt_pk_bf16_f32 v112, v64, v65
    v_cvt_pk_bf16_f32 v113, v66, v67
    v_pk_fma_f32 v[80:81], v[40:41], v[108:109], v[80:81] op_sel:[0,0,0] op_sel_hi:[0,1,1]
    v_pk_fma_f32 v[82:83], v[40:41], v[110:111], v[82:83] op_sel:[0,0,0] op_sel_hi:[0,1,1]
    v_pk_fma_f32 v[80:81], v[80:81], v[100:101], s[78:79] op_sel:[0,0,0] op_sel_hi:[1,1,0]
    v_pk_fma_f32 v[82:83], v[82:83], v[102:103], s[78:79] op_sel:[0,0,0] op_sel_hi:[1,1,0]
    v_pk_mul_f32 v[52:53], s[76:77], v[80:81] op_sel:[0,0] op_sel_hi:[0,1]
    v_pk_mul_f32 v[54:55], s[76:77], v[82:83] op_sel:[0,0] op_sel_hi:[0,1]
    buffer_load_dwordx4 v19, s[12:15], s100 offen offset:1024 lds
    v_exp_f32 v52, v52 clamp
    v_exp_f32 v54, v54 clamp
    v_exp_f32 v53, v53 clamp
    v_exp_f32 v55, v55 clamp
    v_max_f32 v80, s78, v80
    v_max_f32 v82, s78, v82
    v_max_f32 v81, s78, v81
    v_max_f32 v83, s78, v83
    v_pk_add_f32 v[80:81], v[80:81], v[52:53] op_sel:[0,0] op_sel_hi:[1,1]
    v_pk_add_f32 v[82:83], v[82:83], v[54:55] op_sel:[0,0] op_sel_hi:[1,1]
    v_cvt_pk_bf16_f32 v114, v80, v81
    v_cvt_pk_bf16_f32 v115, v82, v83
    buffer_load_dwordx4 v19, s[12:15], s100 offen offset:2048 lds
    v_pk_fma_f32 v[68:69], v[40:41], v[104:105], v[68:69] op_sel:[1,0,0] op_sel_hi:[1,1,1]
    v_pk_fma_f32 v[70:71], v[40:41], v[106:107], v[70:71] op_sel:[1,0,0] op_sel_hi:[1,1,1]
    v_pk_fma_f32 v[68:69], v[68:69], v[96:97], s[78:79] op_sel:[0,0,0] op_sel_hi:[1,1,0]
    v_pk_fma_f32 v[70:71], v[70:71], v[98:99], s[78:79] op_sel:[0,0,0] op_sel_hi:[1,1,0]
    v_pk_mul_f32 v[48:49], s[76:77], v[68:69] op_sel:[0,0] op_sel_hi:[0,1]
    v_pk_mul_f32 v[50:51], s[76:77], v[70:71] op_sel:[0,0] op_sel_hi:[0,1]
    v_exp_f32 v48, v48 clamp
    v_exp_f32 v50, v50 clamp
    v_exp_f32 v49, v49 clamp
    v_exp_f32 v51, v51 clamp
    v_max_f32 v68, s78, v68
    v_max_f32 v70, s78, v70
    buffer_load_dwordx4 v19, s[12:15], s100 offen offset:3072 lds
    v_max_f32 v69, s78, v69
    v_max_f32 v71, s78, v71
    v_add_u32 v64, s58, v7
    v_pk_add_f32 v[68:69], v[68:69], v[48:49] op_sel:[0,0] op_sel_hi:[1,1]
    v_add_u32 v65, s58, v8
    v_pk_add_f32 v[70:71], v[70:71], v[50:51] op_sel:[0,0] op_sel_hi:[1,1]
    v_cvt_pk_bf16_f32 v116, v68, v69
    ds_read_b64_tr_b16 a[0:1], v64 offset:0
    v_cvt_pk_bf16_f32 v117, v70, v71
    ds_read_b64_tr_b16 a[2:3], v64 offset:256
    v_pk_fma_f32 v[84:85], v[40:41], v[108:109], v[84:85] op_sel:[1,0,0] op_sel_hi:[1,1,1]
    s_add_u32 m0, s58, 102400
    s_add_u32 s100, s82, 32768
    buffer_load_dwordx4 v19, s[12:15], s100 offen offset:0 lds
    ds_read_b64_tr_b16 a[4:5], v65 offset:0
    v_pk_fma_f32 v[86:87], v[40:41], v[110:111], v[86:87] op_sel:[1,0,0] op_sel_hi:[1,1,1]
    ds_read_b64_tr_b16 a[6:7], v65 offset:256
    v_pk_fma_f32 v[84:85], v[84:85], v[100:101], s[78:79] op_sel:[0,0,0] op_sel_hi:[1,1,0]
    ds_read_b64_tr_b16 a[8:9], v64 offset:2048
    v_pk_fma_f32 v[86:87], v[86:87], v[102:103], s[78:79] op_sel:[0,0,0] op_sel_hi:[1,1,0]
    ds_read_b64_tr_b16 a[10:11], v64 offset:2304
    v_pk_mul_f32 v[52:53], s[76:77], v[84:85] op_sel:[0,0] op_sel_hi:[0,1]
    ds_read_b64_tr_b16 a[12:13], v65 offset:2048
    v_pk_mul_f32 v[54:55], s[76:77], v[86:87] op_sel:[0,0] op_sel_hi:[0,1]
    ds_read_b64_tr_b16 a[14:15], v65 offset:2304
    v_exp_f32 v52, v52 clamp
    buffer_load_dwordx4 v19, s[12:15], s100 offen offset:1024 lds
    ds_read_b64_tr_b16 a[16:17], v64 offset:4096
    v_exp_f32 v54, v54 clamp
    ds_read_b64_tr_b16 a[18:19], v64 offset:4352
    v_exp_f32 v53, v53 clamp
    ds_read_b64_tr_b16 a[20:21], v65 offset:4096
    v_exp_f32 v55, v55 clamp
    ds_read_b64_tr_b16 a[22:23], v65 offset:4352
    v_max_f32 v84, s78, v84
    ds_read_b64_tr_b16 a[24:25], v64 offset:6144
    v_max_f32 v86, s78, v86
    ds_read_b64_tr_b16 a[26:27], v64 offset:6400
    v_max_f32 v85, s78, v85
    buffer_load_dwordx4 v19, s[12:15], s100 offen offset:2048 lds
    ds_read_b64_tr_b16 a[28:29], v65 offset:6144
    v_max_f32 v87, s78, v87
    ds_read_b64_tr_b16 a[30:31], v65 offset:6400
    v_pk_add_f32 v[84:85], v[84:85], v[52:53] op_sel:[0,0] op_sel_hi:[1,1]
    v_pk_add_f32 v[86:87], v[86:87], v[54:55] op_sel:[0,0] op_sel_hi:[1,1]
    v_cvt_pk_bf16_f32 v118, v84, v85
    v_cvt_pk_bf16_f32 v119, v86, v87
    v_pk_fma_f32 v[72:73], v[42:43], v[104:105], v[72:73] op_sel:[0,0,0] op_sel_hi:[0,1,1]
    v_pk_fma_f32 v[74:75], v[42:43], v[106:107], v[74:75] op_sel:[0,0,0] op_sel_hi:[0,1,1]
    v_pk_mul_f32 v[72:73], v[72:73], v[96:97] op_sel:[0,0] op_sel_hi:[1,1]
    v_pk_mul_f32 v[74:75], v[74:75], v[98:99] op_sel:[0,0] op_sel_hi:[1,1]
    v_cvt_pk_bf16_f32 v120, v72, v73
    buffer_load_dwordx4 v19, s[12:15], s100 offen offset:3072 lds
    v_cvt_pk_bf16_f32 v121, v74, v75
    v_pk_fma_f32 v[88:89], v[42:43], v[108:109], v[88:89] op_sel:[0,0,0] op_sel_hi:[0,1,1]
    v_pk_fma_f32 v[90:91], v[42:43], v[110:111], v[90:91] op_sel:[0,0,0] op_sel_hi:[0,1,1]
    v_pk_mul_f32 v[88:89], v[88:89], v[100:101] op_sel:[0,0] op_sel_hi:[1,1]
    v_pk_mul_f32 v[90:91], v[90:91], v[102:103] op_sel:[0,0] op_sel_hi:[1,1]
    v_cvt_pk_bf16_f32 v122, v88, v89
    v_cvt_pk_bf16_f32 v123, v90, v91
    v_pk_fma_f32 v[76:77], v[42:43], v[104:105], v[76:77] op_sel:[1,0,0] op_sel_hi:[1,1,1]
    v_pk_fma_f32 v[78:79], v[42:43], v[106:107], v[78:79] op_sel:[1,0,0] op_sel_hi:[1,1,1]
    v_pk_mul_f32 v[76:77], v[76:77], v[96:97] op_sel:[0,0] op_sel_hi:[1,1]
    v_pk_mul_f32 v[78:79], v[78:79], v[98:99] op_sel:[0,0] op_sel_hi:[1,1]
    v_cvt_pk_bf16_f32 v124, v76, v77
    s_add_u32 m0, s58, 131072
    s_add_u32 s100, s82, 65536
    buffer_load_dwordx4 v19, s[12:15], s100 offen offset:0 lds
    v_cvt_pk_bf16_f32 v125, v78, v79
    v_pk_fma_f32 v[92:93], v[42:43], v[108:109], v[92:93] op_sel:[1,0,0] op_sel_hi:[1,1,1]
    v_pk_fma_f32 v[94:95], v[42:43], v[110:111], v[94:95] op_sel:[1,0,0] op_sel_hi:[1,1,1]
    v_pk_mul_f32 v[92:93], v[92:93], v[100:101] op_sel:[0,0] op_sel_hi:[1,1]
    v_pk_mul_f32 v[94:95], v[94:95], v[102:103] op_sel:[0,0] op_sel_hi:[1,1]
    v_cvt_pk_bf16_f32 v126, v92, v93
    v_cvt_pk_bf16_f32 v127, v94, v95
    s_waitcnt lgkmcnt(0)
    v_mfma_f32_16x16x32_bf16 v[84:87], a[0:3], a[228:231], 0
    v_mfma_f32_16x16x32_bf16 v[88:91], a[4:7], a[228:231], 0
    v_mfma_f32_16x16x32_bf16 v[84:87], a[8:11], a[228:231], v[84:87]
    v_mfma_f32_16x16x32_bf16 v[88:91], a[12:15], a[228:231], v[88:91]
    v_mfma_f32_16x16x32_bf16 v[84:87], a[16:19], a[228:231], v[84:87]
    v_mfma_f32_16x16x32_bf16 v[88:91], a[20:23], a[228:231], v[88:91]
    v_mfma_f32_16x16x32_bf16 v[84:87], a[24:27], a[228:231], v[84:87]
    v_mfma_f32_16x16x32_bf16 v[88:91], a[28:31], a[228:231], v[88:91]
    v_mfma_f32_16x16x32_bf16 v[64:67], v[112:115], v[120:123], 0
    v_mfma_f32_16x16x32_bf16 v[72:75], a[228:231], v[112:115], 0
    v_mfma_f32_16x16x32_bf16 v[68:71], v[116:119], v[124:127], 0
    v_mfma_f32_16x16x32_bf16 v[76:79], a[228:231], v[116:119], 0
    s_lshl_b32 s61, s48, 12
    v_add_u32 v60, s61, v1
    v_add_u32 v61, s61, v31
    s_waitcnt vmcnt(13)
    v_mfma_f32_16x16x32_bf16 v[80:83], a[80:83], a[64:67], 0
    v_mfma_f32_16x16x32_bf16 v[80:83], a[80:83], a[68:71], v[80:83]
    v_mfma_f32_16x16x32_bf16 v[80:83], a[80:83], a[72:75], v[80:83]
    v_mfma_f32_16x16x32_bf16 v[80:83], a[80:83], a[76:79], v[80:83]
    s_lshr_b32 s61, s48, 1
    s_and_b32 s62, s48, 1
    s_lshl_b32 s63, s61, 10
    s_lshl_b32 s64, s62, 9
    s_add_u32 s63, s63, s64
    v_add_u32 v54, s63, v28
    s_lshl_b32 s63, s61, 6
    v_add_u32 v55, s63, v31
    s_lshl_b32 s63, s53, 1
    s_add_u32 s63, s63, s61
    s_mul_i32 s63, s63, 1280
    s_add_u32 s63, s63, 114688
    s_lshl_b32 s64, s62, 9
    s_add_u32 s64, s64, s63
    s_lshl_b32 s62, s62, 28
    s_add_u32 s63, s63, s62
    ds_write_b128 v60, v[64:67] offset:0
    ds_write_b32 v61, v72 offset:2048
    ds_write_b128 v60, v[68:71] offset:1024
    ds_write_b32 v61, v76 offset:2112
    ds_write_b128 v60, v[84:87] offset:16384
    ds_write_b128 v60, v[88:91] offset:17408
    v_add_f32_dpp v80, v80, v80 row_ror:4 row_mask:0xf bank_mask:0xf
    v_add_f32_dpp v81, v81, v81 row_ror:4 row_mask:0xf bank_mask:0xf
    v_add_f32_dpp v82, v82, v82 row_ror:4 row_mask:0xf bank_mask:0xf
    v_add_f32_dpp v83, v83, v83 row_ror:4 row_mask:0xf bank_mask:0xf
    v_add_f32_dpp v80, v80, v80 row_ror:8 row_mask:0xf bank_mask:0xf
    v_add_f32_dpp v81, v81, v81 row_ror:8 row_mask:0xf bank_mask:0xf
    v_add_f32_dpp v82, v82, v82 row_ror:8 row_mask:0xf bank_mask:0xf
    v_add_f32_dpp v83, v83, v83 row_ror:8 row_mask:0xf bank_mask:0xf
    v_mov_b32 v38, v80
    s_nop 1
    v_mov_b32_dpp v38, v81 quad_perm:[0,1,2,3] row_mask:0xf bank_mask:2
    s_nop 1
    v_mov_b32_dpp v38, v82 quad_perm:[0,1,2,3] row_mask:0xf bank_mask:4
    s_nop 1
    v_mov_b32_dpp v38, v83 quad_perm:[0,1,2,3] row_mask:0xf bank_mask:8
    ds_read_b64_tr_b16 a[0:1], v7 offset:0
    ds_read_b64_tr_b16 a[2:3], v7 offset:256
    ds_read_b64_tr_b16 a[4:5], v8 offset:0
    ds_read_b64_tr_b16 a[6:7], v8 offset:256
    ds_read_b64_tr_b16 a[16:17], v7 offset:2048
    ds_read_b64_tr_b16 a[18:19], v7 offset:2304
    ds_read_b64_tr_b16 a[20:21], v8 offset:2048
    ds_read_b64_tr_b16 a[22:23], v8 offset:2304
    s_waitcnt lgkmcnt(4)
    v_mfma_f32_16x16x32_bf16 v[96:99], a[0:3], v[128:131], 0
    ds_read_b64_tr_b16 a[32:33], v7 offset:4096
    v_mfma_f32_16x16x32_bf16 v[104:107], a[0:3], v[132:135], 0
    ds_read_b64_tr_b16 a[34:35], v7 offset:4352
    buffer_load_dwordx4 v19, s[12:15], s100 offen offset:1024 lds
    v_mfma_f32_16x16x32_bf16 v[100:103], a[4:7], v[128:131], 0
    ds_read_b64_tr_b16 a[36:37], v8 offset:4096
    v_mfma_f32_16x16x32_bf16 v[108:111], a[4:7], v[132:135], 0
    ds_read_b64_tr_b16 a[38:39], v8 offset:4352
    s_waitcnt lgkmcnt(4)
    v_mfma_f32_16x16x32_bf16 v[96:99], a[16:19], v[136:139], v[96:99]
    ds_read_b64_tr_b16 a[0:1], v7 offset:6144
    v_mfma_f32_16x16x32_bf16 v[104:107], a[16:19], v[140:143], v[104:107]
    ds_read_b64_tr_b16 a[2:3], v7 offset:6400
    buffer_load_dwordx4 v19, s[12:15], s100 offen offset:2048 lds
    v_mfma_f32_16x16x32_bf16 v[100:103], a[20:23], v[136:139], v[100:103]
    ds_read_b64_tr_b16 a[4:5], v8 offset:6144
    v_mfma_f32_16x16x32_bf16 v[108:111], a[20:23], v[140:143], v[108:111]
    ds_read_b64_tr_b16 a[6:7], v8 offset:6400
    s_mov_b32 s85, 1
    s_waitcnt vmcnt(11)
    v_and_b32 v47, s85, v47
    v_cmp_ne_u32 vcc, s85, v47
    s_nop 0
    s_cmp_eq_u64 vcc, 0
    s_cbranch_scc1 POLLD_4
    s_mov_b32 s72, 30000
POLL_3:
    buffer_load_dword v63, v31, s[32:35], 0 offen sc1
    s_waitcnt vmcnt(0)
    v_and_b32 v63, s85, v63
    v_cmp_ne_u32 vcc, s85, v63
    s_nop 0
    s_cmp_eq_u64 vcc, 0
    s_cbranch_scc1 POLLD_4
    s_sub_u32 s72, s72, 1
    s_cbranch_scc0 POLL_3
POLLD_4:
    s_barrier
    ds_read2st64_b32 v[64:65], v54 offset0:0 offset1:1
    ds_read_b32 v72, v55 offset:2048
    ds_read2st64_b32 v[66:67], v54 offset0:16 offset1:17
    ds_read_b32 v73, v55 offset:6144
    ds_read2st64_b32 v[68:69], v54 offset0:32 offset1:33
    ds_read_b32 v74, v55 offset:10240
    ds_read2st64_b32 v[70:71], v54 offset0:48 offset1:49
    ds_read_b32 v75, v55 offset:14336
    ds_read_b128 v[112:115], v1 offset:16384
    ds_read_b128 v[116:119], v1 offset:17408
    ds_read_b128 v[120:123], v1 offset:20480
    ds_read_b128 v[124:127], v1 offset:21504
    ds_read_b128 v[84:87], v1 offset:24576
    ds_read_b128 v[88:91], v1 offset:25600
    ds_read_b128 v[40:43], v1 offset:28672
    ds_read_b128 v[44:47], v1 offset:29696
    s_mov_b32 exec_hi, 0
    buffer_atomic_add_f32 v38, v39, s[36:39], 0 offen sc1
    s_mov_b64 exec, -1
    s_waitcnt lgkmcnt(15)
    v_mfma_f32_16x16x32_bf16 v[96:99], a[32:35], v[144:147], v[96:99]
    ds_read_b64_tr_b16 a[16:17], v7 offset:8192
    v_mfma_f32_16x16x32_bf16 v[104:107], a[32:35], v[148:151], v[104:107]
    ds_read_b64_tr_b16 a[18:19], v7 offset:8448
    buffer_load_dwordx4 v19, s[12:15], s100 offen offset:3072 lds
    v_mfma_f32_16x16x32_bf16 v[100:103], a[36:39], v[144:147], v[100:103]
    ds_read_b64_tr_b16 a[20:21], v8 offset:8192
    v_mfma_f32_16x16x32_bf16 v[108:111], a[36:39], v[148:151], v[108:111]
    ds_read_b64_tr_b16 a[22:23], v8 offset:8448
    v_mfma_f32_16x16x32_bf16 v[96:99], a[0:3], v[152:155], v[96:99]
    ds_read_b64_tr_b16 a[32:33], v7 offset:10240
    v_mfma_f32_16x16x32_bf16 v[104:107], a[0:3], v[156:159], v[104:107]
    ds_read_b64_tr_b16 a[34:35], v7 offset:10496
    s_add_u32 m0, s58, 135168
    s_add_u32 s100, s82, 98304
    buffer_load_dwordx4 v19, s[12:15], s100 offen offset:0 lds
    v_mfma_f32_16x16x32_bf16 v[100:103], a[4:7], v[152:155], v[100:103]
    ds_read_b64_tr_b16 a[36:37], v8 offset:10240
    v_mfma_f32_16x16x32_bf16 v[108:111], a[4:7], v[156:159], v[108:111]
    ds_read_b64_tr_b16 a[38:39], v8 offset:10496
    s_waitcnt lgkmcnt(8)
    v_add_f32 v64, v64, v66
    v_add_f32 v65, v65, v67
    v_add_f32 v68, v68, v70
    v_add_f32 v69, v69, v71
    v_add_f32 v72, v72, v73
    v_add_f32 v74, v74, v75
    v_add_f32 v64, v64, v68
    v_add_f32 v65, v65, v69
    v_add_f32 v72, v72, v74
    buffer_atomic_add_f32 v64, v28, s[36:39], s64 offen sc1
    buffer_atomic_add_f32 v65, v28, s[36:39], s64 offen offset:256 sc1
    s_mov_b64 exec, 0xffff
    buffer_atomic_add_f32 v72, v31, s[36:39], s63 offen offset:1024 sc1
    s_mov_b64 exec, -1
    s_waitcnt lgkmcnt(4)
    v_mfma_f32_16x16x32_bf16 v[96:99], a[16:19], v[160:163], v[96:99]
    ds_read_b64_tr_b16 a[0:1], v7 offset:12288
    v_add_f32 v112, v112, v120
    v_mfma_f32_16x16x32_bf16 v[104:107], a[16:19], v[164:167], v[104:107]
    ds_read_b64_tr_b16 a[2:3], v7 offset:12544
    buffer_load_dwordx4 v19, s[12:15], s100 offen offset:1024 lds
    v_mfma_f32_16x16x32_bf16 v[100:103], a[20:23], v[160:163], v[100:103]
    ds_read_b64_tr_b16 a[4:5], v8 offset:12288
    v_add_f32 v113, v113, v121
    v_mfma_f32_16x16x32_bf16 v[108:111], a[20:23], v[164:167], v[108:111]
    ds_read_b64_tr_b16 a[6:7], v8 offset:12544
    v_add_f32 v114, v114, v122
    s_waitcnt lgkmcnt(4)
    v_mfma_f32_16x16x32_bf16 v[96:99], a[32:35], v[168:171], v[96:99]
    ds_read_b64_tr_b16 a[16:17], v7 offset:14336
    v_add_f32 v115, v115, v123
    v_mfma_f32_16x16x32_bf16 v[104:107], a[32:35], v[172:175], v[104:107]
    ds_read_b64_tr_b16 a[18:19], v7 offset:14592
    buffer_load_dwordx4 v19, s[12:15], s100 offen offset:2048 lds
    v_mfma_f32_16x16x32_bf16 v[100:103], a[36:39], v[168:171], v[100:103]
    ds_read_b64_tr_b16 a[20:21], v8 offset:14336
    v_add_f32 v116, v116, v124
    v_mfma_f32_16x16x32_bf16 v[108:111], a[36:39], v[172:175], v[108:111]
    ds_read_b64_tr_b16 a[22:23], v8 offset:14592
    v_add_f32 v117, v117, v125
    s_waitcnt lgkmcnt(4)
    v_mfma_f32_16x16x32_bf16 v[96:99], a[0:3], v[176:179], v[96:99]
    ds_read_b64_tr_b16 a[32:33], v7 offset:16384
    v_add_f32 v118, v118, v126
    v_mfma_f32_16x16x32_bf16 v[104:107], a[0:3], v[180:183], v[104:107]
    ds_read_b64_tr_b16 a[34:35], v7 offset:16640
    buffer_load_dwordx4 v19, s[12:15], s100 offen offset:3072 lds
    v_mfma_f32_16x16x32_bf16 v[100:103], a[4:7], v[176:179], v[100:103]
    ds_read_b64_tr_b16 a[36:37], v8 offset:16384
    v_add_f32 v119, v119, v127
    v_mfma_f32_16x16x32_bf16 v[108:111], a[4:7], v[180:183], v[108:111]
    ds_read_b64_tr_b16 a[38:39], v8 offset:16640
    v_add_f32 v40, v40, v84
    s_waitcnt lgkmcnt(4)
    v_mfma_f32_16x16x32_bf16 v[96:99], a[16:19], v[184:187], v[96:99]
    ds_read_b64_tr_b16 a[0:1], v7 offset:18432
    v_add_f32 v41, v41, v85
    v_mfma_f32_16x16x32_bf16 v[104:107], a[16:19], v[188:191], v[104:107]
    ds_read_b64_tr_b16 a[2:3], v7 offset:18688
    v_mfma_f32_16x16x32_bf16 v[100:103], a[20:23], v[184:187], v[100:103]
    ds_read_b64_tr_b16 a[4:5], v8 offset:18432
    v_add_f32 v42, v42, v86
    v_mfma_f32_16x16x32_bf16 v[108:111], a[20:23], v[188:191], v[108:111]
    ds_read_b64_tr_b16 a[6:7], v8 offset:18688
    v_add_f32 v43, v43, v87
    s_waitcnt lgkmcnt(4)
    v_mfma_f32_16x16x32_bf16 v[96:99], a[32:35], v[192:195], v[96:99]
    ds_read_b64_tr_b16 a[16:17], v7 offset:20480
    v_add_f32 v44, v44, v88
    v_mfma_f32_16x16x32_bf16 v[104:107], a[32:35], v[196:199], v[104:107]
    ds_read_b64_tr_b16 a[18:19], v7 offset:20736
    s_lshl_b32 s61, s94, 14
    s_lshl_b32 s62, s55, 7
    s_add_u32 s61, s61, s62
    buffer_load_dwordx4 v[20:23], v37, s[4:7], s61 offen
    buffer_load_dwordx4 v[24:27], v37, s[4:7], s61 offen offset:64
    v_mfma_f32_16x16x32_bf16 v[100:103], a[36:39], v[192:195], v[100:103]
    ds_read_b64_tr_b16 a[20:21], v8 offset:20480
    v_add_f32 v45, v45, v89
    v_mfma_f32_16x16x32_bf16 v[108:111], a[36:39], v[196:199], v[108:111]
    ds_read_b64_tr_b16 a[22:23], v8 offset:20736
    v_add_f32 v46, v46, v90
    s_waitcnt lgkmcnt(4)
    v_mfma_f32_16x16x32_bf16 v[96:99], a[0:3], v[200:203], v[96:99]
    ds_read_b64_tr_b16 a[32:33], v7 offset:22528
    v_add_f32 v47, v47, v91
    v_mfma_f32_16x16x32_bf16 v[104:107], a[0:3], v[204:207], v[104:107]
    ds_read_b64_tr_b16 a[34:35], v7 offset:22784
    v_add_f32 v40, v40, v112
    v_mfma_f32_16x16x32_bf16 v[100:103], a[4:7], v[200:203], v[100:103]
    ds_read_b64_tr_b16 a[36:37], v8 offset:22528
    v_add_f32 v41, v41, v113
    v_mfma_f32_16x16x32_bf16 v[108:111], a[4:7], v[204:207], v[108:111]
    ds_read_b64_tr_b16 a[38:39], v8 offset:22784
    v_add_f32 v42, v42, v114
    s_waitcnt lgkmcnt(4)
    v_mfma_f32_16x16x32_bf16 v[96:99], a[16:19], v[208:211], v[96:99]
    ds_read_b64_tr_b16 a[0:1], v7 offset:24576
    v_add_f32 v43, v43, v115
    v_mfma_f32_16x16x32_bf16 v[104:107], a[16:19], v[212:215], v[104:107]
    ds_read_b64_tr_b16 a[2:3], v7 offset:24832
    v_add_f32 v44, v44, v116
    v_mfma_f32_16x16x32_bf16 v[100:103], a[20:23], v[208:211], v[100:103]
    ds_read_b64_tr_b16 a[4:5], v8 offset:24576
    v_add_f32 v45, v45, v117
    v_mfma_f32_16x16x32_bf16 v[108:111], a[20:23], v[212:215], v[108:111]
    ds_read_b64_tr_b16 a[6:7], v8 offset:24832
    v_add_f32 v46, v46, v118
    s_waitcnt lgkmcnt(4)
    v_mfma_f32_16x16x32_bf16 v[96:99], a[32:35], v[216:219], v[96:99]
    ds_read_b64_tr_b16 a[16:17], v7 offset:26624
    v_add_f32 v47, v47, v119
    v_mfma_f32_16x16x32_bf16 v[104:107], a[32:35], v[220:223], v[104:107]
    ds_read_b64_tr_b16 a[18:19], v7 offset:26880
    v_accvgpr_write_b32 a248, v40
    v_mfma_f32_16x16x32_bf16 v[100:103], a[36:39], v[216:219], v[100:103]
    ds_read_b64_tr_b16 a[20:21], v8 offset:26624
    v_accvgpr_write_b32 a249, v41
    v_mfma_f32_16x16x32_bf16 v[108:111], a[36:39], v[220:223], v[108:111]
    ds_read_b64_tr_b16 a[22:23], v8 offset:26880
    v_accvgpr_write_b32 a250, v42
    s_waitcnt lgkmcnt(4)
    v_mfma_f32_16x16x32_bf16 v[96:99], a[0:3], v[224:227], v[96:99]
    ds_read_b64_tr_b16 a[32:33], v7 offset:28672
    v_accvgpr_write_b32 a251, v43
    v_mfma_f32_16x16x32_bf16 v[104:107], a[0:3], v[228:231], v[104:107]
    ds_read_b64_tr_b16 a[34:35], v7 offset:28928
    v_accvgpr_write_b32 a252, v44
    v_mfma_f32_16x16x32_bf16 v[100:103], a[4:7], v[224:227], v[100:103]
    ds_read_b64_tr_b16 a[36:37], v8 offset:28672
    v_accvgpr_write_b32 a253, v45
    v_mfma_f32_16x16x32_bf16 v[108:111], a[4:7], v[228:231], v[108:111]
    ds_read_b64_tr_b16 a[38:39], v8 offset:28928
    v_accvgpr_write_b32 a254, v46
    s_waitcnt lgkmcnt(4)
    v_mfma_f32_16x16x32_bf16 v[96:99], a[16:19], v[232:235], v[96:99]
    ds_read_b64_tr_b16 a[0:1], v7 offset:30720
    v_accvgpr_write_b32 a255, v47
    v_mfma_f32_16x16x32_bf16 v[104:107], a[16:19], v[236:239], v[104:107]
    ds_read_b64_tr_b16 a[2:3], v7 offset:30976
    v_mfma_f32_16x16x32_bf16 v[100:103], a[20:23], v[232:235], v[100:103]
    ds_read_b64_tr_b16 a[4:5], v8 offset:30720
    v_mfma_f32_16x16x32_bf16 v[108:111], a[20:23], v[236:239], v[108:111]
    ds_read_b64_tr_b16 a[6:7], v8 offset:30976
    s_waitcnt lgkmcnt(4)
    v_mfma_f32_16x16x32_bf16 v[96:99], a[32:35], v[240:243], v[96:99]
    v_mfma_f32_16x16x32_bf16 v[104:107], a[32:35], v[244:247], v[104:107]
    v_mfma_f32_16x16x32_bf16 v[100:103], a[36:39], v[240:243], v[100:103]
    v_mfma_f32_16x16x32_bf16 v[108:111], a[36:39], v[244:247], v[108:111]
    s_waitcnt lgkmcnt(0)
    v_mfma_f32_16x16x32_bf16 v[96:99], a[0:3], v[248:251], v[96:99]
    v_mfma_f32_16x16x32_bf16 v[104:107], a[0:3], v[252:255], v[104:107]
    v_mfma_f32_16x16x32_bf16 v[100:103], a[4:7], v[248:251], v[100:103]
    v_mfma_f32_16x16x32_bf16 v[108:111], a[4:7], v[252:255], v[108:111]
    s_lshl_b32 s61, s56, 14
    s_lshl_b32 s62, s53, 10
    s_add_u32 s61, s61, s62
    s_add_u32 s61, s61, 2097152
    s_nop 0
    v_pk_fma_f32 v[96:97], v[40:41], v[56:57], v[96:97] op_sel:[0,1,0] op_sel_hi:[1,1,1]
    v_pk_fma_f32 v[98:99], v[42:43], v[56:57], v[98:99] op_sel:[0,1,0] op_sel_hi:[1,1,1]
    v_pk_fma_f32 v[96:97], v[96:97], v[56:57], s[78:79] op_sel:[0,0,0] op_sel_hi:[1,0,0]
    v_pk_fma_f32 v[98:99], v[98:99], v[56:57], s[78:79] op_sel:[0,0,0] op_sel_hi:[1,0,0]
    v_pk_mul_f32 v[48:49], s[76:77], v[96:97] op_sel:[0,0] op_sel_hi:[0,1]
    v_pk_mul_f32 v[50:51], s[76:77], v[98:99] op_sel:[0,0] op_sel_hi:[0,1]
    v_exp_f32 v48, v48 clamp
    v_exp_f32 v50, v50 clamp
    v_exp_f32 v49, v49 clamp
    v_exp_f32 v51, v51 clamp
    v_max_f32 v96, s78, v96
    v_max_f32 v98, s78, v98
    v_max_f32 v97, s78, v97
    v_max_f32 v99, s78, v99
    v_pk_add_f32 v[96:97], v[96:97], v[48:49] op_sel:[0,0] op_sel_hi:[1,1]
    v_pk_add_f32 v[98:99], v[98:99], v[50:51] op_sel:[0,0] op_sel_hi:[1,1]
    v_cvt_pk_bf16_f32 v112, v96, v97
    v_cvt_pk_bf16_f32 v113, v98, v99
    v_pk_fma_f32 v[100:101], v[44:45], v[56:57], v[100:101] op_sel:[0,1,0] op_sel_hi:[1,1,1]
    v_pk_fma_f32 v[102:103], v[46:47], v[56:57], v[102:103] op_sel:[0,1,0] op_sel_hi:[1,1,1]
    v_pk_fma_f32 v[100:101], v[100:101], v[56:57], s[78:79] op_sel:[0,0,0] op_sel_hi:[1,0,0]
    v_pk_fma_f32 v[102:103], v[102:103], v[56:57], s[78:79] op_sel:[0,0,0] op_sel_hi:[1,0,0]
    v_pk_mul_f32 v[52:53], s[76:77], v[100:101] op_sel:[0,0] op_sel_hi:[0,1]
    v_pk_mul_f32 v[54:55], s[76:77], v[102:103] op_sel:[0,0] op_sel_hi:[0,1]
    v_exp_f32 v52, v52 clamp
    v_exp_f32 v54, v54 clamp
    v_exp_f32 v53, v53 clamp
    v_exp_f32 v55, v55 clamp
    v_max_f32 v100, s78, v100
    v_max_f32 v102, s78, v102
    v_max_f32 v101, s78, v101
    v_max_f32 v103, s78, v103
    v_pk_add_f32 v[100:101], v[100:101], v[52:53] op_sel:[0,0] op_sel_hi:[1,1]
    v_pk_add_f32 v[102:103], v[102:103], v[54:55] op_sel:[0,0] op_sel_hi:[1,1]
    v_cvt_pk_bf16_f32 v114, v100, v101
    v_cvt_pk_bf16_f32 v115, v102, v103
    buffer_store_dwordx4 v[112:115], v1, s[36:39], s61 offen sc1
    v_pk_fma_f32 v[104:105], v[40:41], v[58:59], v[104:105] op_sel:[0,1,0] op_sel_hi:[1,1,1]
    v_pk_fma_f32 v[106:107], v[42:43], v[58:59], v[106:107] op_sel:[0,1,0] op_sel_hi:[1,1,1]
    v_pk_fma_f32 v[104:105], v[104:105], v[58:59], s[78:79] op_sel:[0,0,0] op_sel_hi:[1,0,0]
    v_pk_fma_f32 v[106:107], v[106:107], v[58:59], s[78:79] op_sel:[0,0,0] op_sel_hi:[1,0,0]
    v_pk_mul_f32 v[48:49], s[76:77], v[104:105] op_sel:[0,0] op_sel_hi:[0,1]
    v_pk_mul_f32 v[50:51], s[76:77], v[106:107] op_sel:[0,0] op_sel_hi:[0,1]
    v_exp_f32 v48, v48 clamp
    v_exp_f32 v50, v50 clamp
    v_exp_f32 v49, v49 clamp
    v_exp_f32 v51, v51 clamp
    v_max_f32 v104, s78, v104
    v_max_f32 v106, s78, v106
    v_max_f32 v105, s78, v105
    v_max_f32 v107, s78, v107
    v_pk_add_f32 v[104:105], v[104:105], v[48:49] op_sel:[0,0] op_sel_hi:[1,1]
    v_pk_add_f32 v[106:107], v[106:107], v[50:51] op_sel:[0,0] op_sel_hi:[1,1]
    v_cvt_pk_bf16_f32 v116, v104, v105
    v_cvt_pk_bf16_f32 v117, v106, v107
    v_pk_fma_f32 v[108:109], v[44:45], v[58:59], v[108:109] op_sel:[0,1,0] op_sel_hi:[1,1,1]
    v_pk_fma_f32 v[110:111], v[46:47], v[58:59], v[110:111] op_sel:[0,1,0] op_sel_hi:[1,1,1]
    v_pk_fma_f32 v[108:109], v[108:109], v[58:59], s[78:79] op_sel:[0,0,0] op_sel_hi:[1,0,0]
    v_pk_fma_f32 v[110:111], v[110:111], v[58:59], s[78:79] op_sel:[0,0,0] op_sel_hi:[1,0,0]
    v_pk_mul_f32 v[52:53], s[76:77], v[108:109] op_sel:[0,0] op_sel_hi:[0,1]
    v_pk_mul_f32 v[54:55], s[76:77], v[110:111] op_sel:[0,0] op_sel_hi:[0,1]
    v_exp_f32 v52, v52 clamp
    v_exp_f32 v54, v54 clamp
    v_exp_f32 v53, v53 clamp
    v_exp_f32 v55, v55 clamp
    v_max_f32 v108, s78, v108
    v_max_f32 v110, s78, v110
    v_max_f32 v109, s78, v109
    v_max_f32 v111, s78, v111
    v_pk_add_f32 v[108:109], v[108:109], v[52:53] op_sel:[0,0] op_sel_hi:[1,1]
    v_pk_add_f32 v[110:111], v[110:111], v[54:55] op_sel:[0,0] op_sel_hi:[1,1]
    v_cvt_pk_bf16_f32 v118, v108, v109
    v_cvt_pk_bf16_f32 v119, v110, v111
    buffer_store_dwordx4 v[116:119], v2, s[36:39], s61 offen sc1
    s_lshl_b32 s68, s53, 7
    s_lshl_b32 s61, s49, 3
    s_add_u32 s68, s68, s61
    s_lshl_b32 s61, s52, 2
    s_add_u32 s68, s68, s61
    s_add_u32 s68, s68, 0
    s_waitcnt vmcnt(4)
    ds_read_b64_tr_b16 a[0:1], v13 offset:32768
    ds_read_b64_tr_b16 a[2:3], v13 offset:33280
    ds_read_b64_tr_b16 a[4:5], v13 offset:32776
    ds_read_b64_tr_b16 a[6:7], v13 offset:33288
    ds_read_b64_tr_b16 a[8:9], v14 offset:32768
    ds_read_b64_tr_b16 a[10:11], v14 offset:33280
    ds_read_b64_tr_b16 a[12:13], v14 offset:32776
    ds_read_b64_tr_b16 a[14:15], v14 offset:33288
    ds_read_b64_tr_b16 a[16:17], v13 offset:36864
    ds_read_b64_tr_b16 a[18:19], v13 offset:37376
    ds_read_b64_tr_b16 a[20:21], v13 offset:36872
    ds_read_b64_tr_b16 a[22:23], v13 offset:37384
    ds_read_b64_tr_b16 a[24:25], v14 offset:36864
    ds_read_b64_tr_b16 a[26:27], v14 offset:37376
    ds_read_b64_tr_b16 a[28:29], v14 offset:36872
    ds_read_b64_tr_b16 a[30:31], v14 offset:37384
    ds_read_b64_tr_b16 a[32:33], v15 offset:0
    ds_read_b64_tr_b16 a[34:35], v15 offset:512
    ds_read_b64_tr_b16 a[36:37], v15 offset:8
    ds_read_b64_tr_b16 a[38:39], v15 offset:520
    ds_read_b64_tr_b16 a[40:41], v16 offset:0
    ds_read_b64_tr_b16 a[42:43], v16 offset:512
    ds_read_b64_tr_b16 a[44:45], v16 offset:8
    ds_read_b64_tr_b16 a[46:47], v16 offset:520
    ds_read_b64_tr_b16 v[240:241], v15 offset:4096
    ds_read_b64_tr_b16 v[242:243], v15 offset:4608
    ds_read_b64_tr_b16 v[244:245], v15 offset:4104
    ds_read_b64_tr_b16 v[246:247], v15 offset:4616
    ds_read_b64_tr_b16 v[248:249], v16 offset:4096
    ds_read_b64_tr_b16 v[250:251], v16 offset:4608
    ds_read_b64_tr_b16 v[252:253], v16 offset:4104
    ds_read_b64_tr_b16 v[254:255], v16 offset:4616
    s_waitcnt vmcnt(0)
    s_barrier
    s_cmp_lg_u32 s48, 0
    s_cbranch_scc1 SK_5
    v_lshlrev_b32 v62, 11, v0
    v_mov_b32 v63, 1
    s_mov_b64 exec, 0xff
    buffer_store_dword v63, v62, s[36:39], s68 offen sc1
    s_mov_b64 exec, -1
SK_5:
    v_mov_b32 v48, -1
    v_mov_b32 v49, -1
    v_mov_b32 v50, -1
    v_mov_b32 v51, -1
    s_lshl_b32 s61, s94, 14
    s_lshl_b32 s62, s55, 11
    s_add_u32 s61, s61, s62
    s_add_u32 s62, s61, 10485760
    buffer_store_dwordx4 v[48:51], v1, s[36:39], s62 offen offset:0 sc1
    buffer_store_dwordx4 v[48:51], v1, s[36:39], s62 offen offset:1024 sc1
    s_add_u32 s62, s61, 8388608
    buffer_store_dwordx4 v[48:51], v1, s[36:39], s62 offen offset:0 sc1
    buffer_store_dwordx4 v[48:51], v1, s[36:39], s62 offen offset:1024 sc1
    s_lshr_b32 s61, s61, 4
    s_mov_b64 exec, 0xff
    s_add_u32 s62, s61, 1310720
    buffer_store_dwordx4 v[48:51], v1, s[36:39], s62 offen sc1
    s_add_u32 s62, s61, 1179648
    buffer_store_dwordx4 v[48:51], v1, s[36:39], s62 offen sc1
    s_mov_b64 exec, -1
    s_add_u32 m0, s58, 32768
    s_add_u32 s100, s81, 0
    buffer_load_dwordx4 v18, s[20:23], s100 offen offset:0 lds
    buffer_load_dwordx4 v32, s[20:23], s100 offen offset:1024 lds
    buffer_load_dwordx4 v33, s[20:23], s100 offen offset:2048 lds
    s_add_u32 m0, s58, 35840
    s_add_u32 s100, s81, 132096
    buffer_load_dwordx4 v18, s[20:23], s100 offen offset:0 lds
    buffer_load_dwordx4 v32, s[20:23], s100 offen offset:1024 lds
    buffer_load_dwordx4 v33, s[20:23], s100 offen offset:2048 lds
    s_add_u32 m0, s58, 38912
    s_add_u32 s100, s81, 264192
    buffer_load_dwordx4 v18, s[20:23], s100 offen offset:0 lds
    buffer_load_dwordx4 v32, s[20:23], s100 offen offset:1024 lds
    s_lshl_b32 s73, s51, 13
    s_mov_b32 s74, 0
    s_lshl_b32 s61, s48, 9
    s_lshl_b32 s62, s49, 11
    s_add_u32 s61, s61, s62
    s_lshl_b32 s62, s51, 14
    v_lshlrev_b32 v62, 3, v30
    v_add_u32 v62, v62, v31
    s_add_u32 s61, s61, s62
    s_add_u32 s61, s61, 0
    s_mov_b32 s85, 1
    buffer_load_dword v64, v62, s[36:39], s61 offen sc1
    v_add_u32 v3, 12288, v1
    v_add_u32 v4, 24576, v1
    v_add_u32 v38, 36864, v1
    v_and_b32 v39, 12, v28
    s_mov_b32 s65, s61
    s_add_u32 s61, s58, 0
    v_add_u32 v61, s61, v1
    v_add_u32 v60, 65536, v61
    s_add_u32 s60, s48, 1
    s_and_b32 s60, s60, 3
    s_lshl_b32 s60, s60, 13
    s_add_u32 s60, s60, 65536
    v_add_u32 v57, s60, v1
    s_add_u32 s60, s48, 2
    s_and_b32 s60, s60, 3
    s_lshl_b32 s60, s60, 13
    s_add_u32 s60, s60, 4096
    v_add_u32 v58, s60, v1
    s_add_u32 s60, s48, 3
    s_and_b32 s60, s60, 3
    s_lshl_b32 s60, s60, 13
    s_add_u32 s60, s60, 0
    v_add_u32 v59, s60, v1
    s_mul_i32 s63, s48, 10240
    s_mul_i32 s62, s51, 40960
    s_add_u32 s63, s63, s62
    s_add_u32 s63, s63, 114688
    s_lshl_b32 s62, s48, 12
    s_add_u32 s62, s62, s74
    s_add_u32 s62, s62, 2097152
    v_lshlrev_b32 v40, 16, v20
    v_and_b32 v41, 0xffff0000, v20
    v_lshlrev_b32 v42, 16, v21
    v_and_b32 v43, 0xffff0000, v21
    v_lshlrev_b32 v44, 16, v22
    v_and_b32 v45, 0xffff0000, v22
    v_lshlrev_b32 v46, 16, v23
    v_and_b32 v47, 0xffff0000, v23
    v_lshlrev_b32 v48, 16, v24
    v_and_b32 v49, 0xffff0000, v24
    v_lshlrev_b32 v50, 16, v25
    v_and_b32 v51, 0xffff0000, v25
    v_lshlrev_b32 v52, 16, v26
    v_and_b32 v53, 0xffff0000, v26
    v_lshlrev_b32 v54, 16, v27
    v_and_b32 v55, 0xffff0000, v27
    v_mov_b32 v20, s78
    v_mov_b32 v21, s78
    v_mov_b32 v22, s78
    v_mov_b32 v23, s78
    s_waitcnt vmcnt(0)
    v_and_b32 v64, s85, v64
    v_cmp_ne_u32 vcc, s85, v64
    s_nop 0
    s_cmp_eq_u64 vcc, 0
    s_cbranch_scc1 POLLD_7
    v_lshrrev_b32 v65, 4, v0
    v_mul_u32_u24 v65, 2752, v65
    v_and_b32 v66, 15, v0
    v_min_u32 v66, 12, v66
    v_lshl_add_u32 v65, v66, 7, v65
    s_add_u32 s60, s87, 0
    buffer_load_dword a224, v65, s[20:23], s60 offen
    s_mov_b32 s72, 30000
POLL_6:
    buffer_load_dword v63, v62, s[36:39], s65 offen sc1
    s_waitcnt vmcnt(0)
    v_and_b32 v63, s85, v63
    v_cmp_ne_u32 vcc, s85, v63
    s_nop 0
    s_cmp_eq_u64 vcc, 0
    s_cbranch_scc1 POLLD_7
    s_sub_u32 s72, s72, 1
    s_cbranch_scc0 POLL_6
POLLD_7:
    buffer_load_dwordx4 v[128:131], v1, s[36:39], s63 offen sc1
    buffer_load_dwordx4 v[132:135], v1, s[36:39], s63 offen offset:1280 sc1
    buffer_load_dwordx4 v[160:163], v34, s[36:39], s63 offen sc1
    s_add_u32 s63, s63, 2560
    s_lshl_b32 s64, s91, 14
    s_add_u32 s64, s64, s62
    buffer_load_dwordx4 v[176:179], v1, s[36:39], s64 offen offset:0 sc1
    buffer_load_dwordx4 v[136:139], v1, s[36:39], s63 offen sc1
    buffer_load_dwordx4 v[140:143], v1, s[36:39], s63 offen offset:1280 sc1
    buffer_load_dwordx4 v[164:167], v34, s[36:39], s63 offen sc1
    s_add_u32 s63, s63, 2560
    buffer_load_dwordx4 v[180:183], v1, s[36:39], s64 offen offset:1024 sc1
    buffer_load_dwordx4 v[144:147], v1, s[36:39], s63 offen sc1
    buffer_load_dwordx4 v[148:151], v1, s[36:39], s63 offen offset:1280 sc1
    buffer_load_dwordx4 v[168:171], v34, s[36:39], s63 offen sc1
    s_add_u32 s63, s63, 2560
    buffer_load_dwordx4 v[184:187], v1, s[36:39], s64 offen offset:2048 sc1
    buffer_load_dwordx4 v[152:155], v1, s[36:39], s63 offen sc1
    buffer_load_dwordx4 v[156:159], v1, s[36:39], s63 offen offset:1280 sc1
    buffer_load_dwordx4 v[172:175], v34, s[36:39], s63 offen sc1
    buffer_load_dwordx4 v[188:191], v1, s[36:39], s64 offen offset:3072 sc1
    s_lshl_b32 s64, s92, 14
    s_add_u32 s64, s64, s62
    buffer_load_dwordx4 v[192:195], v1, s[36:39], s64 offen offset:0 sc1
    buffer_load_dwordx4 v[196:199], v1, s[36:39], s64 offen offset:1024 sc1
    buffer_load_dwordx4 v[200:203], v1, s[36:39], s64 offen offset:2048 sc1
    buffer_load_dwordx4 v[204:207], v1, s[36:39], s64 offen offset:3072 sc1
    s_mov_b32 s44, s36
    s_mov_b32 s45, s37
    s_mov_b32 s46, s38
    s_mov_b32 s47, s39
    s_lshl_b32 s89, s94, 14
    s_lshl_b32 s61, s55, 11
    s_add_u32 s89, s89, s61
    s_add_u32 s89, s89, s74
    s_add_u32 s89, s89, 6291456
    s_mov_b32 s88, 1024
    v_mov_b32 v56, v1
    s_lshr_b32 s69, s94, 1
    s_lshl_b32 s69, s69, 5
    s_add_u32 s69, s69, s55
    s_lshl_b32 s69, s69, 2
    s_and_b32 s61, s48, 1
    s_add_u32 s69, s69, s61
    s_add_u32 s68, s69, s73
    s_add_u32 s68, s68, 32768
    s_lshl_b32 s59, s94, 10
    s_lshl_b32 s61, s55, 7
    s_add_u32 s59, s59, s61
    s_lshl_b32 s67, s51, 17
    s_add_u32 s67, s67, 1048576
    s_add_u32 s66, s67, s59
    s_waitcnt lgkmcnt(0)
    s_waitcnt vmcnt(17)
    v_cvt_pk_bf16_f32 v128, v128, v129
    v_cvt_pk_bf16_f32 v129, v130, v131
    v_cvt_pk_bf16_f32 v132, v132, v133
    v_cvt_pk_bf16_f32 v133, v134, v135
    v_mov_b32 v130, 0
    v_mov_b32 v131, 0
    v_cvt_pk_bf16_f32 v160, v160, v161
    v_cvt_pk_bf16_f32 v161, v162, v163
    v_and_b32 v162, v36, v160
    v_and_b32 v163, v36, v161
    v_and_b32 v160, v35, v160
    v_and_b32 v161, v35, v161
    s_waitcnt vmcnt(16)
    s_nop 0
    v_mfma_f32_16x16x32_bf16 v[104:107], v[160:163], v[176:179], v[20:23]
    v_mfma_f32_16x16x32_bf16 v[96:99], v[128:131], v[176:179], 0
    v_mfma_f32_16x16x32_bf16 v[100:103], v[130:133], v[176:179], 0
    s_lshl_b32 s64, s93, 14
    s_add_u32 s64, s64, s62
    buffer_load_dwordx4 v[208:211], v1, s[36:39], s64 offen offset:0 sc1
    s_waitcnt vmcnt(14)
    v_cvt_pk_bf16_f32 v136, v136, v137
    v_cvt_pk_bf16_f32 v137, v138, v139
    v_cvt_pk_bf16_f32 v140, v140, v141
    v_cvt_pk_bf16_f32 v141, v142, v143
    v_mov_b32 v138, 0
    v_mov_b32 v139, 0
    v_cvt_pk_bf16_f32 v164, v164, v165
    v_cvt_pk_bf16_f32 v165, v166, v167
    v_and_b32 v166, v36, v164
    v_and_b32 v167, v36, v165
    v_and_b32 v164, v35, v164
    v_and_b32 v165, v35, v165
    s_waitcnt vmcnt(13)
    s_nop 0
    v_mfma_f32_16x16x32_bf16 v[116:119], v[164:167], v[180:183], v[20:23]
    v_mfma_f32_16x16x32_bf16 v[108:111], v[136:139], v[180:183], 0
    v_mfma_f32_16x16x32_bf16 v[112:115], v[138:141], v[180:183], 0
    buffer_load_dwordx4 v[212:215], v1, s[36:39], s64 offen offset:1024 sc1
    v_rcp_f32 v24, v104
    v_rcp_f32 v25, v105
    v_mul_f32 v96, v96, v24
    v_mul_f32 v97, v97, v24
    v_cvt_pk_bf16_f32 v120, v96, v97
    v_mul_f32 v98, v98, v24
    v_mul_f32 v99, v99, v24
    v_cvt_pk_bf16_f32 v121, v98, v99
    v_mul_f32 v100, v100, v25
    v_mul_f32 v101, v101, v25
    v_cvt_pk_bf16_f32 v122, v100, v101
    v_mul_f32 v102, v102, v25
    v_mul_f32 v103, v103, v25
    v_cvt_pk_bf16_f32 v123, v102, v103
    s_nop 1
    v_mfma_f32_16x16x32_bf16 v[64:67], a[0:3], v[120:123], 0
    v_rcp_f32 v26, v116
    v_rcp_f32 v27, v117
    s_waitcnt vmcnt(11)
    v_cvt_pk_bf16_f32 v144, v144, v145
    v_cvt_pk_bf16_f32 v145, v146, v147
    v_cvt_pk_bf16_f32 v148, v148, v149
    v_cvt_pk_bf16_f32 v149, v150, v151
    v_mov_b32 v146, 0
    v_mov_b32 v147, 0
    v_cvt_pk_bf16_f32 v168, v168, v169
    v_cvt_pk_bf16_f32 v169, v170, v171
    v_and_b32 v170, v36, v168
    v_and_b32 v171, v36, v169
    v_and_b32 v168, v35, v168
    v_and_b32 v169, v35, v169
    s_waitcnt vmcnt(10)
    s_nop 0
    v_mfma_f32_16x16x32_bf16 v[104:107], v[168:171], v[184:187], v[20:23]
    v_mul_f32 v108, v108, v26
    v_mul_f32 v109, v109, v26
    v_mfma_f32_16x16x32_bf16 v[68:71], a[4:7], v[120:123], 0
    v_cvt_pk_bf16_f32 v124, v108, v109
    v_mul_f32 v110, v110, v26
    v_mfma_f32_16x16x32_bf16 v[96:99], v[144:147], v[184:187], 0
    v_mul_f32 v111, v111, v26
    v_cvt_pk_bf16_f32 v125, v110, v111
    v_mfma_f32_16x16x32_bf16 v[72:75], a[8:11], v[120:123], 0
    v_mul_f32 v112, v112, v27
    v_mul_f32 v113, v113, v27
    v_mfma_f32_16x16x32_bf16 v[100:103], v[146:149], v[184:187], 0
    v_cvt_pk_bf16_f32 v126, v112, v113
    v_mul_f32 v114, v114, v27
    v_mfma_f32_16x16x32_bf16 v[76:79], a[12:15], v[120:123], 0
    v_mul_f32 v115, v115, v27
    v_cvt_pk_bf16_f32 v127, v114, v115
    buffer_load_dwordx4 v[216:219], v1, s[36:39], s64 offen offset:2048 sc1
    s_nop 0
    v_mfma_f32_16x16x32_bf16 v[64:67], a[16:19], v[124:127], v[64:67]
    v_rcp_f32 v24, v104
    v_rcp_f32 v25, v105
    s_waitcnt vmcnt(8)
    v_cvt_pk_bf16_f32 v152, v152, v153
    v_cvt_pk_bf16_f32 v153, v154, v155
    v_cvt_pk_bf16_f32 v156, v156, v157
    v_cvt_pk_bf16_f32 v157, v158, v159
    v_mov_b32 v154, 0
    v_mov_b32 v155, 0
    v_cvt_pk_bf16_f32 v172, v172, v173
    v_cvt_pk_bf16_f32 v173, v174, v175
    v_and_b32 v174, v36, v172
    v_and_b32 v175, v36, v173
    v_and_b32 v172, v35, v172
    v_and_b32 v173, v35, v173
    s_waitcnt vmcnt(7)
    s_nop 0
    v_mfma_f32_16x16x32_bf16 v[116:119], v[172:175], v[188:191], v[20:23]
    v_mul_f32 v96, v96, v24
    v_mul_f32 v97, v97, v24
    v_mfma_f32_16x16x32_bf16 v[68:71], a[20:23], v[124:127], v[68:71]
    v_cvt_pk_bf16_f32 v120, v96, v97
    v_mul_f32 v98, v98, v24
    v_mfma_f32_16x16x32_bf16 v[108:111], v[152:155], v[188:191], 0
    v_mul_f32 v99, v99, v24
    v_cvt_pk_bf16_f32 v121, v98, v99
    v_mfma_f32_16x16x32_bf16 v[72:75], a[24:27], v[124:127], v[72:75]
    v_mul_f32 v100, v100, v25
    v_mul_f32 v101, v101, v25
    v_mfma_f32_16x16x32_bf16 v[112:115], v[154:157], v[188:191], 0
    v_cvt_pk_bf16_f32 v122, v100, v101
    v_mul_f32 v102, v102, v25
    v_mfma_f32_16x16x32_bf16 v[76:79], a[28:31], v[124:127], v[76:79]
    v_mul_f32 v103, v103, v25
    v_cvt_pk_bf16_f32 v123, v102, v103
    buffer_load_dwordx4 v[220:223], v1, s[36:39], s64 offen offset:3072 sc1
    s_nop 0
    v_mfma_f32_16x16x32_bf16 v[64:67], a[32:35], v[120:123], v[64:67]
    v_rcp_f32 v26, v116
    v_rcp_f32 v27, v117
    s_waitcnt vmcnt(7)
    v_mfma_f32_16x16x32_bf16 v[104:107], v[160:163], v[192:195], v[20:23]
    v_mul_f32 v108, v108, v26
    v_mul_f32 v109, v109, v26
    v_mfma_f32_16x16x32_bf16 v[68:71], a[36:39], v[120:123], v[68:71]
    v_cvt_pk_bf16_f32 v124, v108, v109
    v_mul_f32 v110, v110, v26
    v_mfma_f32_16x16x32_bf16 v[96:99], v[128:131], v[192:195], 0
    v_mul_f32 v111, v111, v26
    v_cvt_pk_bf16_f32 v125, v110, v111
    v_mfma_f32_16x16x32_bf16 v[72:75], a[40:43], v[120:123], v[72:75]
    v_mul_f32 v112, v112, v27
    v_mul_f32 v113, v113, v27
    v_mfma_f32_16x16x32_bf16 v[100:103], v[130:133], v[192:195], 0
    v_cvt_pk_bf16_f32 v126, v112, v113
    v_mul_f32 v114, v114, v27
    v_mfma_f32_16x16x32_bf16 v[76:79], a[44:47], v[120:123], v[76:79]
    v_mul_f32 v115, v115, v27
    v_cvt_pk_bf16_f32 v127, v114, v115
    s_lshl_b32 s64, s94, 14
    s_add_u32 s64, s64, s62
    buffer_load_dwordx4 v[224:227], v1, s[36:39], s64 offen offset:0 sc1
    v_mfma_f32_16x16x32_bf16 v[64:67], v[240:243], v[124:127], v[64:67]
    v_rcp_f32 v24, v104
    v_rcp_f32 v25, v105
    s_waitcnt vmcnt(7)
    v_mfma_f32_16x16x32_bf16 v[116:119], v[164:167], v[196:199], v[20:23]
    v_mul_f32 v96, v96, v24
    v_mul_f32 v97, v97, v24
    v_mfma_f32_16x16x32_bf16 v[68:71], v[244:247], v[124:127], v[68:71]
    v_cvt_pk_bf16_f32 v120, v96, v97
    v_mul_f32 v98, v98, v24
    v_mfma_f32_16x16x32_bf16 v[108:111], v[136:139], v[196:199], 0
    v_mul_f32 v99, v99, v24
    v_cvt_pk_bf16_f32 v121, v98, v99
    v_mfma_f32_16x16x32_bf16 v[72:75], v[248:251], v[124:127], v[72:75]
    v_mul_f32 v100, v100, v25
    v_mul_f32 v101, v101, v25
    v_mfma_f32_16x16x32_bf16 v[112:115], v[138:141], v[196:199], 0
    v_cvt_pk_bf16_f32 v122, v100, v101
    v_mul_f32 v102, v102, v25
    v_mfma_f32_16x16x32_bf16 v[76:79], v[252:255], v[124:127], v[76:79]
    v_mul_f32 v103, v103, v25
    v_cvt_pk_bf16_f32 v123, v102, v103
    buffer_load_dwordx4 v[228:231], v1, s[36:39], s64 offen offset:1024 sc1
    s_nop 0
    v_mfma_f32_16x16x32_bf16 v[80:83], a[0:3], v[120:123], 0
    v_rcp_f32 v26, v116
    v_rcp_f32 v27, v117
    s_waitcnt vmcnt(7)
    v_mfma_f32_16x16x32_bf16 v[104:107], v[168:171], v[200:203], v[20:23]
    v_mul_f32 v108, v108, v26
    v_mul_f32 v109, v109, v26
    v_mfma_f32_16x16x32_bf16 v[84:87], a[4:7], v[120:123], 0
    v_cvt_pk_bf16_f32 v124, v108, v109
    v_mul_f32 v110, v110, v26
    v_mfma_f32_16x16x32_bf16 v[96:99], v[144:147], v[200:203], 0
    v_mul_f32 v111, v111, v26
    v_cvt_pk_bf16_f32 v125, v110, v111
    v_mfma_f32_16x16x32_bf16 v[88:91], a[8:11], v[120:123], 0
    v_mul_f32 v112, v112, v27
    v_mul_f32 v113, v113, v27
    v_mfma_f32_16x16x32_bf16 v[100:103], v[146:149], v[200:203], 0
    v_cvt_pk_bf16_f32 v126, v112, v113
    v_mul_f32 v114, v114, v27
    v_mfma_f32_16x16x32_bf16 v[92:95], a[12:15], v[120:123], 0
    v_mul_f32 v115, v115, v27
    v_cvt_pk_bf16_f32 v127, v114, v115
    buffer_load_dwordx4 v[232:235], v1, s[36:39], s64 offen offset:2048 sc1
    s_nop 0
    v_mfma_f32_16x16x32_bf16 v[80:83], a[16:19], v[124:127], v[80:83]
    v_rcp_f32 v24, v104
    v_rcp_f32 v25, v105
    s_waitcnt vmcnt(7)
    v_mfma_f32_16x16x32_bf16 v[116:119], v[172:175], v[204:207], v[20:23]
    v_mul_f32 v96, v96, v24
    v_mul_f32 v97, v97, v24
    v_mfma_f32_16x16x32_bf16 v[84:87], a[20:23], v[124:127], v[84:87]
    v_cvt_pk_bf16_f32 v120, v96, v97
    v_mul_f32 v98, v98, v24
    v_mfma_f32_16x16x32_bf16 v[108:111], v[152:155], v[204:207], 0
    v_mul_f32 v99, v99, v24
    v_cvt_pk_bf16_f32 v121, v98, v99
    v_mfma_f32_16x16x32_bf16 v[88:91], a[24:27], v[124:127], v[88:91]
    v_mul_f32 v100, v100, v25
    v_mul_f32 v101, v101, v25
    v_mfma_f32_16x16x32_bf16 v[112:115], v[154:157], v[204:207], 0
    v_cvt_pk_bf16_f32 v122, v100, v101
    v_mul_f32 v102, v102, v25
    v_mfma_f32_16x16x32_bf16 v[92:95], a[28:31], v[124:127], v[92:95]
    v_mul_f32 v103, v103, v25
    v_cvt_pk_bf16_f32 v123, v102, v103
    buffer_load_dwordx4 v[236:239], v1, s[36:39], s64 offen offset:3072 sc1
    ds_write_b128 v61, v[64:67] offset:0
    ds_write_b128 v61, v[68:71] offset:1024
    v_mfma_f32_16x16x32_bf16 v[80:83], a[32:35], v[120:123], v[80:83]
    v_rcp_f32 v26, v116
    v_rcp_f32 v27, v117
    s_waitcnt vmcnt(7)
    v_mfma_f32_16x16x32_bf16 v[104:107], v[160:163], v[208:211], v[20:23]
    v_mul_f32 v108, v108, v26
    v_mul_f32 v109, v109, v26
    v_mfma_f32_16x16x32_bf16 v[84:87], a[36:39], v[120:123], v[84:87]
    v_cvt_pk_bf16_f32 v124, v108, v109
    v_mul_f32 v110, v110, v26
    v_mfma_f32_16x16x32_bf16 v[96:99], v[128:131], v[208:211], 0
    v_mul_f32 v111, v111, v26
    v_cvt_pk_bf16_f32 v125, v110, v111
    s_add_u32 m0, s58, 98304
    s_add_u32 s100, s81, 0
    buffer_load_dwordx4 v18, s[16:19], s100 offen offset:0 lds
    v_mfma_f32_16x16x32_bf16 v[88:91], a[40:43], v[120:123], v[88:91]
    v_mul_f32 v112, v112, v27
    v_mul_f32 v113, v113, v27
    v_mfma_f32_16x16x32_bf16 v[100:103], v[130:133], v[208:211], 0
    v_cvt_pk_bf16_f32 v126, v112, v113
    v_mul_f32 v114, v114, v27
    v_mfma_f32_16x16x32_bf16 v[92:95], a[44:47], v[120:123], v[92:95]
    v_mul_f32 v115, v115, v27
    v_cvt_pk_bf16_f32 v127, v114, v115
    buffer_load_dwordx4 v32, s[16:19], s100 offen offset:1024 lds
    ds_write_b128 v61, v[72:75] offset:2048
    ds_write_b128 v61, v[76:79] offset:3072
    v_mfma_f32_16x16x32_bf16 v[80:83], v[240:243], v[124:127], v[80:83]
    v_rcp_f32 v24, v104
    v_rcp_f32 v25, v105
    s_waitcnt vmcnt(8)
    v_mfma_f32_16x16x32_bf16 v[116:119], v[164:167], v[212:215], v[20:23]
    v_mul_f32 v96, v96, v24
    v_mul_f32 v97, v97, v24
    v_mfma_f32_16x16x32_bf16 v[84:87], v[244:247], v[124:127], v[84:87]
    v_cvt_pk_bf16_f32 v120, v96, v97
    v_mul_f32 v98, v98, v24
    v_mfma_f32_16x16x32_bf16 v[108:111], v[136:139], v[212:215], 0
    v_mul_f32 v99, v99, v24
    v_cvt_pk_bf16_f32 v121, v98, v99
    buffer_load_dwordx4 v33, s[16:19], s100 offen offset:2048 lds
    v_mfma_f32_16x16x32_bf16 v[88:91], v[248:251], v[124:127], v[88:91]
    v_mul_f32 v100, v100, v25
    v_mul_f32 v101, v101, v25
    v_mfma_f32_16x16x32_bf16 v[112:115], v[138:141], v[212:215], 0
    v_cvt_pk_bf16_f32 v122, v100, v101
    v_mul_f32 v102, v102, v25
    v_mfma_f32_16x16x32_bf16 v[92:95], v[252:255], v[124:127], v[92:95]
    v_mul_f32 v103, v103, v25
    v_cvt_pk_bf16_f32 v123, v102, v103
    s_add_u32 m0, s58, 131072
    s_add_u32 s100, s81, 64
    buffer_load_dwordx4 v18, s[16:19], s100 offen offset:0 lds
    v_mfma_f32_16x16x32_bf16 v[64:67], a[0:3], v[120:123], 0
    v_rcp_f32 v26, v116
    v_rcp_f32 v27, v117
    s_waitcnt vmcnt(9)
    v_mfma_f32_16x16x32_bf16 v[104:107], v[168:171], v[216:219], v[20:23]
    v_mul_f32 v108, v108, v26
    v_mul_f32 v109, v109, v26
    v_mfma_f32_16x16x32_bf16 v[68:71], a[4:7], v[120:123], 0
    v_cvt_pk_bf16_f32 v124, v108, v109
    v_mul_f32 v110, v110, v26
    v_mfma_f32_16x16x32_bf16 v[96:99], v[144:147], v[216:219], 0
    v_mul_f32 v111, v111, v26
    v_cvt_pk_bf16_f32 v125, v110, v111
    buffer_load_dwordx4 v32, s[16:19], s100 offen offset:1024 lds
    v_mfma_f32_16x16x32_bf16 v[72:75], a[8:11], v[120:123], 0
    v_mul_f32 v112, v112, v27
    v_mul_f32 v113, v113, v27
    v_mfma_f32_16x16x32_bf16 v[100:103], v[146:149], v[216:219], 0
    v_cvt_pk_bf16_f32 v126, v112, v113
    v_mul_f32 v114, v114, v27
    v_mfma_f32_16x16x32_bf16 v[76:79], a[12:15], v[120:123], 0
    v_mul_f32 v115, v115, v27
    v_cvt_pk_bf16_f32 v127, v114, v115
    buffer_load_dwordx4 v33, s[16:19], s100 offen offset:2048 lds
    s_nop 0
    v_mfma_f32_16x16x32_bf16 v[64:67], a[16:19], v[124:127], v[64:67]
    v_rcp_f32 v24, v104
    v_rcp_f32 v25, v105
    s_waitcnt vmcnt(10)
    v_mfma_f32_16x16x32_bf16 v[116:119], v[172:175], v[220:223], v[20:23]
    v_mul_f32 v96, v96, v24
    v_mul_f32 v97, v97, v24
    v_mfma_f32_16x16x32_bf16 v[68:71], a[20:23], v[124:127], v[68:71]
    v_cvt_pk_bf16_f32 v120, v96, v97
    v_mul_f32 v98, v98, v24
    v_mfma_f32_16x16x32_bf16 v[108:111], v[152:155], v[220:223], 0
    v_mul_f32 v99, v99, v24
    v_cvt_pk_bf16_f32 v121, v98, v99
    s_add_u32 m0, s58, 101376
    s_add_u32 s100, s81, 132096
    buffer_load_dwordx4 v18, s[16:19], s100 offen offset:0 lds
    v_mfma_f32_16x16x32_bf16 v[72:75], a[24:27], v[124:127], v[72:75]
    v_mul_f32 v100, v100, v25
    v_mul_f32 v101, v101, v25
    v_mfma_f32_16x16x32_bf16 v[112:115], v[154:157], v[220:223], 0
    v_cvt_pk_bf16_f32 v122, v100, v101
    v_mul_f32 v102, v102, v25
    v_mfma_f32_16x16x32_bf16 v[76:79], a[28:31], v[124:127], v[76:79]
    v_mul_f32 v103, v103, v25
    v_cvt_pk_bf16_f32 v123, v102, v103
    buffer_load_dwordx4 v32, s[16:19], s100 offen offset:1024 lds
    ds_write_b128 v61, v[80:83] offset:4096
    ds_write_b128 v61, v[84:87] offset:5120
    v_mfma_f32_16x16x32_bf16 v[64:67], a[32:35], v[120:123], v[64:67]
    v_rcp_f32 v26, v116
    v_rcp_f32 v27, v117
    s_waitcnt vmcnt(11)
    v_mfma_f32_16x16x32_bf16 v[104:107], v[160:163], v[224:227], v[20:23]
    v_mul_f32 v108, v108, v26
    v_mul_f32 v109, v109, v26
    v_mfma_f32_16x16x32_bf16 v[68:71], a[36:39], v[120:123], v[68:71]
    v_cvt_pk_bf16_f32 v124, v108, v109
    v_mul_f32 v110, v110, v26
    v_mfma_f32_16x16x32_bf16 v[96:99], v[128:131], v[224:227], 0
    v_mul_f32 v111, v111, v26
    v_cvt_pk_bf16_f32 v125, v110, v111
    buffer_load_dwordx4 v33, s[16:19], s100 offen offset:2048 lds
    v_mfma_f32_16x16x32_bf16 v[72:75], a[40:43], v[120:123], v[72:75]
    v_mul_f32 v112, v112, v27
    v_mul_f32 v113, v113, v27
    v_mfma_f32_16x16x32_bf16 v[100:103], v[130:133], v[224:227], 0
    v_cvt_pk_bf16_f32 v126, v112, v113
    v_mul_f32 v114, v114, v27
    v_mfma_f32_16x16x32_bf16 v[76:79], a[44:47], v[120:123], v[76:79]
    v_mul_f32 v115, v115, v27
    v_cvt_pk_bf16_f32 v127, v114, v115
    s_add_u32 m0, s58, 134144
    s_add_u32 s100, s81, 132160
    buffer_load_dwordx4 v18, s[16:19], s100 offen offset:0 lds
    v_lshrrev_b32 v62, 3, v0
    v_mul_u32_u24 v62, 393216, v62
    v_and_b32 v63, 7, v0
    v_lshl_add_u32 v62, v63, 7, v62
    s_add_u32 s60, s98, 0
    s_mov_b32 exec_hi, 0
    buffer_load_dword a224, v62, s[24:27], s60 offen
    s_mov_b64 exec, -1
    ds_write_b128 v61, v[88:91] offset:6144
    ds_write_b128 v61, v[92:95] offset:7168
    v_mfma_f32_16x16x32_bf16 v[64:67], v[240:243], v[124:127], v[64:67]
    v_rcp_f32 v24, v104
    v_rcp_f32 v25, v105
    s_waitcnt vmcnt(13)
    v_mfma_f32_16x16x32_bf16 v[116:119], v[164:167], v[228:231], v[20:23]
    v_mul_f32 v96, v96, v24
    v_mul_f32 v97, v97, v24
    v_mfma_f32_16x16x32_bf16 v[68:71], v[244:247], v[124:127], v[68:71]
    v_cvt_pk_bf16_f32 v120, v96, v97
    v_mul_f32 v98, v98, v24
    v_mfma_f32_16x16x32_bf16 v[108:111], v[136:139], v[228:231], 0
    v_mul_f32 v99, v99, v24
    v_cvt_pk_bf16_f32 v121, v98, v99
    buffer_load_dwordx4 v32, s[16:19], s100 offen offset:1024 lds
    v_mfma_f32_16x16x32_bf16 v[72:75], v[248:251], v[124:127], v[72:75]
    v_mul_f32 v100, v100, v25
    v_mul_f32 v101, v101, v25
    v_mfma_f32_16x16x32_bf16 v[112:115], v[138:141], v[228:231], 0
    v_cvt_pk_bf16_f32 v122, v100, v101
    v_mul_f32 v102, v102, v25
    v_mfma_f32_16x16x32_bf16 v[76:79], v[252:255], v[124:127], v[76:79]
    v_mul_f32 v103, v103, v25
    v_cvt_pk_bf16_f32 v123, v102, v103
    buffer_load_dwordx4 v33, s[16:19], s100 offen offset:2048 lds
    s_nop 0
    v_mfma_f32_16x16x32_bf16 v[80:83], a[0:3], v[120:123], v[40:43]
    v_rcp_f32 v26, v116
    v_rcp_f32 v27, v117
    s_waitcnt vmcnt(14)
    v_mfma_f32_16x16x32_bf16 v[104:107], v[168:171], v[232:235], v[20:23]
    v_mul_f32 v108, v108, v26
    v_mul_f32 v109, v109, v26
    v_mfma_f32_16x16x32_bf16 v[84:87], a[4:7], v[120:123], v[44:47]
    v_cvt_pk_bf16_f32 v124, v108, v109
    v_mul_f32 v110, v110, v26
    v_mfma_f32_16x16x32_bf16 v[96:99], v[144:147], v[232:235], 0
    v_mul_f32 v111, v111, v26
    v_cvt_pk_bf16_f32 v125, v110, v111
    s_add_u32 m0, s58, 104448
    s_add_u32 s100, s81, 264192
    buffer_load_dwordx4 v18, s[16:19], s100 offen offset:0 lds
    v_mfma_f32_16x16x32_bf16 v[88:91], a[8:11], v[120:123], v[48:51]
    v_mul_f32 v112, v112, v27
    v_mul_f32 v113, v113, v27
    v_mfma_f32_16x16x32_bf16 v[100:103], v[146:149], v[232:235], 0
    v_cvt_pk_bf16_f32 v126, v112, v113
    v_mul_f32 v114, v114, v27
    v_mfma_f32_16x16x32_bf16 v[92:95], a[12:15], v[120:123], v[52:55]
    v_mul_f32 v115, v115, v27
    v_cvt_pk_bf16_f32 v127, v114, v115
    buffer_load_dwordx4 v32, s[16:19], s100 offen offset:1024 lds
    s_nop 0
    v_mfma_f32_16x16x32_bf16 v[80:83], a[16:19], v[124:127], v[80:83]
    v_rcp_f32 v24, v104
    v_rcp_f32 v25, v105
    s_waitcnt vmcnt(15)
    v_mfma_f32_16x16x32_bf16 v[116:119], v[172:175], v[236:239], v[20:23]
    v_mul_f32 v96, v96, v24
    v_mul_f32 v97, v97, v24
    v_mfma_f32_16x16x32_bf16 v[84:87], a[20:23], v[124:127], v[84:87]
    v_cvt_pk_bf16_f32 v120, v96, v97
    v_mul_f32 v98, v98, v24
    v_mfma_f32_16x16x32_bf16 v[108:111], v[152:155], v[236:239], 0
    v_mul_f32 v99, v99, v24
    v_cvt_pk_bf16_f32 v121, v98, v99
    s_add_u32 m0, s58, 137216
    s_add_u32 s100, s81, 264256
    buffer_load_dwordx4 v18, s[16:19], s100 offen offset:0 lds
    v_mfma_f32_16x16x32_bf16 v[88:91], a[24:27], v[124:127], v[88:91]
    v_mul_f32 v100, v100, v25
    v_mul_f32 v101, v101, v25
    v_mfma_f32_16x16x32_bf16 v[112:115], v[154:157], v[236:239], 0
    v_cvt_pk_bf16_f32 v122, v100, v101
    v_mul_f32 v102, v102, v25
    v_mfma_f32_16x16x32_bf16 v[92:95], a[28:31], v[124:127], v[92:95]
    v_mul_f32 v103, v103, v25
    v_cvt_pk_bf16_f32 v123, v102, v103
    buffer_load_dwordx4 v32, s[16:19], s100 offen offset:1024 lds
    ds_write_b128 v60, v[64:67] offset:0
    ds_write_b128 v60, v[68:71] offset:1024
    v_mfma_f32_16x16x32_bf16 v[80:83], a[32:35], v[120:123], v[80:83]
    v_rcp_f32 v26, v116
    v_rcp_f32 v27, v117
    v_mul_f32 v108, v108, v26
    v_mul_f32 v109, v109, v26
    v_mfma_f32_16x16x32_bf16 v[84:87], a[36:39], v[120:123], v[84:87]
    v_cvt_pk_bf16_f32 v124, v108, v109
    v_mul_f32 v110, v110, v26
    v_mul_f32 v111, v111, v26
    v_cvt_pk_bf16_f32 v125, v110, v111
    v_mfma_f32_16x16x32_bf16 v[88:91], a[40:43], v[120:123], v[88:91]
    v_mul_f32 v112, v112, v27
    v_mul_f32 v113, v113, v27
    v_cvt_pk_bf16_f32 v126, v112, v113
    v_mfma_f32_16x16x32_bf16 v[92:95], a[44:47], v[120:123], v[92:95]
    v_mul_f32 v114, v114, v27
    v_mul_f32 v115, v115, v27
    v_cvt_pk_bf16_f32 v127, v114, v115
    ds_write_b128 v60, v[72:75] offset:2048
    ds_write_b128 v60, v[76:79] offset:3072
    v_mfma_f32_16x16x32_bf16 v[80:83], v[240:243], v[124:127], v[80:83]
    v_mfma_f32_16x16x32_bf16 v[84:87], v[244:247], v[124:127], v[84:87]
    v_mfma_f32_16x16x32_bf16 v[88:91], v[248:251], v[124:127], v[88:91]
    v_mfma_f32_16x16x32_bf16 v[92:95], v[252:255], v[124:127], v[92:95]
    s_waitcnt lgkmcnt(0)
    s_barrier
    ds_read_b128 v[96:99], v57 offset:0
    ds_read_b128 v[100:103], v57 offset:1024
    ds_read_b128 v[104:107], v57 offset:2048
    ds_read_b128 v[108:111], v57 offset:3072
    ds_read_b128 v[112:115], v58 offset:0
    ds_read_b128 v[116:119], v58 offset:1024
    ds_read_b128 v[120:123], v58 offset:2048
    ds_read_b128 v[124:127], v58 offset:3072
    ds_read_b128 v[128:131], v59 offset:0
    ds_read_b128 v[132:135], v59 offset:1024
    ds_read_b128 v[136:139], v59 offset:2048
    ds_read_b128 v[140:143], v59 offset:3072
    s_waitcnt lgkmcnt(8)
    v_pk_add_f32 v[80:81], v[80:81], v[96:97] op_sel:[0,0] op_sel_hi:[1,1]
    v_pk_add_f32 v[82:83], v[82:83], v[98:99] op_sel:[0,0] op_sel_hi:[1,1]
    v_pk_add_f32 v[84:85], v[84:85], v[100:101] op_sel:[0,0] op_sel_hi:[1,1]
    v_pk_add_f32 v[86:87], v[86:87], v[102:103] op_sel:[0,0] op_sel_hi:[1,1]
    v_pk_add_f32 v[88:89], v[88:89], v[104:105] op_sel:[0,0] op_sel_hi:[1,1]
    v_pk_add_f32 v[90:91], v[90:91], v[106:107] op_sel:[0,0] op_sel_hi:[1,1]
    v_pk_add_f32 v[92:93], v[92:93], v[108:109] op_sel:[0,0] op_sel_hi:[1,1]
    v_pk_add_f32 v[94:95], v[94:95], v[110:111] op_sel:[0,0] op_sel_hi:[1,1]
    s_waitcnt lgkmcnt(4)
    v_pk_add_f32 v[80:81], v[80:81], v[112:113] op_sel:[0,0] op_sel_hi:[1,1]
    v_pk_add_f32 v[82:83], v[82:83], v[114:115] op_sel:[0,0] op_sel_hi:[1,1]
    v_pk_add_f32 v[84:85], v[84:85], v[116:117] op_sel:[0,0] op_sel_hi:[1,1]
    v_pk_add_f32 v[86:87], v[86:87], v[118:119] op_sel:[0,0] op_sel_hi:[1,1]
    v_pk_add_f32 v[88:89], v[88:89], v[120:121] op_sel:[0,0] op_sel_hi:[1,1]
    v_pk_add_f32 v[90:91], v[90:91], v[122:123] op_sel:[0,0] op_sel_hi:[1,1]
    v_pk_add_f32 v[92:93], v[92:93], v[124:125] op_sel:[0,0] op_sel_hi:[1,1]
    v_pk_add_f32 v[94:95], v[94:95], v[126:127] op_sel:[0,0] op_sel_hi:[1,1]
    s_waitcnt lgkmcnt(0)
    v_pk_add_f32 v[80:81], v[80:81], v[128:129] op_sel:[0,0] op_sel_hi:[1,1]
    v_cvt_pk_bf16_f32 v20, v80, v81
    v_pk_add_f32 v[82:83], v[82:83], v[130:131] op_sel:[0,0] op_sel_hi:[1,1]
    v_cvt_pk_bf16_f32 v21, v82, v83
    v_pk_add_f32 v[84:85], v[84:85], v[132:133] op_sel:[0,0] op_sel_hi:[1,1]
    v_cvt_pk_bf16_f32 v22, v84, v85
    v_pk_add_f32 v[86:87], v[86:87], v[134:135] op_sel:[0,0] op_sel_hi:[1,1]
    v_cvt_pk_bf16_f32 v23, v86, v87
    buffer_store_dwordx4 v[20:23], v56, s[44:47], s89 offen sc1
    s_add_u32 s89, s89, s88
    v_pk_add_f32 v[88:89], v[88:89], v[136:137] op_sel:[0,0] op_sel_hi:[1,1]
    v_cvt_pk_bf16_f32 v24, v88, v89
    v_pk_add_f32 v[90:91], v[90:91], v[138:139] op_sel:[0,0] op_sel_hi:[1,1]
    v_cvt_pk_bf16_f32 v25, v90, v91
    v_pk_add_f32 v[92:93], v[92:93], v[140:141] op_sel:[0,0] op_sel_hi:[1,1]
    v_cvt_pk_bf16_f32 v26, v92, v93
    v_pk_add_f32 v[94:95], v[94:95], v[142:143] op_sel:[0,0] op_sel_hi:[1,1]
    v_cvt_pk_bf16_f32 v27, v94, v95
    buffer_store_dwordx4 v[24:27], v56, s[44:47], s89 offen sc1
    v_dot2_f32_bf16 v40, v20, s75, 0
    v_dot2_f32_bf16 v41, v20, v20, 0
    v_dot2_f32_bf16 v40, v21, s75, v40
    v_dot2_f32_bf16 v41, v21, v21, v41
    v_dot2_f32_bf16 v40, v22, s75, v40
    v_dot2_f32_bf16 v41, v22, v22, v41
    v_dot2_f32_bf16 v40, v23, s75, v40
    v_dot2_f32_bf16 v41, v23, v23, v41
    v_dot2_f32_bf16 v40, v24, s75, v40
    v_dot2_f32_bf16 v41, v24, v24, v41
    v_dot2_f32_bf16 v40, v25, s75, v40
    v_dot2_f32_bf16 v41, v25, v25, v41
    v_dot2_f32_bf16 v40, v26, s75, v40
    v_dot2_f32_bf16 v41, v26, v26, v41
    v_dot2_f32_bf16 v40, v27, s75, v40
    v_dot2_f32_bf16 v41, v27, v27, v41
    s_nop 1
    v_mov_b32 v42, v40
    v_mov_b32 v43, v41
    s_nop 0
    v_permlane16_swap_b32 v40, v42
    v_permlane16_swap_b32 v41, v43
    v_add_f32 v40, v40, v42
    v_add_f32 v41, v41, v43
    v_mov_b32 v42, v40
    v_mov_b32 v43, v41
    s_nop 0
    v_permlane32_swap_b32 v40, v42
    v_permlane32_swap_b32 v41, v43
    v_add_f32 v40, v40, v42
    v_add_f32 v41, v41, v43
    s_mov_b64 exec, 0xffff
    buffer_store_dwordx2 v[40:41], v29, s[36:39], s66 offen sc1
    s_mov_b64 exec, -1
    s_waitcnt vmcnt(3)
    s_barrier
    s_add_u32 m0, s58, 0
    s_add_u32 s100, s81, 64
    buffer_load_dwordx4 v18, s[20:23], s100 offen offset:0 lds
    buffer_load_dwordx4 v32, s[20:23], s100 offen offset:1024 lds
    buffer_load_dwordx4 v33, s[20:23], s100 offen offset:2048 lds
    s_add_u32 m0, s58, 65536
    s_add_u32 s100, s81, 128
    buffer_load_dwordx4 v18, s[20:23], s100 offen offset:0 lds
    buffer_load_dwordx4 v32, s[20:23], s100 offen offset:1024 lds
    buffer_load_dwordx4 v33, s[20:23], s100 offen offset:2048 lds
    s_add_u32 m0, s58, 3072
    s_add_u32 s100, s81, 132160
    buffer_load_dwordx4 v18, s[20:23], s100 offen offset:0 lds
    buffer_load_dwordx4 v32, s[20:23], s100 offen offset:1024 lds
    buffer_load_dwordx4 v33, s[20:23], s100 offen offset:2048 lds
    s_lshl_b32 s66, s54, 1
    s_add_u32 s66, s66, 98304
    s_add_u32 s65, s66, 0x2000
    s_mov_b32 s101, 50
REDO_8:
    buffer_load_dwordx4 v[64:67], v30, s[36:39], s66 offen offset:0 sc1
    buffer_load_dwordx4 v[68:71], v30, s[36:39], s66 offen offset:64 sc1
    buffer_load_dwordx4 v[72:75], v30, s[36:39], s65 offen offset:0 sc1
    buffer_load_dwordx4 v[76:79], v30, s[36:39], s65 offen offset:64 sc1
    buffer_load_dwordx4 v[96:99], v30, s[36:39], s66 offen offset:128 sc1
    buffer_load_dwordx4 v[100:103], v30, s[36:39], s66 offen offset:192 sc1
    buffer_load_dwordx4 v[104:107], v30, s[36:39], s65 offen offset:128 sc1
    buffer_load_dwordx4 v[108:111], v30, s[36:39], s65 offen offset:192 sc1
    s_mov_b32 s85, 0x0101
    s_lshl_b32 s61, s56, 10
    s_add_u32 s61, s61, s67
    s_mov_b32 s72, 20000
PST_9:
    buffer_load_dwordx2 v[48:49], v29, s[36:39], s61 offen offset:0 sc1
    buffer_load_dwordx2 v[50:51], v29, s[36:39], s61 offen offset:128 sc1
    buffer_load_dwordx2 v[52:53], v29, s[36:39], s61 offen offset:1024 sc1
    buffer_load_dwordx2 v[54:55], v29, s[36:39], s61 offen offset:1152 sc1
    s_waitcnt vmcnt(0)
    v_max3_u32 v63, v48, v50, v52
    v_max_u32 v63, v63, v54
    v_cmp_eq_u32 vcc, -1, v63
    s_nop 0
    s_cmp_eq_u64 vcc, 0
    s_cbranch_scc1 PSTD_10
    s_sub_u32 s72, s72, 1
    s_cbranch_scc0 PST_9
PSTD_10:
    v_mov_b32 v61, 0
    s_lshl_b32 s90, s56, 14
    s_add_u32 s90, s90, s74
    s_add_u32 s90, s90, 6291456
    s_mov_b32 s63, s90
    s_and_b32 s64, s53, 3
    s_lshl_b32 s64, s64, 12
    s_add_u32 s90, s63, s64
    buffer_load_dwordx4 v[128:131], v1, s[36:39], s90 offen offset:0 sc1
    buffer_load_dwordx4 v[132:135], v2, s[36:39], s90 offen offset:0 sc1
    buffer_load_dwordx4 v[136:139], v1, s[36:39], s90 offen offset:1024 sc1
    buffer_load_dwordx4 v[140:143], v2, s[36:39], s90 offen offset:1024 sc1
    buffer_load_dwordx4 v[144:147], v1, s[36:39], s90 offen offset:2048 sc1
    buffer_load_dwordx4 v[148:151], v2, s[36:39], s90 offen offset:2048 sc1
    buffer_load_dwordx4 v[152:155], v1, s[36:39], s90 offen offset:3072 sc1
    buffer_load_dwordx4 v[156:159], v2, s[36:39], s90 offen offset:3072 sc1
    s_add_u32 s64, s64, 4096
    s_and_b32 s64, s64, 0x3fff
    s_add_u32 s90, s63, s64
    buffer_load_dwordx4 v[160:163], v1, s[36:39], s90 offen offset:0 sc1
    buffer_load_dwordx4 v[164:167], v2, s[36:39], s90 offen offset:0 sc1
    buffer_load_dwordx4 v[168:171], v1, s[36:39], s90 offen offset:1024 sc1
    buffer_load_dwordx4 v[172:175], v2, s[36:39], s90 offen offset:1024 sc1
    s_mov_b32 s62, 0
    s_add_u32 s62, s62, 16777216
    s_mul_i32 s70, s56, 49152
    s_mul_i32 s61, s53, 3072
    s_add_u32 s70, s70, s61
    s_add_u32 s70, s70, s62
    s_mul_i32 s61, s48, 3072
    s_add_u32 s62, s62, s61
    s_mul_i32 s40, s91, 49152
    s_add_u32 s40, s40, s62
    s_mul_i32 s41, s92, 49152
    s_add_u32 s41, s41, s62
    s_mul_i32 s42, s93, 49152
    s_add_u32 s42, s42, s62
    s_mul_i32 s43, s94, 49152
    s_add_u32 s43, s43, s62
    s_lshl_b32 s62, s51, 14
    s_add_u32 s62, s62, 65536
    s_and_b32 s71, s56, 0xfc
    s_and_b32 s61, s53, 3
    s_add_u32 s71, s71, s61
    s_lshl_b32 s71, s71, 7
    s_and_b32 s61, s53, 12
    s_add_u32 s71, s71, s61
    s_and_b32 s61, s48, 1
    s_add_u32 s71, s71, s61
    s_add_u32 s71, s71, s62
    s_lshl_b32 s95, s94, 7
    s_add_u32 s95, s95, s62
    v_add_u32 v60, 49152, v1
    v_add_f32 v44, v48, v50
    v_add_f32 v45, v49, v51
    v_add_f32 v46, v52, v54
    v_add_f32 v47, v53, v55
    v_mov_b32 v48, v44
    v_mov_b32 v49, v45
    buffer_load_dwordx4 v[176:179], v1, s[36:39], s90 offen offset:2048 sc1
    v_mov_b32 v50, v46
    v_mov_b32 v51, v47
    v_permlane16_swap_b32 v44, v48
    v_permlane16_swap_b32 v45, v49
    v_permlane16_swap_b32 v46, v50
    v_permlane16_swap_b32 v47, v51
    buffer_load_dwordx4 v[180:183], v2, s[36:39], s90 offen offset:2048 sc1
    v_add_f32 v44, v44, v48
    v_add_f32 v45, v45, v49
    v_add_f32 v46, v46, v50
    v_add_f32 v47, v47, v51
    v_mov_b32 v48, v44
    v_mov_b32 v49, v45
    buffer_load_dwordx4 v[184:187], v1, s[36:39], s90 offen offset:3072 sc1
    v_mov_b32 v50, v46
    v_mov_b32 v51, v47
    v_permlane32_swap_b32 v44, v48
    v_permlane32_swap_b32 v45, v49
    v_permlane32_swap_b32 v46, v50
    v_permlane32_swap_b32 v47, v51
    buffer_load_dwordx4 v[188:191], v2, s[36:39], s90 offen offset:3072 sc1
    v_add_f32 v44, v44, v48
    v_add_f32 v45, v45, v49
    v_add_f32 v46, v46, v50
    v_add_f32 v47, v47, v51
    v_mul_f32 v57, 0xbb000000, v44
    v_mul_f32 v59, 0xbb000000, v46
    s_add_u32 s64, s64, 4096
    s_and_b32 s64, s64, 0x3fff
    s_add_u32 s90, s63, s64
    buffer_load_dwordx4 v[192:195], v1, s[36:39], s90 offen offset:0 sc1
    v_mul_f32 v45, 0x3b000000, v45
    v_mul_f32 v47, 0x3b000000, v47
    v_fma_f32 v45, -v57, v57, v45
    v_fma_f32 v47, -v59, v59, v47
    v_max_f32 v45, 0, v45
    v_max_f32 v47, 0, v47
    buffer_load_dwordx4 v[196:199], v2, s[36:39], s90 offen offset:0 sc1
    v_add_f32 v45, 0x3727c5ac, v45
    v_add_f32 v47, 0x3727c5ac, v47
    v_rcp_f32 v56, v45
    v_rcp_f32 v58, v47
    s_nop 0
    v_pk_mul_f32 v[80:81], v[58:59], v[64:65] op_sel:[1,0] op_sel_hi:[1,1]
    v_pk_mul_f32 v[64:65], v[56:57], v[64:65] op_sel:[1,0] op_sel_hi:[1,1]
    buffer_load_dwordx4 v[200:203], v1, s[36:39], s90 offen offset:1024 sc1
    v_pk_mul_f32 v[82:83], v[58:59], v[66:67] op_sel:[1,0] op_sel_hi:[1,1]
    v_pk_mul_f32 v[66:67], v[56:57], v[66:67] op_sel:[1,0] op_sel_hi:[1,1]
    v_pk_mul_f32 v[84:85], v[58:59], v[68:69] op_sel:[1,0] op_sel_hi:[1,1]
    v_pk_mul_f32 v[68:69], v[56:57], v[68:69] op_sel:[1,0] op_sel_hi:[1,1]
    v_pk_mul_f32 v[86:87], v[58:59], v[70:71] op_sel:[1,0] op_sel_hi:[1,1]
    v_pk_mul_f32 v[70:71], v[56:57], v[70:71] op_sel:[1,0] op_sel_hi:[1,1]
    buffer_load_dwordx4 v[204:207], v2, s[36:39], s90 offen offset:1024 sc1
    v_pk_mul_f32 v[88:89], v[58:59], v[72:73] op_sel:[1,0] op_sel_hi:[1,1]
    v_pk_mul_f32 v[72:73], v[56:57], v[72:73] op_sel:[1,0] op_sel_hi:[1,1]
    v_pk_mul_f32 v[90:91], v[58:59], v[74:75] op_sel:[1,0] op_sel_hi:[1,1]
    v_pk_mul_f32 v[74:75], v[56:57], v[74:75] op_sel:[1,0] op_sel_hi:[1,1]
    v_pk_mul_f32 v[92:93], v[58:59], v[76:77] op_sel:[1,0] op_sel_hi:[1,1]
    v_pk_mul_f32 v[76:77], v[56:57], v[76:77] op_sel:[1,0] op_sel_hi:[1,1]
    buffer_load_dwordx4 v[208:211], v1, s[36:39], s90 offen offset:2048 sc1
    v_pk_mul_f32 v[94:95], v[58:59], v[78:79] op_sel:[1,0] op_sel_hi:[1,1]
    v_pk_mul_f32 v[78:79], v[56:57], v[78:79] op_sel:[1,0] op_sel_hi:[1,1]
    ds_read_b64_tr_b16 a[0:1], v7 offset:32768
    ds_read_b64_tr_b16 a[2:3], v7 offset:33024
    ds_read_b64_tr_b16 a[4:5], v8 offset:32768
    ds_read_b64_tr_b16 a[6:7], v8 offset:33024
    ds_read_b64_tr_b16 a[8:9], v5 offset:32768
    ds_read_b64_tr_b16 a[10:11], v5 offset:33024
    ds_read_b64_tr_b16 a[12:13], v6 offset:32768
    ds_read_b64_tr_b16 a[14:15], v6 offset:33024
    ds_read_b64_tr_b16 a[16:17], v7 offset:34816
    ds_read_b64_tr_b16 a[18:19], v7 offset:35072
    ds_read_b64_tr_b16 a[20:21], v8 offset:34816
    ds_read_b64_tr_b16 a[22:23], v8 offset:35072
    ds_read_b64_tr_b16 a[24:25], v5 offset:34816
    ds_read_b64_tr_b16 a[26:27], v5 offset:35072
    ds_read_b64_tr_b16 a[28:29], v6 offset:34816
    ds_read_b64_tr_b16 a[30:31], v6 offset:35072
    s_waitcnt vmcnt(19) lgkmcnt(8)
    v_mfma_f32_16x16x32_bf16 v[64:67], a[0:3], v[128:131], v[64:67]
    ds_read_b64_tr_b16 a[32:33], v7 offset:36864
    v_mul_f32 v112, v59, v96
    v_mfma_f32_16x16x32_bf16 v[80:83], a[0:3], v[132:135], v[80:83]
    ds_read_b64_tr_b16 a[34:35], v7 offset:37120
    buffer_load_dwordx4 v[212:215], v2, s[36:39], s90 offen offset:2048 sc1
    v_mfma_f32_16x16x32_bf16 v[68:71], a[4:7], v[128:131], v[68:71]
    ds_read_b64_tr_b16 a[36:37], v8 offset:36864
    v_mul_f32 v96, v57, v96
    v_mfma_f32_16x16x32_bf16 v[84:87], a[4:7], v[132:135], v[84:87]
    ds_read_b64_tr_b16 a[38:39], v8 offset:37120
    buffer_load_dwordx4 v[216:219], v1, s[36:39], s90 offen offset:3072 sc1
    v_mfma_f32_16x16x32_bf16 v[72:75], a[8:11], v[128:131], v[72:75]
    ds_read_b64_tr_b16 a[40:41], v5 offset:36864
    v_mul_f32 v113, v59, v97
    v_mfma_f32_16x16x32_bf16 v[88:91], a[8:11], v[132:135], v[88:91]
    ds_read_b64_tr_b16 a[42:43], v5 offset:37120
    buffer_load_dwordx4 v[220:223], v2, s[36:39], s90 offen offset:3072 sc1
    v_mfma_f32_16x16x32_bf16 v[76:79], a[12:15], v[128:131], v[76:79]
    ds_read_b64_tr_b16 a[44:45], v6 offset:36864
    v_mul_f32 v97, v57, v97
    v_mfma_f32_16x16x32_bf16 v[92:95], a[12:15], v[132:135], v[92:95]
    ds_read_b64_tr_b16 a[46:47], v6 offset:37120
    s_add_u32 s64, s64, 4096
    s_and_b32 s64, s64, 0x3fff
    s_add_u32 s90, s63, s64
    buffer_load_dwordx4 v[224:227], v1, s[36:39], s90 offen offset:0 sc1
    v_max3_u32 v61, v61, v128, v132
    s_waitcnt vmcnt(21) lgkmcnt(8)
    v_mfma_f32_16x16x32_bf16 v[64:67], a[16:19], v[136:139], v[64:67]
    ds_read_b64_tr_b16 a[0:1], v7 offset:38912
    v_mul_f32 v114, v59, v98
    v_mfma_f32_16x16x32_bf16 v[80:83], a[16:19], v[140:143], v[80:83]
    ds_read_b64_tr_b16 a[2:3], v7 offset:39168
    buffer_load_dwordx4 v[228:231], v2, s[36:39], s90 offen offset:0 sc1
    v_mfma_f32_16x16x32_bf16 v[68:71], a[20:23], v[136:139], v[68:71]
    ds_read_b64_tr_b16 a[4:5], v8 offset:38912
    v_mul_f32 v98, v57, v98
    v_mfma_f32_16x16x32_bf16 v[84:87], a[20:23], v[140:143], v[84:87]
    ds_read_b64_tr_b16 a[6:7], v8 offset:39168
    buffer_load_dwordx4 v[232:235], v1, s[36:39], s90 offen offset:1024 sc1
    v_mfma_f32_16x16x32_bf16 v[72:75], a[24:27], v[136:139], v[72:75]
    ds_read_b64_tr_b16 a[8:9], v5 offset:38912
    v_mul_f32 v115, v59, v99
    v_mfma_f32_16x16x32_bf16 v[88:91], a[24:27], v[140:143], v[88:91]
    ds_read_b64_tr_b16 a[10:11], v5 offset:39168
    buffer_load_dwordx4 v[236:239], v2, s[36:39], s90 offen offset:1024 sc1
    v_mfma_f32_16x16x32_bf16 v[76:79], a[28:31], v[136:139], v[76:79]
    ds_read_b64_tr_b16 a[12:13], v6 offset:38912
    v_mul_f32 v99, v57, v99
    v_mfma_f32_16x16x32_bf16 v[92:95], a[28:31], v[140:143], v[92:95]
    ds_read_b64_tr_b16 a[14:15], v6 offset:39168
    buffer_load_dwordx4 v[240:243], v1, s[36:39], s90 offen offset:2048 sc1
    v_max3_u32 v61, v61, v136, v140
    s_waitcnt vmcnt(23) lgkmcnt(8)
    v_mfma_f32_16x16x32_bf16 v[64:67], a[32:35], v[144:147], v[64:67]
    ds_read_b64_tr_b16 a[16:17], v7 offset:40960
    v_mul_f32 v116, v59, v100
    v_mfma_f32_16x16x32_bf16 v[80:83], a[32:35], v[148:151], v[80:83]
    ds_read_b64_tr_b16 a[18:19], v7 offset:41216
    buffer_load_dwordx4 v[244:247], v2, s[36:39], s90 offen offset:2048 sc1
    v_mfma_f32_16x16x32_bf16 v[68:71], a[36:39], v[144:147], v[68:71]
    ds_read_b64_tr_b16 a[20:21], v8 offset:40960
    v_mul_f32 v100, v57, v100
    v_mfma_f32_16x16x32_bf16 v[84:87], a[36:39], v[148:151], v[84:87]
    ds_read_b64_tr_b16 a[22:23], v8 offset:41216
    buffer_load_dwordx4 v[248:251], v1, s[36:39], s90 offen offset:3072 sc1
    v_mfma_f32_16x16x32_bf16 v[72:75], a[40:43], v[144:147], v[72:75]
    ds_read_b64_tr_b16 a[24:25], v5 offset:40960
    v_mul_f32 v117, v59, v101
    v_mfma_f32_16x16x32_bf16 v[88:91], a[40:43], v[148:151], v[88:91]
    ds_read_b64_tr_b16 a[26:27], v5 offset:41216
    buffer_load_dwordx4 v[252:255], v2, s[36:39], s90 offen offset:3072 sc1
    v_mfma_f32_16x16x32_bf16 v[76:79], a[44:47], v[144:147], v[76:79]
    ds_read_b64_tr_b16 a[28:29], v6 offset:40960
    v_mul_f32 v101, v57, v101
    v_mfma_f32_16x16x32_bf16 v[92:95], a[44:47], v[148:151], v[92:95]
    ds_read_b64_tr_b16 a[30:31], v6 offset:41216
    s_add_u32 m0, s58, 68608
    s_add_u32 s100, s81, 132224
    buffer_load_dwordx4 v18, s[20:23], s100 offen offset:0 lds
    v_max3_u32 v61, v61, v144, v148
    s_waitcnt vmcnt(25) lgkmcnt(8)
    v_mfma_f32_16x16x32_bf16 v[64:67], a[0:3], v[152:155], v[64:67]
    ds_read_b64_tr_b16 a[32:33], v7 offset:43008
    v_mul_f32 v118, v59, v102
    v_mfma_f32_16x16x32_bf16 v[80:83], a[0:3], v[156:159], v[80:83]
    ds_read_b64_tr_b16 a[34:35], v7 offset:43264
    buffer_load_dwordx4 v32, s[20:23], s100 offen offset:1024 lds
    v_mfma_f32_16x16x32_bf16 v[68:71], a[4:7], v[152:155], v[68:71]
    ds_read_b64_tr_b16 a[36:37], v8 offset:43008
    v_mul_f32 v102, v57, v102
    v_mfma_f32_16x16x32_bf16 v[84:87], a[4:7], v[156:159], v[84:87]
    ds_read_b64_tr_b16 a[38:39], v8 offset:43264
    buffer_load_dwordx4 v33, s[20:23], s100 offen offset:2048 lds
    v_mfma_f32_16x16x32_bf16 v[72:75], a[8:11], v[152:155], v[72:75]
    ds_read_b64_tr_b16 a[40:41], v5 offset:43008
    v_mul_f32 v119, v59, v103
    v_mfma_f32_16x16x32_bf16 v[88:91], a[8:11], v[156:159], v[88:91]
    ds_read_b64_tr_b16 a[42:43], v5 offset:43264
    s_add_u32 m0, s58, 6144
    s_add_u32 s100, s81, 264256
    buffer_load_dwordx4 v18, s[20:23], s100 offen offset:0 lds
    v_mfma_f32_16x16x32_bf16 v[76:79], a[12:15], v[152:155], v[76:79]
    ds_read_b64_tr_b16 a[44:45], v6 offset:43008
    v_mul_f32 v103, v57, v103
    v_mfma_f32_16x16x32_bf16 v[92:95], a[12:15], v[156:159], v[92:95]
    ds_read_b64_tr_b16 a[46:47], v6 offset:43264
    buffer_load_dwordx4 v32, s[20:23], s100 offen offset:1024 lds
    v_max3_u32 v61, v61, v152, v156
    s_waitcnt vmcnt(27) lgkmcnt(8)
    v_mfma_f32_16x16x32_bf16 v[64:67], a[16:19], v[160:163], v[64:67]
    ds_read_b64_tr_b16 a[0:1], v7 offset:45056
    v_mul_f32 v120, v59, v104
    v_mfma_f32_16x16x32_bf16 v[80:83], a[16:19], v[164:167], v[80:83]
    ds_read_b64_tr_b16 a[2:3], v7 offset:45312
    s_add_u32 m0, s58, 71680
    s_add_u32 s100, s81, 264320
    buffer_load_dwordx4 v18, s[20:23], s100 offen offset:0 lds
    v_mfma_f32_16x16x32_bf16 v[68:71], a[20:23], v[160:163], v[68:71]
    ds_read_b64_tr_b16 a[4:5], v8 offset:45056
    v_mul_f32 v104, v57, v104
    v_mfma_f32_16x16x32_bf16 v[84:87], a[20:23], v[164:167], v[84:87]
    ds_read_b64_tr_b16 a[6:7], v8 offset:45312
    buffer_load_dwordx4 v32, s[20:23], s100 offen offset:1024 lds
    v_mfma_f32_16x16x32_bf16 v[72:75], a[24:27], v[160:163], v[72:75]
    ds_read_b64_tr_b16 a[8:9], v5 offset:45056
    v_mul_f32 v121, v59, v105
    v_mfma_f32_16x16x32_bf16 v[88:91], a[24:27], v[164:167], v[88:91]
    ds_read_b64_tr_b16 a[10:11], v5 offset:45312
    v_mfma_f32_16x16x32_bf16 v[76:79], a[28:31], v[160:163], v[76:79]
    ds_read_b64_tr_b16 a[12:13], v6 offset:45056
    v_mul_f32 v105, v57, v105
    v_mfma_f32_16x16x32_bf16 v[92:95], a[28:31], v[164:167], v[92:95]
    ds_read_b64_tr_b16 a[14:15], v6 offset:45312
    v_mul_f32 v122, v59, v106
    v_max3_u32 v61, v61, v160, v164
    s_waitcnt vmcnt(27) lgkmcnt(8)
    v_mfma_f32_16x16x32_bf16 v[64:67], a[32:35], v[168:171], v[64:67]
    ds_read_b64_tr_b16 a[16:17], v7 offset:47104
    v_mul_f32 v106, v57, v106
    v_mfma_f32_16x16x32_bf16 v[80:83], a[32:35], v[172:175], v[80:83]
    ds_read_b64_tr_b16 a[18:19], v7 offset:47360
    v_mul_f32 v123, v59, v107
    v_mfma_f32_16x16x32_bf16 v[68:71], a[36:39], v[168:171], v[68:71]
    ds_read_b64_tr_b16 a[20:21], v8 offset:47104
    v_mul_f32 v107, v57, v107
    v_mfma_f32_16x16x32_bf16 v[84:87], a[36:39], v[172:175], v[84:87]
    ds_read_b64_tr_b16 a[22:23], v8 offset:47360
    v_mul_f32 v124, v59, v108
    v_mfma_f32_16x16x32_bf16 v[72:75], a[40:43], v[168:171], v[72:75]
    ds_read_b64_tr_b16 a[24:25], v5 offset:47104
    v_mul_f32 v108, v57, v108
    v_mfma_f32_16x16x32_bf16 v[88:91], a[40:43], v[172:175], v[88:91]
    ds_read_b64_tr_b16 a[26:27], v5 offset:47360
    v_mul_f32 v125, v59, v109
    v_mfma_f32_16x16x32_bf16 v[76:79], a[44:47], v[168:171], v[76:79]
    ds_read_b64_tr_b16 a[28:29], v6 offset:47104
    v_mul_f32 v109, v57, v109
    v_mfma_f32_16x16x32_bf16 v[92:95], a[44:47], v[172:175], v[92:95]
    ds_read_b64_tr_b16 a[30:31], v6 offset:47360
    v_mul_f32 v126, v59, v110
    v_max3_u32 v61, v61, v168, v172
    s_waitcnt vmcnt(25) lgkmcnt(8)
    v_mfma_f32_16x16x32_bf16 v[64:67], a[0:3], v[176:179], v[64:67]
    ds_read_b64_tr_b16 a[32:33], v7 offset:49152
    v_mul_f32 v110, v57, v110
    v_mfma_f32_16x16x32_bf16 v[80:83], a[0:3], v[180:183], v[80:83]
    ds_read_b64_tr_b16 a[34:35], v7 offset:49408
    v_mul_f32 v127, v59, v111
    v_mfma_f32_16x16x32_bf16 v[68:71], a[4:7], v[176:179], v[68:71]
    ds_read_b64_tr_b16 a[36:37], v8 offset:49152
    v_mul_f32 v111, v57, v111
    v_mfma_f32_16x16x32_bf16 v[84:87], a[4:7], v[180:183], v[84:87]
    ds_read_b64_tr_b16 a[38:39], v8 offset:49408
    v_mfma_f32_16x16x32_bf16 v[72:75], a[8:11], v[176:179], v[72:75]
    ds_read_b64_tr_b16 a[40:41], v5 offset:49152
    v_mfma_f32_16x16x32_bf16 v[88:91], a[8:11], v[180:183], v[88:91]
    ds_read_b64_tr_b16 a[42:43], v5 offset:49408
    v_mfma_f32_16x16x32_bf16 v[76:79], a[12:15], v[176:179], v[76:79]
    ds_read_b64_tr_b16 a[44:45], v6 offset:49152
    v_mfma_f32_16x16x32_bf16 v[92:95], a[12:15], v[180:183], v[92:95]
    ds_read_b64_tr_b16 a[46:47], v6 offset:49408
    v_max3_u32 v61, v61, v176, v180
    s_waitcnt vmcnt(23) lgkmcnt(8)
    v_mfma_f32_16x16x32_bf16 v[64:67], a[16:19], v[184:187], v[64:67]
    ds_read_b64_tr_b16 a[0:1], v7 offset:51200
    v_mfma_f32_16x16x32_bf16 v[80:83], a[16:19], v[188:191], v[80:83]
    ds_read_b64_tr_b16 a[2:3], v7 offset:51456
    v_mfma_f32_16x16x32_bf16 v[68:71], a[20:23], v[184:187], v[68:71]
    ds_read_b64_tr_b16 a[4:5], v8 offset:51200
    v_mfma_f32_16x16x32_bf16 v[84:87], a[20:23], v[188:191], v[84:87]
    ds_read_b64_tr_b16 a[6:7], v8 offset:51456
    v_mfma_f32_16x16x32_bf16 v[72:75], a[24:27], v[184:187], v[72:75]
    ds_read_b64_tr_b16 a[8:9], v5 offset:51200
    v_mfma_f32_16x16x32_bf16 v[88:91], a[24:27], v[188:191], v[88:91]
    ds_read_b64_tr_b16 a[10:11], v5 offset:51456
    v_mfma_f32_16x16x32_bf16 v[76:79], a[28:31], v[184:187], v[76:79]
    ds_read_b64_tr_b16 a[12:13], v6 offset:51200
    v_mfma_f32_16x16x32_bf16 v[92:95], a[28:31], v[188:191], v[92:95]
    ds_read_b64_tr_b16 a[14:15], v6 offset:51456
    v_max3_u32 v61, v61, v184, v188
    s_waitcnt vmcnt(21) lgkmcnt(8)
    v_mfma_f32_16x16x32_bf16 v[64:67], a[32:35], v[192:195], v[64:67]
    ds_read_b64_tr_b16 a[16:17], v7 offset:53248
    v_mfma_f32_16x16x32_bf16 v[80:83], a[32:35], v[196:199], v[80:83]
    ds_read_b64_tr_b16 a[18:19], v7 offset:53504
    v_mfma_f32_16x16x32_bf16 v[68:71], a[36:39], v[192:195], v[68:71]
    ds_read_b64_tr_b16 a[20:21], v8 offset:53248
    v_mfma_f32_16x16x32_bf16 v[84:87], a[36:39], v[196:199], v[84:87]
    ds_read_b64_tr_b16 a[22:23], v8 offset:53504
    v_mfma_f32_16x16x32_bf16 v[72:75], a[40:43], v[192:195], v[72:75]
    ds_read_b64_tr_b16 a[24:25], v5 offset:53248
    v_mfma_f32_16x16x32_bf16 v[88:91], a[40:43], v[196:199], v[88:91]
    ds_read_b64_tr_b16 a[26:27], v5 offset:53504
    v_mfma_f32_16x16x32_bf16 v[76:79], a[44:47], v[192:195], v[76:79]
    ds_read_b64_tr_b16 a[28:29], v6 offset:53248
    v_mfma_f32_16x16x32_bf16 v[92:95], a[44:47], v[196:199], v[92:95]
    ds_read_b64_tr_b16 a[30:31], v6 offset:53504
    v_max3_u32 v61, v61, v192, v196
    s_waitcnt vmcnt(19) lgkmcnt(8)
    v_mfma_f32_16x16x32_bf16 v[64:67], a[0:3], v[200:203], v[64:67]
    ds_read_b64_tr_b16 a[32:33], v7 offset:55296
    v_mfma_f32_16x16x32_bf16 v[80:83], a[0:3], v[204:207], v[80:83]
    ds_read_b64_tr_b16 a[34:35], v7 offset:55552
    v_mfma_f32_16x16x32_bf16 v[68:71], a[4:7], v[200:203], v[68:71]
    ds_read_b64_tr_b16 a[36:37], v8 offset:55296
    v_mfma_f32_16x16x32_bf16 v[84:87], a[4:7], v[204:207], v[84:87]
    ds_read_b64_tr_b16 a[38:39], v8 offset:55552
    v_mfma_f32_16x16x32_bf16 v[72:75], a[8:11], v[200:203], v[72:75]
    ds_read_b64_tr_b16 a[40:41], v5 offset:55296
    v_mfma_f32_16x16x32_bf16 v[88:91], a[8:11], v[204:207], v[88:91]
    ds_read_b64_tr_b16 a[42:43], v5 offset:55552
    v_mfma_f32_16x16x32_bf16 v[76:79], a[12:15], v[200:203], v[76:79]
    ds_read_b64_tr_b16 a[44:45], v6 offset:55296
    v_mfma_f32_16x16x32_bf16 v[92:95], a[12:15], v[204:207], v[92:95]
    ds_read_b64_tr_b16 a[46:47], v6 offset:55552
    v_max3_u32 v61, v61, v200, v204
    v_lshrrev_b32 v62, 3, v0
    v_mul_u32_u24 v62, 393216, v62
    v_and_b32 v63, 7, v0
    v_lshl_add_u32 v62, v63, 7, v62
    s_add_u32 s60, s98, 32768
    s_mov_b32 exec_hi, 0
    buffer_load_dword a224, v62, s[24:27], s60 offen
    s_mov_b64 exec, -1
    s_waitcnt vmcnt(18) lgkmcnt(8)
    v_mfma_f32_16x16x32_bf16 v[64:67], a[16:19], v[208:211], v[64:67]
    ds_read_b64_tr_b16 a[0:1], v7 offset:57344
    v_mfma_f32_16x16x32_bf16 v[80:83], a[16:19], v[212:215], v[80:83]
    ds_read_b64_tr_b16 a[2:3], v7 offset:57600
    v_mfma_f32_16x16x32_bf16 v[68:71], a[20:23], v[208:211], v[68:71]
    ds_read_b64_tr_b16 a[4:5], v8 offset:57344
    v_mfma_f32_16x16x32_bf16 v[84:87], a[20:23], v[212:215], v[84:87]
    ds_read_b64_tr_b16 a[6:7], v8 offset:57600
    v_mfma_f32_16x16x32_bf16 v[72:75], a[24:27], v[208:211], v[72:75]
    ds_read_b64_tr_b16 a[8:9], v5 offset:57344
    v_mfma_f32_16x16x32_bf16 v[88:91], a[24:27], v[212:215], v[88:91]
    ds_read_b64_tr_b16 a[10:11], v5 offset:57600
    v_mfma_f32_16x16x32_bf16 v[76:79], a[28:31], v[208:211], v[76:79]
    ds_read_b64_tr_b16 a[12:13], v6 offset:57344
    v_mfma_f32_16x16x32_bf16 v[92:95], a[28:31], v[212:215], v[92:95]
    ds_read_b64_tr_b16 a[14:15], v6 offset:57600
    v_max3_u32 v61, v61, v208, v212
    s_waitcnt vmcnt(16) lgkmcnt(8)
    v_mfma_f32_16x16x32_bf16 v[64:67], a[32:35], v[216:219], v[64:67]
    ds_read_b64_tr_b16 a[16:17], v7 offset:59392
    v_mfma_f32_16x16x32_bf16 v[80:83], a[32:35], v[220:223], v[80:83]
    ds_read_b64_tr_b16 a[18:19], v7 offset:59648
    v_mfma_f32_16x16x32_bf16 v[68:71], a[36:39], v[216:219], v[68:71]
    ds_read_b64_tr_b16 a[20:21], v8 offset:59392
    v_mfma_f32_16x16x32_bf16 v[84:87], a[36:39], v[220:223], v[84:87]
    ds_read_b64_tr_b16 a[22:23], v8 offset:59648
    v_mfma_f32_16x16x32_bf16 v[72:75], a[40:43], v[216:219], v[72:75]
    ds_read_b64_tr_b16 a[24:25], v5 offset:59392
    v_mfma_f32_16x16x32_bf16 v[88:91], a[40:43], v[220:223], v[88:91]
    ds_read_b64_tr_b16 a[26:27], v5 offset:59648
    v_mfma_f32_16x16x32_bf16 v[76:79], a[44:47], v[216:219], v[76:79]
    ds_read_b64_tr_b16 a[28:29], v6 offset:59392
    v_mfma_f32_16x16x32_bf16 v[92:95], a[44:47], v[220:223], v[92:95]
    ds_read_b64_tr_b16 a[30:31], v6 offset:59648
    v_max3_u32 v61, v61, v216, v220
    s_waitcnt vmcnt(14) lgkmcnt(8)
    v_mfma_f32_16x16x32_bf16 v[64:67], a[0:3], v[224:227], v[64:67]
    ds_read_b64_tr_b16 a[32:33], v7 offset:61440
    v_mfma_f32_16x16x32_bf16 v[80:83], a[0:3], v[228:231], v[80:83]
    ds_read_b64_tr_b16 a[34:35], v7 offset:61696
    v_mfma_f32_16x16x32_bf16 v[68:71], a[4:7], v[224:227], v[68:71]
    ds_read_b64_tr_b16 a[36:37], v8 offset:61440
    v_mfma_f32_16x16x32_bf16 v[84:87], a[4:7], v[228:231], v[84:87]
    ds_read_b64_tr_b16 a[38:39], v8 offset:61696
    v_mfma_f32_16x16x32_bf16 v[72:75], a[8:11], v[224:227], v[72:75]
    ds_read_b64_tr_b16 a[40:41], v5 offset:61440
    v_mfma_f32_16x16x32_bf16 v[88:91], a[8:11], v[228:231], v[88:91]
    ds_read_b64_tr_b16 a[42:43], v5 offset:61696
    v_mfma_f32_16x16x32_bf16 v[76:79], a[12:15], v[224:227], v[76:79]
    ds_read_b64_tr_b16 a[44:45], v6 offset:61440
    v_mfma_f32_16x16x32_bf16 v[92:95], a[12:15], v[228:231], v[92:95]
    ds_read_b64_tr_b16 a[46:47], v6 offset:61696
    v_max3_u32 v61, v61, v224, v228
    s_waitcnt vmcnt(12) lgkmcnt(8)
    v_mfma_f32_16x16x32_bf16 v[64:67], a[16:19], v[232:235], v[64:67]
    ds_read_b64_tr_b16 a[0:1], v7 offset:63488
    v_mfma_f32_16x16x32_bf16 v[80:83], a[16:19], v[236:239], v[80:83]
    ds_read_b64_tr_b16 a[2:3], v7 offset:63744
    v_mfma_f32_16x16x32_bf16 v[68:71], a[20:23], v[232:235], v[68:71]
    ds_read_b64_tr_b16 a[4:5], v8 offset:63488
    v_mfma_f32_16x16x32_bf16 v[84:87], a[20:23], v[236:239], v[84:87]
    ds_read_b64_tr_b16 a[6:7], v8 offset:63744
    v_mfma_f32_16x16x32_bf16 v[72:75], a[24:27], v[232:235], v[72:75]
    ds_read_b64_tr_b16 a[8:9], v5 offset:63488
    v_mfma_f32_16x16x32_bf16 v[88:91], a[24:27], v[236:239], v[88:91]
    ds_read_b64_tr_b16 a[10:11], v5 offset:63744
    v_mfma_f32_16x16x32_bf16 v[76:79], a[28:31], v[232:235], v[76:79]
    ds_read_b64_tr_b16 a[12:13], v6 offset:63488
    v_mfma_f32_16x16x32_bf16 v[92:95], a[28:31], v[236:239], v[92:95]
    ds_read_b64_tr_b16 a[14:15], v6 offset:63744
    v_max3_u32 v61, v61, v232, v236
    s_waitcnt vmcnt(10) lgkmcnt(8)
    v_mfma_f32_16x16x32_bf16 v[64:67], a[32:35], v[240:243], v[64:67]
    v_mfma_f32_16x16x32_bf16 v[80:83], a[32:35], v[244:247], v[80:83]
    v_mfma_f32_16x16x32_bf16 v[68:71], a[36:39], v[240:243], v[68:71]
    v_mfma_f32_16x16x32_bf16 v[84:87], a[36:39], v[244:247], v[84:87]
    v_mfma_f32_16x16x32_bf16 v[72:75], a[40:43], v[240:243], v[72:75]
    v_mfma_f32_16x16x32_bf16 v[88:91], a[40:43], v[244:247], v[88:91]
    v_mfma_f32_16x16x32_bf16 v[76:79], a[44:47], v[240:243], v[76:79]
    v_mfma_f32_16x16x32_bf16 v[92:95], a[44:47], v[244:247], v[92:95]
    v_max3_u32 v61, v61, v240, v244
    s_waitcnt vmcnt(8) lgkmcnt(0)
    v_mfma_f32_16x16x32_bf16 v[64:67], a[0:3], v[248:251], v[64:67]
    v_mfma_f32_16x16x32_bf16 v[80:83], a[0:3], v[252:255], v[80:83]
    v_mfma_f32_16x16x32_bf16 v[68:71], a[4:7], v[248:251], v[68:71]
    v_mfma_f32_16x16x32_bf16 v[84:87], a[4:7], v[252:255], v[84:87]
    v_mfma_f32_16x16x32_bf16 v[72:75], a[8:11], v[248:251], v[72:75]
    v_mfma_f32_16x16x32_bf16 v[88:91], a[8:11], v[252:255], v[88:91]
    v_mfma_f32_16x16x32_bf16 v[76:79], a[12:15], v[248:251], v[76:79]
    v_mfma_f32_16x16x32_bf16 v[92:95], a[12:15], v[252:255], v[92:95]
    v_max3_u32 v61, v61, v248, v252
    v_cmp_eq_u32 vcc, -1, v61
    s_nop 0
    s_cmp_eq_u64 vcc, 0
    s_cbranch_scc1 REDOD_11
    s_waitcnt vmcnt(0) lgkmcnt(0)
    s_sub_u32 s101, s101, 1
    s_nop 7
    s_cbranch_scc0 REDO_8
REDOD_11:
    s_waitcnt vmcnt(1)
    s_barrier
    ds_read_b64_tr_b16 a[0:1], v9 offset:0
    ds_read_b64_tr_b16 a[2:3], v9 offset:256
    ds_read_b64_tr_b16 a[4:5], v10 offset:0
    ds_read_b64_tr_b16 a[6:7], v10 offset:256
    ds_read_b64_tr_b16 a[8:9], v5 offset:0
    ds_read_b64_tr_b16 a[10:11], v5 offset:256
    ds_read_b64_tr_b16 a[12:13], v6 offset:0
    ds_read_b64_tr_b16 a[14:15], v6 offset:256
    ds_read_b64_tr_b16 a[16:17], v9 offset:2048
    ds_read_b64_tr_b16 a[18:19], v9 offset:2304
    ds_read_b64_tr_b16 a[20:21], v10 offset:2048
    ds_read_b64_tr_b16 a[22:23], v10 offset:2304
    ds_read_b64_tr_b16 a[24:25], v5 offset:2048
    ds_read_b64_tr_b16 a[26:27], v5 offset:2304
    ds_read_b64_tr_b16 a[28:29], v6 offset:2048
    ds_read_b64_tr_b16 a[30:31], v6 offset:2304
    s_waitcnt lgkmcnt(8)
    v_mfma_f32_16x16x32_bf16 v[96:99], a[0:3], v[128:131], v[96:99]
    ds_read_b64_tr_b16 a[32:33], v9 offset:4096
    v_max_f32 v64, 0, v64
    v_max_f32 v65, 0, v65
    v_mfma_f32_16x16x32_bf16 v[112:115], a[0:3], v[132:135], v[112:115]
    ds_read_b64_tr_b16 a[34:35], v9 offset:4352
    buffer_load_dwordx4 v[40:43], v30, s[36:39], s66 offen offset:256 sc1
    v_mfma_f32_16x16x32_bf16 v[100:103], a[4:7], v[128:131], v[100:103]
    ds_read_b64_tr_b16 a[36:37], v10 offset:4096
    v_max_f32 v66, 0, v66
    v_max_f32 v67, 0, v67
    v_mfma_f32_16x16x32_bf16 v[116:119], a[4:7], v[132:135], v[116:119]
    ds_read_b64_tr_b16 a[38:39], v10 offset:4352
    v_mul_f32 v72, v56, v72
    v_mul_f32 v73, v56, v73
    v_mfma_f32_16x16x32_bf16 v[104:107], a[8:11], v[128:131], v[104:107]
    ds_read_b64_tr_b16 a[40:41], v5 offset:4096
    v_mul_f32 v74, v56, v74
    v_mul_f32 v75, v56, v75
    v_mfma_f32_16x16x32_bf16 v[120:123], a[8:11], v[132:135], v[120:123]
    ds_read_b64_tr_b16 a[42:43], v5 offset:4352
    buffer_load_dwordx4 v[44:47], v30, s[36:39], s66 offen offset:320 sc1
    v_mfma_f32_16x16x32_bf16 v[108:111], a[12:15], v[128:131], v[108:111]
    ds_read_b64_tr_b16 a[44:45], v6 offset:4096
    v_mul_f32 v64, v64, v72
    v_mul_f32 v65, v65, v73
    v_mfma_f32_16x16x32_bf16 v[124:127], a[12:15], v[132:135], v[124:127]
    ds_read_b64_tr_b16 a[46:47], v6 offset:4352
    v_mul_f32 v66, v66, v74
    v_mul_f32 v67, v67, v75
    s_waitcnt lgkmcnt(8)
    v_mfma_f32_16x16x32_bf16 v[96:99], a[16:19], v[136:139], v[96:99]
    ds_read_b64_tr_b16 a[0:1], v9 offset:6144
    v_cvt_pk_bf16_f32 v72, v64, v65
    v_cvt_pk_bf16_f32 v73, v66, v67
    v_mfma_f32_16x16x32_bf16 v[112:115], a[16:19], v[140:143], v[112:115]
    ds_read_b64_tr_b16 a[2:3], v9 offset:6400
    buffer_load_dwordx4 v[48:51], v30, s[36:39], s65 offen offset:256 sc1
    v_mfma_f32_16x16x32_bf16 v[100:103], a[20:23], v[136:139], v[100:103]
    ds_read_b64_tr_b16 a[4:5], v10 offset:6144
    v_max_f32 v68, 0, v68
    v_max_f32 v69, 0, v69
    v_mfma_f32_16x16x32_bf16 v[116:119], a[20:23], v[140:143], v[116:119]
    ds_read_b64_tr_b16 a[6:7], v10 offset:6400
    v_max_f32 v70, 0, v70
    v_max_f32 v71, 0, v71
    v_mfma_f32_16x16x32_bf16 v[104:107], a[24:27], v[136:139], v[104:107]
    ds_read_b64_tr_b16 a[8:9], v5 offset:6144
    v_mul_f32 v76, v56, v76
    v_mul_f32 v77, v56, v77
    v_mfma_f32_16x16x32_bf16 v[120:123], a[24:27], v[140:143], v[120:123]
    ds_read_b64_tr_b16 a[10:11], v5 offset:6400
    buffer_load_dwordx4 v[52:55], v30, s[36:39], s65 offen offset:320 sc1
    v_mfma_f32_16x16x32_bf16 v[108:111], a[28:31], v[136:139], v[108:111]
    ds_read_b64_tr_b16 a[12:13], v6 offset:6144
    v_mul_f32 v78, v56, v78
    v_mul_f32 v79, v56, v79
    v_mfma_f32_16x16x32_bf16 v[124:127], a[28:31], v[140:143], v[124:127]
    ds_read_b64_tr_b16 a[14:15], v6 offset:6400
    v_mul_f32 v68, v68, v76
    v_mul_f32 v69, v69, v77
    s_waitcnt lgkmcnt(8)
    v_mfma_f32_16x16x32_bf16 v[96:99], a[32:35], v[144:147], v[96:99]
    ds_read_b64_tr_b16 a[16:17], v9 offset:8192
    v_mul_f32 v70, v70, v78
    v_mul_f32 v71, v71, v79
    v_mfma_f32_16x16x32_bf16 v[112:115], a[32:35], v[148:151], v[112:115]
    ds_read_b64_tr_b16 a[18:19], v9 offset:8448
    v_mfma_f32_16x16x32_bf16 v[100:103], a[36:39], v[144:147], v[100:103]
    ds_read_b64_tr_b16 a[20:21], v10 offset:8192
    v_cvt_pk_bf16_f32 v74, v68, v69
    v_cvt_pk_bf16_f32 v75, v70, v71
    v_mfma_f32_16x16x32_bf16 v[116:119], a[36:39], v[148:151], v[116:119]
    ds_read_b64_tr_b16 a[22:23], v10 offset:8448
    buffer_store_dwordx4 v[72:75], v1, s[36:39], s70 offen offset:0 sc1
    v_max_f32 v80, 0, v80
    v_mfma_f32_16x16x32_bf16 v[104:107], a[40:43], v[144:147], v[104:107]
    ds_read_b64_tr_b16 a[24:25], v5 offset:8192
    v_max_f32 v81, 0, v81
    v_max_f32 v82, 0, v82
    v_mfma_f32_16x16x32_bf16 v[120:123], a[40:43], v[148:151], v[120:123]
    ds_read_b64_tr_b16 a[26:27], v5 offset:8448
    s_add_u32 m0, s58, 98304
    s_add_u32 s100, s81, 128
    buffer_load_dwordx4 v18, s[16:19], s100 offen offset:0 lds
    v_mfma_f32_16x16x32_bf16 v[108:111], a[44:47], v[144:147], v[108:111]
    ds_read_b64_tr_b16 a[28:29], v6 offset:8192
    v_max_f32 v83, 0, v83
    v_mul_f32 v88, v58, v88
    v_mfma_f32_16x16x32_bf16 v[124:127], a[44:47], v[148:151], v[124:127]
    ds_read_b64_tr_b16 a[30:31], v6 offset:8448
    v_mul_f32 v89, v58, v89
    v_mul_f32 v90, v58, v90
    s_waitcnt lgkmcnt(8)
    v_mfma_f32_16x16x32_bf16 v[96:99], a[0:3], v[152:155], v[96:99]
    ds_read_b64_tr_b16 a[32:33], v9 offset:10240
    v_mul_f32 v91, v58, v91
    v_mul_f32 v80, v80, v88
    v_mfma_f32_16x16x32_bf16 v[112:115], a[0:3], v[156:159], v[112:115]
    ds_read_b64_tr_b16 a[34:35], v9 offset:10496
    buffer_load_dwordx4 v32, s[16:19], s100 offen offset:1024 lds
    v_mfma_f32_16x16x32_bf16 v[100:103], a[4:7], v[152:155], v[100:103]
    ds_read_b64_tr_b16 a[36:37], v10 offset:10240
    v_mul_f32 v81, v81, v89
    v_mul_f32 v82, v82, v90
    v_mfma_f32_16x16x32_bf16 v[116:119], a[4:7], v[156:159], v[116:119]
    ds_read_b64_tr_b16 a[38:39], v10 offset:10496
    v_mul_f32 v83, v83, v91
    v_cvt_pk_bf16_f32 v88, v80, v81
    v_mfma_f32_16x16x32_bf16 v[104:107], a[8:11], v[152:155], v[104:107]
    ds_read_b64_tr_b16 a[40:41], v5 offset:10240
    v_cvt_pk_bf16_f32 v89, v82, v83
    v_max_f32 v84, 0, v84
    v_mfma_f32_16x16x32_bf16 v[120:123], a[8:11], v[156:159], v[120:123]
    ds_read_b64_tr_b16 a[42:43], v5 offset:10496
    buffer_load_dwordx4 v33, s[16:19], s100 offen offset:2048 lds
    v_mfma_f32_16x16x32_bf16 v[108:111], a[12:15], v[152:155], v[108:111]
    ds_read_b64_tr_b16 a[44:45], v6 offset:10240
    v_max_f32 v85, 0, v85
    v_max_f32 v86, 0, v86
    v_mfma_f32_16x16x32_bf16 v[124:127], a[12:15], v[156:159], v[124:127]
    ds_read_b64_tr_b16 a[46:47], v6 offset:10496
    v_max_f32 v87, 0, v87
    v_mul_f32 v92, v58, v92
    s_waitcnt lgkmcnt(8)
    v_mfma_f32_16x16x32_bf16 v[96:99], a[16:19], v[160:163], v[96:99]
    ds_read_b64_tr_b16 a[0:1], v9 offset:12288
    v_mul_f32 v93, v58, v93
    v_mul_f32 v94, v58, v94
    v_mfma_f32_16x16x32_bf16 v[112:115], a[16:19], v[164:167], v[112:115]
    ds_read_b64_tr_b16 a[2:3], v9 offset:12544
    s_add_u32 m0, s58, 101376
    s_add_u32 s100, s81, 132224
    buffer_load_dwordx4 v18, s[16:19], s100 offen offset:0 lds
    v_mfma_f32_16x16x32_bf16 v[100:103], a[20:23], v[160:163], v[100:103]
    ds_read_b64_tr_b16 a[4:5], v10 offset:12288
    v_mul_f32 v95, v58, v95
    v_mul_f32 v84, v84, v92
    v_mfma_f32_16x16x32_bf16 v[116:119], a[20:23], v[164:167], v[116:119]
    ds_read_b64_tr_b16 a[6:7], v10 offset:12544
    v_mul_f32 v85, v85, v93
    v_mul_f32 v86, v86, v94
    v_mfma_f32_16x16x32_bf16 v[104:107], a[24:27], v[160:163], v[104:107]
    ds_read_b64_tr_b16 a[8:9], v5 offset:12288
    v_mul_f32 v87, v87, v95
    v_cvt_pk_bf16_f32 v90, v84, v85
    v_mfma_f32_16x16x32_bf16 v[120:123], a[24:27], v[164:167], v[120:123]
    ds_read_b64_tr_b16 a[10:11], v5 offset:12544
    buffer_load_dwordx4 v32, s[16:19], s100 offen offset:1024 lds
    v_mfma_f32_16x16x32_bf16 v[108:111], a[28:31], v[160:163], v[108:111]
    ds_read_b64_tr_b16 a[12:13], v6 offset:12288
    v_cvt_pk_bf16_f32 v91, v86, v87
    buffer_store_dwordx4 v[88:91], v60, s[36:39], s70 offen offset:0 sc1
    v_mfma_f32_16x16x32_bf16 v[124:127], a[28:31], v[164:167], v[124:127]
    ds_read_b64_tr_b16 a[14:15], v6 offset:12544
    s_waitcnt vmcnt(7)
    s_waitcnt lgkmcnt(8)
    v_mfma_f32_16x16x32_bf16 v[96:99], a[32:35], v[168:171], v[96:99]
    ds_read_b64_tr_b16 a[16:17], v9 offset:14336
    v_mul_f32 v80, v59, v40
    v_mul_f32 v64, v57, v40
    v_mfma_f32_16x16x32_bf16 v[112:115], a[32:35], v[172:175], v[112:115]
    ds_read_b64_tr_b16 a[18:19], v9 offset:14592
    buffer_load_dwordx4 v33, s[16:19], s100 offen offset:2048 lds
    v_mfma_f32_16x16x32_bf16 v[100:103], a[36:39], v[168:171], v[100:103]
    ds_read_b64_tr_b16 a[20:21], v10 offset:14336
    v_mul_f32 v81, v59, v41
    v_mul_f32 v65, v57, v41
    v_mfma_f32_16x16x32_bf16 v[116:119], a[36:39], v[172:175], v[116:119]
    ds_read_b64_tr_b16 a[22:23], v10 offset:14592
    v_mul_f32 v82, v59, v42
    v_mul_f32 v66, v57, v42
    v_mfma_f32_16x16x32_bf16 v[104:107], a[40:43], v[168:171], v[104:107]
    ds_read_b64_tr_b16 a[24:25], v5 offset:14336
    v_mul_f32 v83, v59, v43
    v_mul_f32 v67, v57, v43
    v_mfma_f32_16x16x32_bf16 v[120:123], a[40:43], v[172:175], v[120:123]
    ds_read_b64_tr_b16 a[26:27], v5 offset:14592
    s_add_u32 m0, s58, 104448
    s_add_u32 s100, s81, 264320
    buffer_load_dwordx4 v18, s[16:19], s100 offen offset:0 lds
    v_mfma_f32_16x16x32_bf16 v[108:111], a[44:47], v[168:171], v[108:111]
    ds_read_b64_tr_b16 a[28:29], v6 offset:14336
    v_mul_f32 v84, v59, v44
    v_mul_f32 v68, v57, v44
    v_mfma_f32_16x16x32_bf16 v[124:127], a[44:47], v[172:175], v[124:127]
    ds_read_b64_tr_b16 a[30:31], v6 offset:14592
    v_mul_f32 v85, v59, v45
    v_mul_f32 v69, v57, v45
    s_waitcnt lgkmcnt(8)
    v_mfma_f32_16x16x32_bf16 v[96:99], a[0:3], v[176:179], v[96:99]
    ds_read_b64_tr_b16 a[32:33], v9 offset:16384
    v_mul_f32 v86, v59, v46
    v_mul_f32 v70, v57, v46
    v_mfma_f32_16x16x32_bf16 v[112:115], a[0:3], v[180:183], v[112:115]
    ds_read_b64_tr_b16 a[34:35], v9 offset:16640
    buffer_load_dwordx4 v32, s[16:19], s100 offen offset:1024 lds
    v_mfma_f32_16x16x32_bf16 v[100:103], a[4:7], v[176:179], v[100:103]
    ds_read_b64_tr_b16 a[36:37], v10 offset:16384
    v_mul_f32 v87, v59, v47
    v_mul_f32 v71, v57, v47
    v_mfma_f32_16x16x32_bf16 v[116:119], a[4:7], v[180:183], v[116:119]
    ds_read_b64_tr_b16 a[38:39], v10 offset:16640
    v_mul_f32 v88, v59, v48
    v_mul_f32 v72, v57, v48
    v_mfma_f32_16x16x32_bf16 v[104:107], a[8:11], v[176:179], v[104:107]
    ds_read_b64_tr_b16 a[40:41], v5 offset:16384
    v_mul_f32 v89, v59, v49
    v_mul_f32 v73, v57, v49
    v_mfma_f32_16x16x32_bf16 v[120:123], a[8:11], v[180:183], v[120:123]
    ds_read_b64_tr_b16 a[42:43], v5 offset:16640
    v_mfma_f32_16x16x32_bf16 v[108:111], a[12:15], v[176:179], v[108:111]
    ds_read_b64_tr_b16 a[44:45], v6 offset:16384
    v_mul_f32 v90, v59, v50
    v_mul_f32 v74, v57, v50
    v_mfma_f32_16x16x32_bf16 v[124:127], a[12:15], v[180:183], v[124:127]
    ds_read_b64_tr_b16 a[46:47], v6 offset:16640
    v_mul_f32 v91, v59, v51
    v_mul_f32 v75, v57, v51
    s_waitcnt lgkmcnt(8)
    v_mfma_f32_16x16x32_bf16 v[96:99], a[16:19], v[184:187], v[96:99]
    ds_read_b64_tr_b16 a[0:1], v9 offset:18432
    v_mul_f32 v92, v59, v52
    v_mul_f32 v76, v57, v52
    v_mfma_f32_16x16x32_bf16 v[112:115], a[16:19], v[188:191], v[112:115]
    ds_read_b64_tr_b16 a[2:3], v9 offset:18688
    s_add_u32 m0, s58, 32768
    s_add_u32 s100, s83, 0
    buffer_load_dwordx4 v19, s[24:27], s100 offen offset:0 lds
    v_mfma_f32_16x16x32_bf16 v[100:103], a[20:23], v[184:187], v[100:103]
    ds_read_b64_tr_b16 a[4:5], v10 offset:18432
    v_mul_f32 v93, v59, v53
    v_mul_f32 v77, v57, v53
    v_mfma_f32_16x16x32_bf16 v[116:119], a[20:23], v[188:191], v[116:119]
    ds_read_b64_tr_b16 a[6:7], v10 offset:18688
    v_mul_f32 v94, v59, v54
    v_mul_f32 v78, v57, v54
    v_mfma_f32_16x16x32_bf16 v[104:107], a[24:27], v[184:187], v[104:107]
    ds_read_b64_tr_b16 a[8:9], v5 offset:18432
    v_mul_f32 v95, v59, v55
    v_mul_f32 v79, v57, v55
    v_mfma_f32_16x16x32_bf16 v[120:123], a[24:27], v[188:191], v[120:123]
    ds_read_b64_tr_b16 a[10:11], v5 offset:18688
    buffer_load_dwordx4 v19, s[24:27], s100 offen offset:1024 lds
    v_mfma_f32_16x16x32_bf16 v[108:111], a[28:31], v[184:187], v[108:111]
    ds_read_b64_tr_b16 a[12:13], v6 offset:18432
    v_mfma_f32_16x16x32_bf16 v[124:127], a[28:31], v[188:191], v[124:127]
    ds_read_b64_tr_b16 a[14:15], v6 offset:18688
    s_waitcnt lgkmcnt(8)
    v_mfma_f32_16x16x32_bf16 v[96:99], a[32:35], v[192:195], v[96:99]
    ds_read_b64_tr_b16 a[16:17], v9 offset:20480
    v_mfma_f32_16x16x32_bf16 v[112:115], a[32:35], v[196:199], v[112:115]
    ds_read_b64_tr_b16 a[18:19], v9 offset:20736
    buffer_load_dwordx4 v19, s[24:27], s100 offen offset:2048 lds
    v_mfma_f32_16x16x32_bf16 v[100:103], a[36:39], v[192:195], v[100:103]
    ds_read_b64_tr_b16 a[20:21], v10 offset:20480
    v_mfma_f32_16x16x32_bf16 v[116:119], a[36:39], v[196:199], v[116:119]
    ds_read_b64_tr_b16 a[22:23], v10 offset:20736
    v_mfma_f32_16x16x32_bf16 v[104:107], a[40:43], v[192:195], v[104:107]
    ds_read_b64_tr_b16 a[24:25], v5 offset:20480
    v_mfma_f32_16x16x32_bf16 v[120:123], a[40:43], v[196:199], v[120:123]
    ds_read_b64_tr_b16 a[26:27], v5 offset:20736
    buffer_load_dwordx4 v19, s[24:27], s100 offen offset:3072 lds
    v_mfma_f32_16x16x32_bf16 v[108:111], a[44:47], v[192:195], v[108:111]
    ds_read_b64_tr_b16 a[28:29], v6 offset:20480
    v_mfma_f32_16x16x32_bf16 v[124:127], a[44:47], v[196:199], v[124:127]
    ds_read_b64_tr_b16 a[30:31], v6 offset:20736
    s_waitcnt lgkmcnt(8)
    v_mfma_f32_16x16x32_bf16 v[96:99], a[0:3], v[200:203], v[96:99]
    ds_read_b64_tr_b16 a[32:33], v9 offset:22528
    v_mfma_f32_16x16x32_bf16 v[112:115], a[0:3], v[204:207], v[112:115]
    ds_read_b64_tr_b16 a[34:35], v9 offset:22784
    s_add_u32 m0, s58, 36864
    s_add_u32 s100, s83, 393216
    buffer_load_dwordx4 v19, s[24:27], s100 offen offset:0 lds
    v_mfma_f32_16x16x32_bf16 v[100:103], a[4:7], v[200:203], v[100:103]
    ds_read_b64_tr_b16 a[36:37], v10 offset:22528
    v_mfma_f32_16x16x32_bf16 v[116:119], a[4:7], v[204:207], v[116:119]
    ds_read_b64_tr_b16 a[38:39], v10 offset:22784
    v_mfma_f32_16x16x32_bf16 v[104:107], a[8:11], v[200:203], v[104:107]
    ds_read_b64_tr_b16 a[40:41], v5 offset:22528
    v_mfma_f32_16x16x32_bf16 v[120:123], a[8:11], v[204:207], v[120:123]
    ds_read_b64_tr_b16 a[42:43], v5 offset:22784
    buffer_load_dwordx4 v19, s[24:27], s100 offen offset:1024 lds
    v_mfma_f32_16x16x32_bf16 v[108:111], a[12:15], v[200:203], v[108:111]
    ds_read_b64_tr_b16 a[44:45], v6 offset:22528
    v_mfma_f32_16x16x32_bf16 v[124:127], a[12:15], v[204:207], v[124:127]
    ds_read_b64_tr_b16 a[46:47], v6 offset:22784
    s_waitcnt lgkmcnt(8)
    v_mfma_f32_16x16x32_bf16 v[96:99], a[16:19], v[208:211], v[96:99]
    ds_read_b64_tr_b16 a[0:1], v9 offset:24576
    v_mfma_f32_16x16x32_bf16 v[112:115], a[16:19], v[212:215], v[112:115]
    ds_read_b64_tr_b16 a[2:3], v9 offset:24832
    buffer_load_dwordx4 v19, s[24:27], s100 offen offset:2048 lds
    v_mfma_f32_16x16x32_bf16 v[100:103], a[20:23], v[208:211], v[100:103]
    ds_read_b64_tr_b16 a[4:5], v10 offset:24576
    v_mfma_f32_16x16x32_bf16 v[116:119], a[20:23], v[212:215], v[116:119]
    ds_read_b64_tr_b16 a[6:7], v10 offset:24832
    v_mfma_f32_16x16x32_bf16 v[104:107], a[24:27], v[208:211], v[104:107]
    ds_read_b64_tr_b16 a[8:9], v5 offset:24576
    v_mfma_f32_16x16x32_bf16 v[120:123], a[24:27], v[212:215], v[120:123]
    ds_read_b64_tr_b16 a[10:11], v5 offset:24832
    buffer_load_dwordx4 v19, s[24:27], s100 offen offset:3072 lds
    v_mfma_f32_16x16x32_bf16 v[108:111], a[28:31], v[208:211], v[108:111]
    ds_read_b64_tr_b16 a[12:13], v6 offset:24576
    v_mfma_f32_16x16x32_bf16 v[124:127], a[28:31], v[212:215], v[124:127]
    ds_read_b64_tr_b16 a[14:15], v6 offset:24832
    s_waitcnt vmcnt(11)
    v_mov_b32 v62, 0
    v_mov_b32 v63, 1
    s_mov_b64 exec, 1
    buffer_store_byte v63, v62, s[36:39], s71 offen offset:0 sc1
    s_mov_b64 exec, -1
    s_waitcnt lgkmcnt(8)
    v_mfma_f32_16x16x32_bf16 v[96:99], a[32:35], v[216:219], v[96:99]
    ds_read_b64_tr_b16 a[16:17], v9 offset:26624
    v_mfma_f32_16x16x32_bf16 v[112:115], a[32:35], v[220:223], v[112:115]
    ds_read_b64_tr_b16 a[18:19], v9 offset:26880
    v_mfma_f32_16x16x32_bf16 v[100:103], a[36:39], v[216:219], v[100:103]
    ds_read_b64_tr_b16 a[20:21], v10 offset:26624
    v_mfma_f32_16x16x32_bf16 v[116:119], a[36:39], v[220:223], v[116:119]
    ds_read_b64_tr_b16 a[22:23], v10 offset:26880
    v_mfma_f32_16x16x32_bf16 v[104:107], a[40:43], v[216:219], v[104:107]
    ds_read_b64_tr_b16 a[24:25], v5 offset:26624
    v_mfma_f32_16x16x32_bf16 v[120:123], a[40:43], v[220:223], v[120:123]
    ds_read_b64_tr_b16 a[26:27], v5 offset:26880
    v_mfma_f32_16x16x32_bf16 v[108:111], a[44:47], v[216:219], v[108:111]
    ds_read_b64_tr_b16 a[28:29], v6 offset:26624
    v_mfma_f32_16x16x32_bf16 v[124:127], a[44:47], v[220:223], v[124:127]
    ds_read_b64_tr_b16 a[30:31], v6 offset:26880
    v_lshrrev_b32 v62, 3, v0
    v_mul_u32_u24 v62, 393216, v62
    v_and_b32 v63, 7, v0
    v_lshl_add_u32 v62, v63, 7, v62
    s_add_u32 s60, s98, 65536
    s_mov_b32 exec_hi, 0
    buffer_load_dword a224, v62, s[24:27], s60 offen
    s_mov_b64 exec, -1
    s_waitcnt lgkmcnt(8)
    v_mfma_f32_16x16x32_bf16 v[96:99], a[0:3], v[224:227], v[96:99]
    ds_read_b64_tr_b16 a[32:33], v9 offset:28672
    v_mfma_f32_16x16x32_bf16 v[112:115], a[0:3], v[228:231], v[112:115]
    ds_read_b64_tr_b16 a[34:35], v9 offset:28928
    v_mfma_f32_16x16x32_bf16 v[100:103], a[4:7], v[224:227], v[100:103]
    ds_read_b64_tr_b16 a[36:37], v10 offset:28672
    v_mfma_f32_16x16x32_bf16 v[116:119], a[4:7], v[228:231], v[116:119]
    ds_read_b64_tr_b16 a[38:39], v10 offset:28928
    v_mfma_f32_16x16x32_bf16 v[104:107], a[8:11], v[224:227], v[104:107]
    ds_read_b64_tr_b16 a[40:41], v5 offset:28672
    v_mfma_f32_16x16x32_bf16 v[120:123], a[8:11], v[228:231], v[120:123]
    ds_read_b64_tr_b16 a[42:43], v5 offset:28928
    v_mfma_f32_16x16x32_bf16 v[108:111], a[12:15], v[224:227], v[108:111]
    ds_read_b64_tr_b16 a[44:45], v6 offset:28672
    v_mfma_f32_16x16x32_bf16 v[124:127], a[12:15], v[228:231], v[124:127]
    ds_read_b64_tr_b16 a[46:47], v6 offset:28928
    s_waitcnt lgkmcnt(8)
    v_mfma_f32_16x16x32_bf16 v[96:99], a[16:19], v[232:235], v[96:99]
    ds_read_b64_tr_b16 a[0:1], v9 offset:30720
    v_mfma_f32_16x16x32_bf16 v[112:115], a[16:19], v[236:239], v[112:115]
    ds_read_b64_tr_b16 a[2:3], v9 offset:30976
    v_mfma_f32_16x16x32_bf16 v[100:103], a[20:23], v[232:235], v[100:103]
    ds_read_b64_tr_b16 a[4:5], v10 offset:30720
    v_mfma_f32_16x16x32_bf16 v[116:119], a[20:23], v[236:239], v[116:119]
    ds_read_b64_tr_b16 a[6:7], v10 offset:30976
    v_mfma_f32_16x16x32_bf16 v[104:107], a[24:27], v[232:235], v[104:107]
    ds_read_b64_tr_b16 a[8:9], v5 offset:30720
    v_mfma_f32_16x16x32_bf16 v[120:123], a[24:27], v[236:239], v[120:123]
    ds_read_b64_tr_b16 a[10:11], v5 offset:30976
    v_mfma_f32_16x16x32_bf16 v[108:111], a[28:31], v[232:235], v[108:111]
    ds_read_b64_tr_b16 a[12:13], v6 offset:30720
    v_mfma_f32_16x16x32_bf16 v[124:127], a[28:31], v[236:239], v[124:127]
    ds_read_b64_tr_b16 a[14:15], v6 offset:30976
    s_waitcnt lgkmcnt(8)
    v_mfma_f32_16x16x32_bf16 v[96:99], a[32:35], v[240:243], v[96:99]
    v_mfma_f32_16x16x32_bf16 v[112:115], a[32:35], v[244:247], v[112:115]
    v_mfma_f32_16x16x32_bf16 v[100:103], a[36:39], v[240:243], v[100:103]
    v_mfma_f32_16x16x32_bf16 v[116:119], a[36:39], v[244:247], v[116:119]
    v_mfma_f32_16x16x32_bf16 v[104:107], a[40:43], v[240:243], v[104:107]
    v_mfma_f32_16x16x32_bf16 v[120:123], a[40:43], v[244:247], v[120:123]
    v_mfma_f32_16x16x32_bf16 v[108:111], a[44:47], v[240:243], v[108:111]
    v_mfma_f32_16x16x32_bf16 v[124:127], a[44:47], v[244:247], v[124:127]
    s_waitcnt lgkmcnt(0)
    v_mfma_f32_16x16x32_bf16 v[96:99], a[0:3], v[248:251], v[96:99]
    v_mfma_f32_16x16x32_bf16 v[112:115], a[0:3], v[252:255], v[112:115]
    v_mfma_f32_16x16x32_bf16 v[100:103], a[4:7], v[248:251], v[100:103]
    v_mfma_f32_16x16x32_bf16 v[116:119], a[4:7], v[252:255], v[116:119]
    v_mfma_f32_16x16x32_bf16 v[104:107], a[8:11], v[248:251], v[104:107]
    v_mfma_f32_16x16x32_bf16 v[120:123], a[8:11], v[252:255], v[120:123]
    v_mfma_f32_16x16x32_bf16 v[108:111], a[12:15], v[248:251], v[108:111]
    v_mfma_f32_16x16x32_bf16 v[124:127], a[12:15], v[252:255], v[124:127]
    s_waitcnt vmcnt(10)
    s_barrier
    ds_read_b64_tr_b16 a[0:1], v7 offset:32768
    ds_read_b64_tr_b16 a[2:3], v7 offset:33024
    ds_read_b64_tr_b16 a[4:5], v8 offset:32768
    ds_read_b64_tr_b16 a[6:7], v8 offset:33024
    ds_read_b64_tr_b16 a[8:9], v7 offset:0
    ds_read_b64_tr_b16 a[10:11], v7 offset:256
    ds_read_b64_tr_b16 a[12:13], v8 offset:0
    ds_read_b64_tr_b16 a[14:15], v8 offset:256
    ds_read_b64_tr_b16 a[16:17], v7 offset:34816
    ds_read_b64_tr_b16 a[18:19], v7 offset:35072
    ds_read_b64_tr_b16 a[20:21], v8 offset:34816
    ds_read_b64_tr_b16 a[22:23], v8 offset:35072
    ds_read_b64_tr_b16 a[24:25], v7 offset:2048
    ds_read_b64_tr_b16 a[26:27], v7 offset:2304
    ds_read_b64_tr_b16 a[28:29], v8 offset:2048
    ds_read_b64_tr_b16 a[30:31], v8 offset:2304
    s_waitcnt lgkmcnt(8)
    v_mfma_f32_16x16x32_bf16 v[64:67], a[0:3], v[128:131], v[64:67]
    ds_read_b64_tr_b16 a[32:33], v7 offset:36864
    v_max_f32 v96, 0, v96
    v_max_f32 v97, 0, v97
    v_mfma_f32_16x16x32_bf16 v[80:83], a[0:3], v[132:135], v[80:83]
    ds_read_b64_tr_b16 a[34:35], v7 offset:37120
    s_add_u32 m0, s58, 131072
    s_add_u32 s100, s83, 786432
    buffer_load_dwordx4 v19, s[24:27], s100 offen offset:0 lds
    v_mfma_f32_16x16x32_bf16 v[68:71], a[4:7], v[128:131], v[68:71]
    ds_read_b64_tr_b16 a[36:37], v8 offset:36864
    v_max_f32 v98, 0, v98
    v_max_f32 v99, 0, v99
    v_mfma_f32_16x16x32_bf16 v[84:87], a[4:7], v[132:135], v[84:87]
    ds_read_b64_tr_b16 a[38:39], v8 offset:37120
    v_mul_f32 v104, v56, v104
    v_mul_f32 v105, v56, v105
    v_mfma_f32_16x16x32_bf16 v[72:75], a[8:11], v[128:131], v[72:75]
    ds_read_b64_tr_b16 a[40:41], v7 offset:4096
    buffer_load_dwordx4 v19, s[24:27], s100 offen offset:1024 lds
    v_mfma_f32_16x16x32_bf16 v[88:91], a[8:11], v[132:135], v[88:91]
    ds_read_b64_tr_b16 a[42:43], v7 offset:4352
    v_mul_f32 v106, v56, v106
    v_mul_f32 v107, v56, v107
    v_mfma_f32_16x16x32_bf16 v[76:79], a[12:15], v[128:131], v[76:79]
    ds_read_b64_tr_b16 a[44:45], v8 offset:4096
    buffer_load_dwordx4 v19, s[24:27], s100 offen offset:2048 lds
    v_mfma_f32_16x16x32_bf16 v[92:95], a[12:15], v[132:135], v[92:95]
    ds_read_b64_tr_b16 a[46:47], v8 offset:4352
    v_mul_f32 v96, v96, v104
    v_mul_f32 v97, v97, v105
    s_waitcnt lgkmcnt(8)
    v_mfma_f32_16x16x32_bf16 v[64:67], a[16:19], v[136:139], v[64:67]
    ds_read_b64_tr_b16 a[0:1], v7 offset:38912
    v_mul_f32 v98, v98, v106
    v_mul_f32 v99, v99, v107
    v_mfma_f32_16x16x32_bf16 v[80:83], a[16:19], v[140:143], v[80:83]
    ds_read_b64_tr_b16 a[2:3], v7 offset:39168
    buffer_load_dwordx4 v19, s[24:27], s100 offen offset:3072 lds
    v_mfma_f32_16x16x32_bf16 v[68:71], a[20:23], v[136:139], v[68:71]
    ds_read_b64_tr_b16 a[4:5], v8 offset:38912
    v_cvt_pk_bf16_f32 v104, v96, v97
    v_cvt_pk_bf16_f32 v105, v98, v99
    v_mfma_f32_16x16x32_bf16 v[84:87], a[20:23], v[140:143], v[84:87]
    ds_read_b64_tr_b16 a[6:7], v8 offset:39168
    v_max_f32 v100, 0, v100
    v_max_f32 v101, 0, v101
    v_mfma_f32_16x16x32_bf16 v[72:75], a[24:27], v[136:139], v[72:75]
    ds_read_b64_tr_b16 a[8:9], v7 offset:6144
    s_add_u32 m0, s58, 135168
    s_add_u32 s100, s50, 1179648
    buffer_load_dwordx4 v19, s[24:27], s100 offen offset:0 lds
    v_mfma_f32_16x16x32_bf16 v[88:91], a[24:27], v[140:143], v[88:91]
    ds_read_b64_tr_b16 a[10:11], v7 offset:6400
    v_max_f32 v102, 0, v102
    v_max_f32 v103, 0, v103
    v_mfma_f32_16x16x32_bf16 v[76:79], a[28:31], v[136:139], v[76:79]
    ds_read_b64_tr_b16 a[12:13], v8 offset:6144
    buffer_load_dwordx4 v19, s[24:27], s100 offen offset:1024 lds
    v_mfma_f32_16x16x32_bf16 v[92:95], a[28:31], v[140:143], v[92:95]
    ds_read_b64_tr_b16 a[14:15], v8 offset:6400
    v_mul_f32 v108, v56, v108
    v_mul_f32 v109, v56, v109
    s_waitcnt lgkmcnt(8)
    v_mfma_f32_16x16x32_bf16 v[64:67], a[32:35], v[144:147], v[64:67]
    ds_read_b64_tr_b16 a[16:17], v7 offset:40960
    v_mul_f32 v110, v56, v110
    v_mul_f32 v111, v56, v111
    v_mfma_f32_16x16x32_bf16 v[80:83], a[32:35], v[148:151], v[80:83]
    ds_read_b64_tr_b16 a[18:19], v7 offset:41216
    buffer_load_dwordx4 v19, s[24:27], s100 offen offset:2048 lds
    v_mfma_f32_16x16x32_bf16 v[68:71], a[36:39], v[144:147], v[68:71]
    ds_read_b64_tr_b16 a[20:21], v8 offset:40960
    v_mul_f32 v100, v100, v108
    v_mul_f32 v101, v101, v109
    v_mfma_f32_16x16x32_bf16 v[84:87], a[36:39], v[148:151], v[84:87]
    ds_read_b64_tr_b16 a[22:23], v8 offset:41216
    v_mul_f32 v102, v102, v110
    v_mul_f32 v103, v103, v111
    v_mfma_f32_16x16x32_bf16 v[72:75], a[40:43], v[144:147], v[72:75]
    ds_read_b64_tr_b16 a[24:25], v7 offset:8192
    buffer_load_dwordx4 v19, s[24:27], s100 offen offset:3072 lds
    v_mfma_f32_16x16x32_bf16 v[88:91], a[40:43], v[148:151], v[88:91]
    ds_read_b64_tr_b16 a[26:27], v7 offset:8448
    v_cvt_pk_bf16_f32 v106, v100, v101
    v_cvt_pk_bf16_f32 v107, v102, v103
    v_mfma_f32_16x16x32_bf16 v[76:79], a[44:47], v[144:147], v[76:79]
    ds_read_b64_tr_b16 a[28:29], v8 offset:8192
    v_mfma_f32_16x16x32_bf16 v[92:95], a[44:47], v[148:151], v[92:95]
    ds_read_b64_tr_b16 a[30:31], v8 offset:8448
    buffer_store_dwordx4 v[104:107], v1, s[36:39], s70 offen offset:1024 sc1
    v_max_f32 v112, 0, v112
    s_waitcnt lgkmcnt(8)
    v_mfma_f32_16x16x32_bf16 v[64:67], a[0:3], v[152:155], v[64:67]
    ds_read_b64_tr_b16 a[32:33], v7 offset:43008
    v_max_f32 v113, 0, v113
    v_max_f32 v114, 0, v114
    v_mfma_f32_16x16x32_bf16 v[80:83], a[0:3], v[156:159], v[80:83]
    ds_read_b64_tr_b16 a[34:35], v7 offset:43264
    s_add_u32 m0, s58, 0
    s_add_u32 s100, s83, 32768
    buffer_load_dwordx4 v19, s[24:27], s100 offen offset:0 lds
    v_mfma_f32_16x16x32_bf16 v[68:71], a[4:7], v[152:155], v[68:71]
    ds_read_b64_tr_b16 a[36:37], v8 offset:43008
    v_max_f32 v115, 0, v115
    v_mul_f32 v120, v58, v120
    v_mfma_f32_16x16x32_bf16 v[84:87], a[4:7], v[156:159], v[84:87]
    ds_read_b64_tr_b16 a[38:39], v8 offset:43264
    v_mul_f32 v121, v58, v121
    v_mul_f32 v122, v58, v122
    v_mfma_f32_16x16x32_bf16 v[72:75], a[8:11], v[152:155], v[72:75]
    ds_read_b64_tr_b16 a[40:41], v7 offset:10240
    buffer_load_dwordx4 v19, s[24:27], s100 offen offset:1024 lds
    v_mfma_f32_16x16x32_bf16 v[88:91], a[8:11], v[156:159], v[88:91]
    ds_read_b64_tr_b16 a[42:43], v7 offset:10496
    v_mul_f32 v123, v58, v123
    v_mul_f32 v112, v112, v120
    v_mfma_f32_16x16x32_bf16 v[76:79], a[12:15], v[152:155], v[76:79]
    ds_read_b64_tr_b16 a[44:45], v8 offset:10240
    buffer_load_dwordx4 v19, s[24:27], s100 offen offset:2048 lds
    v_mfma_f32_16x16x32_bf16 v[92:95], a[12:15], v[156:159], v[92:95]
    ds_read_b64_tr_b16 a[46:47], v8 offset:10496
    v_mul_f32 v113, v113, v121
    v_mul_f32 v114, v114, v122
    s_waitcnt lgkmcnt(8)
    v_mfma_f32_16x16x32_bf16 v[64:67], a[16:19], v[160:163], v[64:67]
    ds_read_b64_tr_b16 a[0:1], v7 offset:45056
    v_mul_f32 v115, v115, v123
    v_cvt_pk_bf16_f32 v120, v112, v113
    v_mfma_f32_16x16x32_bf16 v[80:83], a[16:19], v[164:167], v[80:83]
    ds_read_b64_tr_b16 a[2:3], v7 offset:45312
    buffer_load_dwordx4 v19, s[24:27], s100 offen offset:3072 lds
    v_mfma_f32_16x16x32_bf16 v[68:71], a[20:23], v[160:163], v[68:71]
    ds_read_b64_tr_b16 a[4:5], v8 offset:45056
    v_cvt_pk_bf16_f32 v121, v114, v115
    v_max_f32 v116, 0, v116
    v_mfma_f32_16x16x32_bf16 v[84:87], a[20:23], v[164:167], v[84:87]
    ds_read_b64_tr_b16 a[6:7], v8 offset:45312
    v_max_f32 v117, 0, v117
    v_max_f32 v118, 0, v118
    v_mfma_f32_16x16x32_bf16 v[72:75], a[24:27], v[160:163], v[72:75]
    ds_read_b64_tr_b16 a[8:9], v7 offset:12288
    s_add_u32 m0, s58, 4096
    s_add_u32 s100, s83, 425984
    buffer_load_dwordx4 v19, s[24:27], s100 offen offset:0 lds
    v_mfma_f32_16x16x32_bf16 v[88:91], a[24:27], v[164:167], v[88:91]
    ds_read_b64_tr_b16 a[10:11], v7 offset:12544
    v_max_f32 v119, 0, v119
    v_mul_f32 v124, v58, v124
    v_mfma_f32_16x16x32_bf16 v[76:79], a[28:31], v[160:163], v[76:79]
    ds_read_b64_tr_b16 a[12:13], v8 offset:12288
    buffer_load_dwordx4 v19, s[24:27], s100 offen offset:1024 lds
    v_mfma_f32_16x16x32_bf16 v[92:95], a[28:31], v[164:167], v[92:95]
    ds_read_b64_tr_b16 a[14:15], v8 offset:12544
    v_mul_f32 v125, v58, v125
    v_mul_f32 v126, v58, v126
    s_waitcnt lgkmcnt(8)
    v_mfma_f32_16x16x32_bf16 v[64:67], a[32:35], v[168:171], v[64:67]
    ds_read_b64_tr_b16 a[16:17], v7 offset:47104
    v_mul_f32 v127, v58, v127
    v_mul_f32 v116, v116, v124
    v_mfma_f32_16x16x32_bf16 v[80:83], a[32:35], v[172:175], v[80:83]
    ds_read_b64_tr_b16 a[18:19], v7 offset:47360
    buffer_load_dwordx4 v19, s[24:27], s100 offen offset:2048 lds
    v_mfma_f32_16x16x32_bf16 v[68:71], a[36:39], v[168:171], v[68:71]
    ds_read_b64_tr_b16 a[20:21], v8 offset:47104
    v_mul_f32 v117, v117, v125
    v_mul_f32 v118, v118, v126
    v_mfma_f32_16x16x32_bf16 v[84:87], a[36:39], v[172:175], v[84:87]
    ds_read_b64_tr_b16 a[22:23], v8 offset:47360
    v_mul_f32 v119, v119, v127
    v_cvt_pk_bf16_f32 v122, v116, v117
    v_mfma_f32_16x16x32_bf16 v[72:75], a[40:43], v[168:171], v[72:75]
    ds_read_b64_tr_b16 a[24:25], v7 offset:14336
    buffer_load_dwordx4 v19, s[24:27], s100 offen offset:3072 lds
    v_mfma_f32_16x16x32_bf16 v[88:91], a[40:43], v[172:175], v[88:91]
    ds_read_b64_tr_b16 a[26:27], v7 offset:14592
    v_cvt_pk_bf16_f32 v123, v118, v119
    buffer_store_dwordx4 v[120:123], v60, s[36:39], s70 offen offset:1024 sc1
    v_mfma_f32_16x16x32_bf16 v[76:79], a[44:47], v[168:171], v[76:79]
    ds_read_b64_tr_b16 a[28:29], v8 offset:14336
    v_mfma_f32_16x16x32_bf16 v[92:95], a[44:47], v[172:175], v[92:95]
    ds_read_b64_tr_b16 a[30:31], v8 offset:14592
    s_waitcnt vmcnt(19)
    s_waitcnt lgkmcnt(8)
    v_mfma_f32_16x16x32_bf16 v[64:67], a[0:3], v[176:179], v[64:67]
    ds_read_b64_tr_b16 a[32:33], v7 offset:49152
    ds_read_b64_tr_b16 a[48:49], v11 offset:32768
    ds_read_b64_tr_b16 a[50:51], v11 offset:33280
    v_mfma_f32_16x16x32_bf16 v[80:83], a[0:3], v[180:183], v[80:83]
    ds_read_b64_tr_b16 a[34:35], v7 offset:49408
    ds_read_b64_tr_b16 a[52:53], v11 offset:32776
    ds_read_b64_tr_b16 a[54:55], v11 offset:33288
    v_mfma_f32_16x16x32_bf16 v[68:71], a[4:7], v[176:179], v[68:71]
    ds_read_b64_tr_b16 a[36:37], v8 offset:49152
    ds_read_b64_tr_b16 a[56:57], v12 offset:32768
    ds_read_b64_tr_b16 a[58:59], v12 offset:33280
    v_mfma_f32_16x16x32_bf16 v[84:87], a[4:7], v[180:183], v[84:87]
    ds_read_b64_tr_b16 a[38:39], v8 offset:49408
    ds_read_b64_tr_b16 a[60:61], v12 offset:32776
    ds_read_b64_tr_b16 a[62:63], v12 offset:33288
    v_mfma_f32_16x16x32_bf16 v[72:75], a[8:11], v[176:179], v[72:75]
    ds_read_b64_tr_b16 a[40:41], v7 offset:16384
    ds_read_b64_tr_b16 a[64:65], v11 offset:36864
    ds_read_b64_tr_b16 a[66:67], v11 offset:37376
    v_mfma_f32_16x16x32_bf16 v[88:91], a[8:11], v[180:183], v[88:91]
    ds_read_b64_tr_b16 a[42:43], v7 offset:16640
    ds_read_b64_tr_b16 a[68:69], v11 offset:36872
    ds_read_b64_tr_b16 a[70:71], v11 offset:37384
    v_mfma_f32_16x16x32_bf16 v[76:79], a[12:15], v[176:179], v[76:79]
    ds_read_b64_tr_b16 a[44:45], v8 offset:16384
    ds_read_b64_tr_b16 a[72:73], v12 offset:36864
    ds_read_b64_tr_b16 a[74:75], v12 offset:37376
    v_mfma_f32_16x16x32_bf16 v[92:95], a[12:15], v[180:183], v[92:95]
    ds_read_b64_tr_b16 a[46:47], v8 offset:16640
    ds_read_b64_tr_b16 a[76:77], v12 offset:36872
    ds_read_b64_tr_b16 a[78:79], v12 offset:37384
    s_waitcnt lgkmcnt(15)
    v_mfma_f32_16x16x32_bf16 v[64:67], a[16:19], v[184:187], v[64:67]
    ds_read_b64_tr_b16 a[0:1], v7 offset:51200
    v_mfma_f32_16x16x32_bf16 v[80:83], a[16:19], v[188:191], v[80:83]
    ds_read_b64_tr_b16 a[2:3], v7 offset:51456
    v_mfma_f32_16x16x32_bf16 v[68:71], a[20:23], v[184:187], v[68:71]
    ds_read_b64_tr_b16 a[4:5], v8 offset:51200
    v_mfma_f32_16x16x32_bf16 v[84:87], a[20:23], v[188:191], v[84:87]
    ds_read_b64_tr_b16 a[6:7], v8 offset:51456
    v_mfma_f32_16x16x32_bf16 v[72:75], a[24:27], v[184:187], v[72:75]
    ds_read_b64_tr_b16 a[8:9], v7 offset:18432
    v_mfma_f32_16x16x32_bf16 v[88:91], a[24:27], v[188:191], v[88:91]
    ds_read_b64_tr_b16 a[10:11], v7 offset:18688
    v_mfma_f32_16x16x32_bf16 v[76:79], a[28:31], v[184:187], v[76:79]
    ds_read_b64_tr_b16 a[12:13], v8 offset:18432
    v_mfma_f32_16x16x32_bf16 v[92:95], a[28:31], v[188:191], v[92:95]
    ds_read_b64_tr_b16 a[14:15], v8 offset:18688
    buffer_load_dword v44, v39, s[36:39], s95 offen sc1
    s_waitcnt lgkmcnt(10)
    v_mfma_f32_16x16x32_bf16 v[64:67], a[32:35], v[192:195], v[64:67]
    ds_read_b64_tr_b16 a[16:17], v7 offset:53248
    v_mfma_f32_16x16x32_bf16 v[80:83], a[32:35], v[196:199], v[80:83]
    ds_read_b64_tr_b16 a[18:19], v7 offset:53504
    v_mfma_f32_16x16x32_bf16 v[68:71], a[36:39], v[192:195], v[68:71]
    ds_read_b64_tr_b16 a[20:21], v8 offset:53248
    v_mfma_f32_16x16x32_bf16 v[84:87], a[36:39], v[196:199], v[84:87]
    ds_read_b64_tr_b16 a[22:23], v8 offset:53504
    v_mfma_f32_16x16x32_bf16 v[72:75], a[40:43], v[192:195], v[72:75]
    ds_read_b64_tr_b16 a[24:25], v7 offset:20480
    v_mfma_f32_16x16x32_bf16 v[88:91], a[40:43], v[196:199], v[88:91]
    ds_read_b64_tr_b16 a[26:27], v7 offset:20736
    v_mfma_f32_16x16x32_bf16 v[76:79], a[44:47], v[192:195], v[76:79]
    ds_read_b64_tr_b16 a[28:29], v8 offset:20480
    v_mfma_f32_16x16x32_bf16 v[92:95], a[44:47], v[196:199], v[92:95]
    ds_read_b64_tr_b16 a[30:31], v8 offset:20736
    s_waitcnt lgkmcnt(8)
    v_mfma_f32_16x16x32_bf16 v[64:67], a[0:3], v[200:203], v[64:67]
    ds_read_b64_tr_b16 a[32:33], v7 offset:55296
    v_mfma_f32_16x16x32_bf16 v[80:83], a[0:3], v[204:207], v[80:83]
    ds_read_b64_tr_b16 a[34:35], v7 offset:55552
    v_mfma_f32_16x16x32_bf16 v[68:71], a[4:7], v[200:203], v[68:71]
    ds_read_b64_tr_b16 a[36:37], v8 offset:55296
    v_mfma_f32_16x16x32_bf16 v[84:87], a[4:7], v[204:207], v[84:87]
    ds_read_b64_tr_b16 a[38:39], v8 offset:55552
    v_mfma_f32_16x16x32_bf16 v[72:75], a[8:11], v[200:203], v[72:75]
    ds_read_b64_tr_b16 a[40:41], v7 offset:22528
    v_mfma_f32_16x16x32_bf16 v[88:91], a[8:11], v[204:207], v[88:91]
    ds_read_b64_tr_b16 a[42:43], v7 offset:22784
    v_mfma_f32_16x16x32_bf16 v[76:79], a[12:15], v[200:203], v[76:79]
    ds_read_b64_tr_b16 a[44:45], v8 offset:22528
    v_mfma_f32_16x16x32_bf16 v[92:95], a[12:15], v[204:207], v[92:95]
    ds_read_b64_tr_b16 a[46:47], v8 offset:22784
    s_waitcnt lgkmcnt(8)
    v_mfma_f32_16x16x32_bf16 v[64:67], a[16:19], v[208:211], v[64:67]
    ds_read_b64_tr_b16 a[0:1], v7 offset:57344
    v_mfma_f32_16x16x32_bf16 v[80:83], a[16:19], v[212:215], v[80:83]
    ds_read_b64_tr_b16 a[2:3], v7 offset:57600
    v_mfma_f32_16x16x32_bf16 v[68:71], a[20:23], v[208:211], v[68:71]
    ds_read_b64_tr_b16 a[4:5], v8 offset:57344
    v_mfma_f32_16x16x32_bf16 v[84:87], a[20:23], v[212:215], v[84:87]
    ds_read_b64_tr_b16 a[6:7], v8 offset:57600
    v_mfma_f32_16x16x32_bf16 v[72:75], a[24:27], v[208:211], v[72:75]
    ds_read_b64_tr_b16 a[8:9], v7 offset:24576
    v_mfma_f32_16x16x32_bf16 v[88:91], a[24:27], v[212:215], v[88:91]
    ds_read_b64_tr_b16 a[10:11], v7 offset:24832
    v_mfma_f32_16x16x32_bf16 v[76:79], a[28:31], v[208:211], v[76:79]
    ds_read_b64_tr_b16 a[12:13], v8 offset:24576
    v_mfma_f32_16x16x32_bf16 v[92:95], a[28:31], v[212:215], v[92:95]
    ds_read_b64_tr_b16 a[14:15], v8 offset:24832
    s_waitcnt vmcnt(1)
    v_mov_b32 v62, 0
    v_mov_b32 v63, 1
    s_mov_b64 exec, 1
    buffer_store_byte v63, v62, s[36:39], s71 offen offset:16 sc1
    s_mov_b64 exec, -1
    s_waitcnt lgkmcnt(8)
    v_mfma_f32_16x16x32_bf16 v[64:67], a[32:35], v[216:219], v[64:67]
    ds_read_b64_tr_b16 a[16:17], v7 offset:59392
    v_mfma_f32_16x16x32_bf16 v[80:83], a[32:35], v[220:223], v[80:83]
    ds_read_b64_tr_b16 a[18:19], v7 offset:59648
    v_mfma_f32_16x16x32_bf16 v[68:71], a[36:39], v[216:219], v[68:71]
    ds_read_b64_tr_b16 a[20:21], v8 offset:59392
    v_mfma_f32_16x16x32_bf16 v[84:87], a[36:39], v[220:223], v[84:87]
    ds_read_b64_tr_b16 a[22:23], v8 offset:59648
    v_mfma_f32_16x16x32_bf16 v[72:75], a[40:43], v[216:219], v[72:75]
    ds_read_b64_tr_b16 a[24:25], v7 offset:26624
    v_mfma_f32_16x16x32_bf16 v[88:91], a[40:43], v[220:223], v[88:91]
    ds_read_b64_tr_b16 a[26:27], v7 offset:26880
    v_mfma_f32_16x16x32_bf16 v[76:79], a[44:47], v[216:219], v[76:79]
    ds_read_b64_tr_b16 a[28:29], v8 offset:26624
    v_mfma_f32_16x16x32_bf16 v[92:95], a[44:47], v[220:223], v[92:95]
    ds_read_b64_tr_b16 a[30:31], v8 offset:26880
    s_waitcnt vmcnt(1)
    v_and_b32 v44, s85, v44
    v_cmp_ne_u32 vcc, s85, v44
    s_nop 0
    s_cmp_eq_u64 vcc, 0
    s_cbranch_scc1 POLLD_13
    s_mov_b32 s72, 30000
POLL_12:
    buffer_load_dword v63, v39, s[36:39], s95 offen sc1
    s_waitcnt vmcnt(0)
    v_and_b32 v63, s85, v63
    v_cmp_ne_u32 vcc, s85, v63
    s_nop 0
    s_cmp_eq_u64 vcc, 0
    s_cbranch_scc1 POLLD_13
    s_sub_u32 s72, s72, 1
    s_cbranch_scc0 POLL_12
POLLD_13:
    s_waitcnt lgkmcnt(8)
    v_mfma_f32_16x16x32_bf16 v[64:67], a[0:3], v[224:227], v[64:67]
    ds_read_b64_tr_b16 a[32:33], v7 offset:61440
    v_mfma_f32_16x16x32_bf16 v[80:83], a[0:3], v[228:231], v[80:83]
    ds_read_b64_tr_b16 a[34:35], v7 offset:61696
    buffer_load_dwordx4 v[128:131], v1, s[36:39], s40 offen offset:0 sc1
    v_mfma_f32_16x16x32_bf16 v[68:71], a[4:7], v[224:227], v[68:71]
    ds_read_b64_tr_b16 a[36:37], v8 offset:61440
    v_mfma_f32_16x16x32_bf16 v[84:87], a[4:7], v[228:231], v[84:87]
    ds_read_b64_tr_b16 a[38:39], v8 offset:61696
    v_mfma_f32_16x16x32_bf16 v[72:75], a[8:11], v[224:227], v[72:75]
    ds_read_b64_tr_b16 a[40:41], v7 offset:28672
    buffer_load_dwordx4 v[132:135], v1, s[36:39], s41 offen offset:0 sc1
    v_mfma_f32_16x16x32_bf16 v[88:91], a[8:11], v[228:231], v[88:91]
    ds_read_b64_tr_b16 a[42:43], v7 offset:28928
    v_mfma_f32_16x16x32_bf16 v[76:79], a[12:15], v[224:227], v[76:79]
    ds_read_b64_tr_b16 a[44:45], v8 offset:28672
    buffer_load_dwordx4 v[136:139], v1, s[36:39], s42 offen offset:0 sc1
    v_mfma_f32_16x16x32_bf16 v[92:95], a[12:15], v[228:231], v[92:95]
    ds_read_b64_tr_b16 a[46:47], v8 offset:28928
    s_waitcnt lgkmcnt(8)
    v_mfma_f32_16x16x32_bf16 v[64:67], a[16:19], v[232:235], v[64:67]
    ds_read_b64_tr_b16 a[0:1], v7 offset:63488
    v_mfma_f32_16x16x32_bf16 v[80:83], a[16:19], v[236:239], v[80:83]
    ds_read_b64_tr_b16 a[2:3], v7 offset:63744
    buffer_load_dwordx4 v[140:143], v1, s[36:39], s43 offen offset:0 sc1
    v_mfma_f32_16x16x32_bf16 v[68:71], a[20:23], v[232:235], v[68:71]
    ds_read_b64_tr_b16 a[4:5], v8 offset:63488
    v_mfma_f32_16x16x32_bf16 v[84:87], a[20:23], v[236:239], v[84:87]
    ds_read_b64_tr_b16 a[6:7], v8 offset:63744
    v_mfma_f32_16x16x32_bf16 v[72:75], a[24:27], v[232:235], v[72:75]
    ds_read_b64_tr_b16 a[8:9], v7 offset:30720
    buffer_load_dwordx4 v[144:147], v3, s[36:39], s40 offen offset:0 sc1
    v_mfma_f32_16x16x32_bf16 v[88:91], a[24:27], v[236:239], v[88:91]
    ds_read_b64_tr_b16 a[10:11], v7 offset:30976
    v_mfma_f32_16x16x32_bf16 v[76:79], a[28:31], v[232:235], v[76:79]
    ds_read_b64_tr_b16 a[12:13], v8 offset:30720
    buffer_load_dwordx4 v[148:151], v3, s[36:39], s41 offen offset:0 sc1
    v_mfma_f32_16x16x32_bf16 v[92:95], a[28:31], v[236:239], v[92:95]
    ds_read_b64_tr_b16 a[14:15], v8 offset:30976
    s_waitcnt lgkmcnt(8)
    v_mfma_f32_16x16x32_bf16 v[64:67], a[32:35], v[240:243], v[64:67]
    v_mfma_f32_16x16x32_bf16 v[80:83], a[32:35], v[244:247], v[80:83]
    buffer_load_dwordx4 v[152:155], v3, s[36:39], s42 offen offset:0 sc1
    v_mfma_f32_16x16x32_bf16 v[68:71], a[36:39], v[240:243], v[68:71]
    v_mfma_f32_16x16x32_bf16 v[84:87], a[36:39], v[244:247], v[84:87]
    v_mfma_f32_16x16x32_bf16 v[72:75], a[40:43], v[240:243], v[72:75]
    buffer_load_dwordx4 v[156:159], v3, s[36:39], s43 offen offset:0 sc1
    v_mfma_f32_16x16x32_bf16 v[88:91], a[40:43], v[244:247], v[88:91]
    v_mfma_f32_16x16x32_bf16 v[76:79], a[44:47], v[240:243], v[76:79]
    buffer_load_dwordx4 v[160:163], v4, s[36:39], s40 offen offset:0 sc1
    v_mfma_f32_16x16x32_bf16 v[92:95], a[44:47], v[244:247], v[92:95]
    s_waitcnt lgkmcnt(0)
    v_mfma_f32_16x16x32_bf16 v[64:67], a[0:3], v[248:251], v[64:67]
    v_mfma_f32_16x16x32_bf16 v[80:83], a[0:3], v[252:255], v[80:83]
    buffer_load_dwordx4 v[164:167], v4, s[36:39], s41 offen offset:0 sc1
    v_mfma_f32_16x16x32_bf16 v[68:71], a[4:7], v[248:251], v[68:71]
    v_mfma_f32_16x16x32_bf16 v[84:87], a[4:7], v[252:255], v[84:87]
    v_mfma_f32_16x16x32_bf16 v[72:75], a[8:11], v[248:251], v[72:75]
    buffer_load_dwordx4 v[168:171], v4, s[36:39], s42 offen offset:0 sc1
    v_mfma_f32_16x16x32_bf16 v[88:91], a[8:11], v[252:255], v[88:91]
    v_mfma_f32_16x16x32_bf16 v[76:79], a[12:15], v[248:251], v[76:79]
    buffer_load_dwordx4 v[172:175], v4, s[36:39], s43 offen offset:0 sc1
    v_mfma_f32_16x16x32_bf16 v[92:95], a[12:15], v[252:255], v[92:95]
    s_barrier
    v_max_f32 v64, 0, v64
    v_max_f32 v65, 0, v65
    v_max_f32 v66, 0, v66
    v_max_f32 v67, 0, v67
    v_pk_mul_f32 v[72:73], v[56:57], v[72:73] op_sel:[0,0] op_sel_hi:[0,1]
    v_pk_mul_f32 v[74:75], v[56:57], v[74:75] op_sel:[0,0] op_sel_hi:[0,1]
    v_pk_mul_f32 v[64:65], v[64:65], v[72:73] op_sel:[0,0] op_sel_hi:[1,1]
    v_pk_mul_f32 v[66:67], v[66:67], v[74:75] op_sel:[0,0] op_sel_hi:[1,1]
    v_cvt_pk_bf16_f32 v72, v64, v65
    v_cvt_pk_bf16_f32 v73, v66, v67
    buffer_load_dwordx4 v[176:179], v38, s[36:39], s40 offen offset:0 sc1
    v_max_f32 v68, 0, v68
    v_max_f32 v69, 0, v69
    v_max_f32 v70, 0, v70
    v_max_f32 v71, 0, v71
    v_pk_mul_f32 v[76:77], v[56:57], v[76:77] op_sel:[0,0] op_sel_hi:[0,1]
    v_pk_mul_f32 v[78:79], v[56:57], v[78:79] op_sel:[0,0] op_sel_hi:[0,1]
    v_pk_mul_f32 v[68:69], v[68:69], v[76:77] op_sel:[0,0] op_sel_hi:[1,1]
    v_pk_mul_f32 v[70:71], v[70:71], v[78:79] op_sel:[0,0] op_sel_hi:[1,1]
    v_cvt_pk_bf16_f32 v74, v68, v69
    v_cvt_pk_bf16_f32 v75, v70, v71
    buffer_load_dwordx4 v[180:183], v38, s[36:39], s41 offen offset:0 sc1
    buffer_store_dwordx4 v[72:75], v1, s[36:39], s70 offen offset:2048 sc1
    v_max_f32 v80, 0, v80
    v_max_f32 v81, 0, v81
    v_max_f32 v82, 0, v82
    v_max_f32 v83, 0, v83
    v_pk_mul_f32 v[88:89], v[58:59], v[88:89] op_sel:[0,0] op_sel_hi:[0,1]
    v_pk_mul_f32 v[90:91], v[58:59], v[90:91] op_sel:[0,0] op_sel_hi:[0,1]
    v_pk_mul_f32 v[80:81], v[80:81], v[88:89] op_sel:[0,0] op_sel_hi:[1,1]
    v_pk_mul_f32 v[82:83], v[82:83], v[90:91] op_sel:[0,0] op_sel_hi:[1,1]
    v_cvt_pk_bf16_f32 v88, v80, v81
    buffer_load_dwordx4 v[184:187], v38, s[36:39], s42 offen offset:0 sc1
    v_cvt_pk_bf16_f32 v89, v82, v83
    v_max_f32 v84, 0, v84
    v_max_f32 v85, 0, v85
    v_max_f32 v86, 0, v86
    v_max_f32 v87, 0, v87
    v_pk_mul_f32 v[92:93], v[58:59], v[92:93] op_sel:[0,0] op_sel_hi:[0,1]
    v_pk_mul_f32 v[94:95], v[58:59], v[94:95] op_sel:[0,0] op_sel_hi:[0,1]
    v_pk_mul_f32 v[84:85], v[84:85], v[92:93] op_sel:[0,0] op_sel_hi:[1,1]
    v_pk_mul_f32 v[86:87], v[86:87], v[94:95] op_sel:[0,0] op_sel_hi:[1,1]
    v_cvt_pk_bf16_f32 v90, v84, v85
    buffer_load_dwordx4 v[188:191], v38, s[36:39], s43 offen offset:0 sc1
    v_cvt_pk_bf16_f32 v91, v86, v87
    buffer_store_dwordx4 v[88:91], v60, s[36:39], s70 offen offset:2048 sc1
    s_add_u32 s95, s95, 16
    buffer_load_dword v45, v39, s[36:39], s95 offen sc1
    ds_read_b64_tr_b16 a[80:81], v15 offset:0
    ds_read_b64_tr_b16 a[82:83], v15 offset:512
    ds_read_b64_tr_b16 a[84:85], v15 offset:8
    ds_read_b64_tr_b16 a[86:87], v15 offset:520
    ds_read_b64_tr_b16 a[88:89], v16 offset:0
    ds_read_b64_tr_b16 a[90:91], v16 offset:512
    ds_read_b64_tr_b16 a[92:93], v16 offset:8
    ds_read_b64_tr_b16 a[94:95], v16 offset:520
    ds_read_b64_tr_b16 a[96:97], v15 offset:4096
    ds_read_b64_tr_b16 a[98:99], v15 offset:4608
    ds_read_b64_tr_b16 a[100:101], v15 offset:4104
    ds_read_b64_tr_b16 a[102:103], v15 offset:4616
    ds_read_b64_tr_b16 a[104:105], v16 offset:4096
    ds_read_b64_tr_b16 a[106:107], v16 offset:4608
    ds_read_b64_tr_b16 a[108:109], v16 offset:4104
    ds_read_b64_tr_b16 a[110:111], v16 offset:4616
    ds_read_b64_tr_b16 a[112:113], v11 offset:0
    ds_read_b64_tr_b16 a[114:115], v11 offset:512
    ds_read_b64_tr_b16 a[116:117], v11 offset:8
    ds_read_b64_tr_b16 a[118:119], v11 offset:520
    ds_read_b64_tr_b16 a[120:121], v12 offset:0
    ds_read_b64_tr_b16 a[122:123], v12 offset:512
    ds_read_b64_tr_b16 a[124:125], v12 offset:8
    ds_read_b64_tr_b16 a[126:127], v12 offset:520
    ds_read_b64_tr_b16 a[128:129], v11 offset:4096
    ds_read_b64_tr_b16 a[130:131], v11 offset:4608
    ds_read_b64_tr_b16 a[132:133], v11 offset:4104
    ds_read_b64_tr_b16 a[134:135], v11 offset:4616
    ds_read_b64_tr_b16 a[136:137], v12 offset:4096
    ds_read_b64_tr_b16 a[138:139], v12 offset:4608
    ds_read_b64_tr_b16 a[140:141], v12 offset:4104
    ds_read_b64_tr_b16 a[142:143], v12 offset:4616
    s_add_u32 m0, s58, 32768
    s_add_u32 s100, s83, 819200
    buffer_load_dwordx4 v19, s[24:27], s100 offen offset:0 lds
    buffer_load_dwordx4 v19, s[24:27], s100 offen offset:1024 lds
    buffer_load_dwordx4 v19, s[24:27], s100 offen offset:2048 lds
    buffer_load_dwordx4 v19, s[24:27], s100 offen offset:3072 lds
    s_add_u32 m0, s58, 36864
    s_add_u32 s100, s50, 1212416
    buffer_load_dwordx4 v19, s[24:27], s100 offen offset:0 lds
    buffer_load_dwordx4 v19, s[24:27], s100 offen offset:1024 lds
    buffer_load_dwordx4 v19, s[24:27], s100 offen offset:2048 lds
    buffer_load_dwordx4 v19, s[24:27], s100 offen offset:3072 lds
    s_add_u32 s61, s58, 98304
    v_add_u32 v61, s61, v1
    v_add_u32 v60, 32768, v61
    s_add_u32 s60, s48, 1
    s_and_b32 s60, s60, 3
    s_lshl_b32 s60, s60, 13
    s_add_u32 s60, s60, 131072
    v_add_u32 v57, s60, v1
    s_add_u32 s60, s48, 2
    s_and_b32 s60, s60, 3
    s_lshl_b32 s60, s60, 13
    s_add_u32 s60, s60, 102400
    v_add_u32 v58, s60, v1
    s_add_u32 s60, s48, 3
    s_and_b32 s60, s60, 3
    s_lshl_b32 s60, s60, 13
    s_add_u32 s60, s60, 98304
    v_add_u32 v59, s60, v1
    s_lshl_b32 s89, s94, 14
    s_cmp_eq_u32 s51, 0
    s_cselect_b32 s44, s36, s28
    s_cselect_b32 s45, s37, s29
    s_cselect_b32 s46, s38, s30
    s_cselect_b32 s47, s39, s31
    s_cselect_b32 s88, 1024, 64
    s_cselect_b32 s61, 10485760, 0
    s_cselect_b32 s62, 11, 7
    s_cselect_b64 vcc, -1, 0
    s_add_u32 s89, s89, s61
    s_lshl_b32 s61, s55, s62
    s_add_u32 s89, s89, s61
    v_cndmask_b32 v56, v37, v1, vcc
    s_add_u32 s68, s69, 49152
    s_add_u32 s66, s59, 1310720
    s_waitcnt vmcnt(8)
    v_and_b32 v45, s85, v45
    v_cmp_ne_u32 vcc, s85, v45
    s_nop 0
    s_cmp_eq_u64 vcc, 0
    s_cbranch_scc1 POLLD_15
    s_mov_b32 s72, 30000
POLL_14:
    buffer_load_dword v63, v39, s[36:39], s95 offen sc1
    s_waitcnt vmcnt(0)
    v_and_b32 v63, s85, v63
    v_cmp_ne_u32 vcc, s85, v63
    s_nop 0
    s_cmp_eq_u64 vcc, 0
    s_cbranch_scc1 POLLD_15
    s_sub_u32 s72, s72, 1
    s_cbranch_scc0 POLL_14
POLLD_15:
    v_mov_b32 v62, 0
    v_mov_b32 v63, 1
    s_mov_b64 exec, 1
    buffer_store_byte v63, v62, s[36:39], s71 offen offset:32 sc1
    s_mov_b64 exec, -1
    v_lshlrev_b32 v40, 16, v20
    v_and_b32 v41, 0xffff0000, v20
    v_lshlrev_b32 v42, 16, v21
    v_and_b32 v43, 0xffff0000, v21
    v_lshlrev_b32 v44, 16, v22
    v_and_b32 v45, 0xffff0000, v22
    v_lshlrev_b32 v46, 16, v23
    v_and_b32 v47, 0xffff0000, v23
    v_lshlrev_b32 v48, 16, v24
    v_and_b32 v49, 0xffff0000, v24
    v_lshlrev_b32 v50, 16, v25
    v_and_b32 v51, 0xffff0000, v25
    v_lshlrev_b32 v52, 16, v26
    v_and_b32 v53, 0xffff0000, v26
    v_lshlrev_b32 v54, 16, v27
    v_and_b32 v55, 0xffff0000, v27
    buffer_load_dwordx4 v[192:195], v1, s[36:39], s40 offen offset:1024 sc1
    buffer_load_dwordx4 v[196:199], v1, s[36:39], s41 offen offset:1024 sc1
    buffer_load_dwordx4 v[200:203], v1, s[36:39], s42 offen offset:1024 sc1
    buffer_load_dwordx4 v[204:207], v1, s[36:39], s43 offen offset:1024 sc1
    buffer_load_dwordx4 v[208:211], v3, s[36:39], s40 offen offset:1024 sc1
    buffer_load_dwordx4 v[212:215], v3, s[36:39], s41 offen offset:1024 sc1
    buffer_load_dwordx4 v[216:219], v3, s[36:39], s42 offen offset:1024 sc1
    buffer_load_dwordx4 v[220:223], v3, s[36:39], s43 offen offset:1024 sc1
    s_waitcnt lgkmcnt(0)
    v_mfma_f32_16x16x32_bf16 v[64:67], a[48:51], v[128:131], 0
    v_mfma_f32_16x16x32_bf16 v[68:71], a[52:55], v[128:131], 0
    buffer_load_dwordx4 v[224:227], v4, s[36:39], s40 offen offset:1024 sc1
    v_mfma_f32_16x16x32_bf16 v[72:75], a[56:59], v[128:131], 0
    v_mfma_f32_16x16x32_bf16 v[76:79], a[60:63], v[128:131], 0
    buffer_load_dwordx4 v[228:231], v4, s[36:39], s41 offen offset:1024 sc1
    v_mfma_f32_16x16x32_bf16 v[80:83], a[48:51], v[132:135], 0
    v_mfma_f32_16x16x32_bf16 v[84:87], a[52:55], v[132:135], 0
    buffer_load_dwordx4 v[232:235], v4, s[36:39], s42 offen offset:1024 sc1
    v_mfma_f32_16x16x32_bf16 v[88:91], a[56:59], v[132:135], 0
    v_mfma_f32_16x16x32_bf16 v[92:95], a[60:63], v[132:135], 0
    buffer_load_dwordx4 v[236:239], v4, s[36:39], s43 offen offset:1024 sc1
    v_mfma_f32_16x16x32_bf16 v[96:99], a[48:51], v[136:139], 0
    v_mfma_f32_16x16x32_bf16 v[100:103], a[52:55], v[136:139], 0
    buffer_load_dwordx4 v[240:243], v38, s[36:39], s40 offen offset:1024 sc1
    v_mfma_f32_16x16x32_bf16 v[104:107], a[56:59], v[136:139], 0
    v_mfma_f32_16x16x32_bf16 v[108:111], a[60:63], v[136:139], 0
    buffer_load_dwordx4 v[244:247], v38, s[36:39], s41 offen offset:1024 sc1
    v_mfma_f32_16x16x32_bf16 v[112:115], a[48:51], v[140:143], v[40:43]
    v_mfma_f32_16x16x32_bf16 v[116:119], a[52:55], v[140:143], v[44:47]
    buffer_load_dwordx4 v[248:251], v38, s[36:39], s42 offen offset:1024 sc1
    v_mfma_f32_16x16x32_bf16 v[120:123], a[56:59], v[140:143], v[48:51]
    v_mfma_f32_16x16x32_bf16 v[124:127], a[60:63], v[140:143], v[52:55]
    buffer_load_dwordx4 v[252:255], v38, s[36:39], s43 offen offset:1024 sc1
    v_mfma_f32_16x16x32_bf16 v[64:67], a[64:67], v[144:147], v[64:67]
    v_mfma_f32_16x16x32_bf16 v[68:71], a[68:71], v[144:147], v[68:71]
    v_mfma_f32_16x16x32_bf16 v[72:75], a[72:75], v[144:147], v[72:75]
    v_mfma_f32_16x16x32_bf16 v[76:79], a[76:79], v[144:147], v[76:79]
    s_add_u32 m0, s58, 131072
    s_add_u32 s100, s83, 65536
    buffer_load_dwordx4 v19, s[24:27], s100 offen offset:0 lds
    v_mfma_f32_16x16x32_bf16 v[80:83], a[64:67], v[148:151], v[80:83]
    v_mfma_f32_16x16x32_bf16 v[84:87], a[68:71], v[148:151], v[84:87]
    buffer_load_dwordx4 v19, s[24:27], s100 offen offset:1024 lds
    v_mfma_f32_16x16x32_bf16 v[88:91], a[72:75], v[148:151], v[88:91]
    v_mfma_f32_16x16x32_bf16 v[92:95], a[76:79], v[148:151], v[92:95]
    buffer_load_dwordx4 v19, s[24:27], s100 offen offset:2048 lds
    v_mfma_f32_16x16x32_bf16 v[96:99], a[64:67], v[152:155], v[96:99]
    v_mfma_f32_16x16x32_bf16 v[100:103], a[68:71], v[152:155], v[100:103]
    buffer_load_dwordx4 v19, s[24:27], s100 offen offset:3072 lds
    v_mfma_f32_16x16x32_bf16 v[104:107], a[72:75], v[152:155], v[104:107]
    v_mfma_f32_16x16x32_bf16 v[108:111], a[76:79], v[152:155], v[108:111]
    s_add_u32 m0, s58, 135168
    s_add_u32 s100, s83, 458752
    buffer_load_dwordx4 v19, s[24:27], s100 offen offset:0 lds
    v_mfma_f32_16x16x32_bf16 v[112:115], a[64:67], v[156:159], v[112:115]
    v_mfma_f32_16x16x32_bf16 v[116:119], a[68:71], v[156:159], v[116:119]
    buffer_load_dwordx4 v19, s[24:27], s100 offen offset:1024 lds
    v_mfma_f32_16x16x32_bf16 v[120:123], a[72:75], v[156:159], v[120:123]
    v_mfma_f32_16x16x32_bf16 v[124:127], a[76:79], v[156:159], v[124:127]
    buffer_load_dwordx4 v19, s[24:27], s100 offen offset:2048 lds
    v_mfma_f32_16x16x32_bf16 v[64:67], a[80:83], v[160:163], v[64:67]
    v_mfma_f32_16x16x32_bf16 v[68:71], a[84:87], v[160:163], v[68:71]
    buffer_load_dwordx4 v19, s[24:27], s100 offen offset:3072 lds
    v_mfma_f32_16x16x32_bf16 v[72:75], a[88:91], v[160:163], v[72:75]
    v_mfma_f32_16x16x32_bf16 v[76:79], a[92:95], v[160:163], v[76:79]
    v_mfma_f32_16x16x32_bf16 v[80:83], a[80:83], v[164:167], v[80:83]
    v_mfma_f32_16x16x32_bf16 v[84:87], a[84:87], v[164:167], v[84:87]
    s_add_u32 m0, s58, 98304
    s_add_u32 s100, s83, 851968
    buffer_load_dwordx4 v19, s[24:27], s100 offen offset:0 lds
    v_mfma_f32_16x16x32_bf16 v[88:91], a[88:91], v[164:167], v[88:91]
    v_mfma_f32_16x16x32_bf16 v[92:95], a[92:95], v[164:167], v[92:95]
    buffer_load_dwordx4 v19, s[24:27], s100 offen offset:1024 lds
    v_mfma_f32_16x16x32_bf16 v[96:99], a[80:83], v[168:171], v[96:99]
    v_mfma_f32_16x16x32_bf16 v[100:103], a[84:87], v[168:171], v[100:103]
    buffer_load_dwordx4 v19, s[24:27], s100 offen offset:2048 lds
    v_mfma_f32_16x16x32_bf16 v[104:107], a[88:91], v[168:171], v[104:107]
    v_mfma_f32_16x16x32_bf16 v[108:111], a[92:95], v[168:171], v[108:111]
    buffer_load_dwordx4 v19, s[24:27], s100 offen offset:3072 lds
    v_mfma_f32_16x16x32_bf16 v[112:115], a[80:83], v[172:175], v[112:115]
    v_mfma_f32_16x16x32_bf16 v[116:119], a[84:87], v[172:175], v[116:119]
    v_mfma_f32_16x16x32_bf16 v[120:123], a[88:91], v[172:175], v[120:123]
    v_mfma_f32_16x16x32_bf16 v[124:127], a[92:95], v[172:175], v[124:127]
    s_add_u32 s95, s95, 16
    buffer_load_dword v40, v39, s[36:39], s95 offen sc1
    v_mfma_f32_16x16x32_bf16 v[64:67], a[96:99], v[176:179], v[64:67]
    v_mfma_f32_16x16x32_bf16 v[68:71], a[100:103], v[176:179], v[68:71]
    v_mfma_f32_16x16x32_bf16 v[72:75], a[104:107], v[176:179], v[72:75]
    v_mfma_f32_16x16x32_bf16 v[76:79], a[108:111], v[176:179], v[76:79]
    v_mfma_f32_16x16x32_bf16 v[80:83], a[96:99], v[180:183], v[80:83]
    v_mfma_f32_16x16x32_bf16 v[84:87], a[100:103], v[180:183], v[84:87]
    v_mfma_f32_16x16x32_bf16 v[88:91], a[104:107], v[180:183], v[88:91]
    v_mfma_f32_16x16x32_bf16 v[92:95], a[108:111], v[180:183], v[92:95]
    v_mfma_f32_16x16x32_bf16 v[96:99], a[96:99], v[184:187], v[96:99]
    v_mfma_f32_16x16x32_bf16 v[100:103], a[100:103], v[184:187], v[100:103]
    v_mfma_f32_16x16x32_bf16 v[104:107], a[104:107], v[184:187], v[104:107]
    v_mfma_f32_16x16x32_bf16 v[108:111], a[108:111], v[184:187], v[108:111]
    v_mfma_f32_16x16x32_bf16 v[112:115], a[96:99], v[188:191], v[112:115]
    v_mfma_f32_16x16x32_bf16 v[116:119], a[100:103], v[188:191], v[116:119]
    v_mfma_f32_16x16x32_bf16 v[120:123], a[104:107], v[188:191], v[120:123]
    v_mfma_f32_16x16x32_bf16 v[124:127], a[108:111], v[188:191], v[124:127]
    v_lshrrev_b32 v62, 2, v0
    v_mul_u32_u24 v62, 3072, v62
    v_and_b32 v63, 3, v0
    v_lshl_add_u32 v62, v63, 7, v62
    s_add_u32 s60, s99, 1024
    s_mov_b64 exec, 65535
    buffer_load_dword a224, v62, s[8:11], s60 offen
    s_mov_b64 exec, -1
    s_waitcnt vmcnt(29)
    v_mfma_f32_16x16x32_bf16 v[64:67], a[112:115], v[192:195], v[64:67]
    ds_read_b64_tr_b16 a[144:145], v11 offset:32768
    v_mfma_f32_16x16x32_bf16 v[68:71], a[116:119], v[192:195], v[68:71]
    v_mfma_f32_16x16x32_bf16 v[72:75], a[120:123], v[192:195], v[72:75]
    ds_read_b64_tr_b16 a[146:147], v11 offset:33280
    ds_read_b64_tr_b16 a[148:149], v11 offset:32776
    v_mfma_f32_16x16x32_bf16 v[76:79], a[124:127], v[192:195], v[76:79]
    s_waitcnt vmcnt(28)
    v_mfma_f32_16x16x32_bf16 v[80:83], a[112:115], v[196:199], v[80:83]
    ds_read_b64_tr_b16 a[150:151], v11 offset:33288
    ds_read_b64_tr_b16 a[152:153], v12 offset:32768
    v_mfma_f32_16x16x32_bf16 v[84:87], a[116:119], v[196:199], v[84:87]
    v_mfma_f32_16x16x32_bf16 v[88:91], a[120:123], v[196:199], v[88:91]
    ds_read_b64_tr_b16 a[154:155], v12 offset:33280
    ds_read_b64_tr_b16 a[156:157], v12 offset:32776
    v_mfma_f32_16x16x32_bf16 v[92:95], a[124:127], v[196:199], v[92:95]
    s_waitcnt vmcnt(27)
    v_mfma_f32_16x16x32_bf16 v[96:99], a[112:115], v[200:203], v[96:99]
    ds_read_b64_tr_b16 a[158:159], v12 offset:33288
    ds_read_b64_tr_b16 a[160:161], v11 offset:36864
    v_mfma_f32_16x16x32_bf16 v[100:103], a[116:119], v[200:203], v[100:103]
    v_mfma_f32_16x16x32_bf16 v[104:107], a[120:123], v[200:203], v[104:107]
    ds_read_b64_tr_b16 a[162:163], v11 offset:37376
    ds_read_b64_tr_b16 a[164:165], v11 offset:36872
    v_mfma_f32_16x16x32_bf16 v[108:111], a[124:127], v[200:203], v[108:111]
    s_waitcnt vmcnt(26)
    v_mfma_f32_16x16x32_bf16 v[112:115], a[112:115], v[204:207], v[112:115]
    ds_read_b64_tr_b16 a[166:167], v11 offset:37384
    ds_read_b64_tr_b16 a[168:169], v12 offset:36864
    v_mfma_f32_16x16x32_bf16 v[116:119], a[116:119], v[204:207], v[116:119]
    v_mfma_f32_16x16x32_bf16 v[120:123], a[120:123], v[204:207], v[120:123]
    ds_read_b64_tr_b16 a[170:171], v12 offset:37376
    ds_read_b64_tr_b16 a[172:173], v12 offset:36872
    v_mfma_f32_16x16x32_bf16 v[124:127], a[124:127], v[204:207], v[124:127]
    s_waitcnt vmcnt(1)
    v_and_b32 v40, s85, v40
    v_cmp_ne_u32 vcc, s85, v40
    s_nop 0
    s_cmp_eq_u64 vcc, 0
    s_cbranch_scc1 POLLD_17
    s_mov_b32 s72, 30000
POLL_16:
    buffer_load_dword v63, v39, s[36:39], s95 offen sc1
    s_waitcnt vmcnt(0)
    v_and_b32 v63, s85, v63
    v_cmp_ne_u32 vcc, s85, v63
    s_nop 0
    s_cmp_eq_u64 vcc, 0
    s_cbranch_scc1 POLLD_17
    s_sub_u32 s72, s72, 1
    s_cbranch_scc0 POLL_16
POLLD_17:
    v_mfma_f32_16x16x32_bf16 v[64:67], a[128:131], v[208:211], v[64:67]
    ds_read_b64_tr_b16 a[174:175], v12 offset:37384
    v_mfma_f32_16x16x32_bf16 v[68:71], a[132:135], v[208:211], v[68:71]
    buffer_load_dwordx4 v[128:131], v1, s[36:39], s40 offen offset:2048 sc1
    v_mfma_f32_16x16x32_bf16 v[72:75], a[136:139], v[208:211], v[72:75]
    v_mfma_f32_16x16x32_bf16 v[76:79], a[140:143], v[208:211], v[76:79]
    buffer_load_dwordx4 v[132:135], v3, s[36:39], s40 offen offset:2048 sc1
    v_mfma_f32_16x16x32_bf16 v[80:83], a[128:131], v[212:215], v[80:83]
    v_mfma_f32_16x16x32_bf16 v[84:87], a[132:135], v[212:215], v[84:87]
    buffer_load_dwordx4 v[136:139], v4, s[36:39], s40 offen offset:2048 sc1
    v_mfma_f32_16x16x32_bf16 v[88:91], a[136:139], v[212:215], v[88:91]
    v_mfma_f32_16x16x32_bf16 v[92:95], a[140:143], v[212:215], v[92:95]
    buffer_load_dwordx4 v[144:147], v1, s[36:39], s41 offen offset:2048 sc1
    v_mfma_f32_16x16x32_bf16 v[96:99], a[128:131], v[216:219], v[96:99]
    v_mfma_f32_16x16x32_bf16 v[100:103], a[132:135], v[216:219], v[100:103]
    buffer_load_dwordx4 v[148:151], v3, s[36:39], s41 offen offset:2048 sc1
    v_mfma_f32_16x16x32_bf16 v[104:107], a[136:139], v[216:219], v[104:107]
    v_mfma_f32_16x16x32_bf16 v[108:111], a[140:143], v[216:219], v[108:111]
    buffer_load_dwordx4 v[152:155], v4, s[36:39], s41 offen offset:2048 sc1
    v_mfma_f32_16x16x32_bf16 v[112:115], a[128:131], v[220:223], v[112:115]
    v_mfma_f32_16x16x32_bf16 v[116:119], a[132:135], v[220:223], v[116:119]
    buffer_load_dwordx4 v[160:163], v1, s[36:39], s42 offen offset:2048 sc1
    v_mfma_f32_16x16x32_bf16 v[120:123], a[136:139], v[220:223], v[120:123]
    v_mfma_f32_16x16x32_bf16 v[124:127], a[140:143], v[220:223], v[124:127]
    buffer_load_dwordx4 v[164:167], v3, s[36:39], s42 offen offset:2048 sc1
    v_lshrrev_b32 v62, 2, v0
    v_mul_u32_u24 v62, 3072, v62
    v_and_b32 v63, 3, v0
    v_lshl_add_u32 v62, v63, 7, v62
    s_add_u32 s60, s99, 2048
    s_mov_b64 exec, 65535
    buffer_load_dword a224, v62, s[8:11], s60 offen
    s_mov_b64 exec, -1
    s_waitcnt lgkmcnt(0)
    v_mfma_f32_16x16x32_bf16 v[64:67], a[144:147], v[224:227], v[64:67]
    ds_read_b64_tr_b16 a[176:177], v15 offset:0
    v_mfma_f32_16x16x32_bf16 v[68:71], a[148:151], v[224:227], v[68:71]
    buffer_load_dwordx4 v[168:171], v4, s[36:39], s42 offen offset:2048 sc1
    v_mfma_f32_16x16x32_bf16 v[72:75], a[152:155], v[224:227], v[72:75]
    ds_read_b64_tr_b16 a[178:179], v15 offset:512
    ds_read_b64_tr_b16 a[180:181], v15 offset:8
    v_mfma_f32_16x16x32_bf16 v[76:79], a[156:159], v[224:227], v[76:79]
    buffer_load_dwordx4 v[176:179], v1, s[36:39], s43 offen offset:2048 sc1
    v_mfma_f32_16x16x32_bf16 v[80:83], a[144:147], v[228:231], v[80:83]
    ds_read_b64_tr_b16 a[182:183], v15 offset:520
    ds_read_b64_tr_b16 a[184:185], v16 offset:0
    v_mfma_f32_16x16x32_bf16 v[84:87], a[148:151], v[228:231], v[84:87]
    buffer_load_dwordx4 v[180:183], v3, s[36:39], s43 offen offset:2048 sc1
    v_mfma_f32_16x16x32_bf16 v[88:91], a[152:155], v[228:231], v[88:91]
    ds_read_b64_tr_b16 a[186:187], v16 offset:512
    ds_read_b64_tr_b16 a[188:189], v16 offset:8
    v_mfma_f32_16x16x32_bf16 v[92:95], a[156:159], v[228:231], v[92:95]
    buffer_load_dwordx4 v[184:187], v4, s[36:39], s43 offen offset:2048 sc1
    v_mfma_f32_16x16x32_bf16 v[96:99], a[144:147], v[232:235], v[96:99]
    ds_read_b64_tr_b16 a[190:191], v16 offset:520
    ds_read_b64_tr_b16 a[192:193], v15 offset:4096
    v_mfma_f32_16x16x32_bf16 v[100:103], a[148:151], v[232:235], v[100:103]
    v_mfma_f32_16x16x32_bf16 v[104:107], a[152:155], v[232:235], v[104:107]
    ds_read_b64_tr_b16 a[194:195], v15 offset:4608
    ds_read_b64_tr_b16 a[196:197], v15 offset:4104
    v_mfma_f32_16x16x32_bf16 v[108:111], a[156:159], v[232:235], v[108:111]
    v_mfma_f32_16x16x32_bf16 v[112:115], a[144:147], v[236:239], v[112:115]
    ds_read_b64_tr_b16 a[198:199], v15 offset:4616
    ds_read_b64_tr_b16 a[200:201], v16 offset:4096
    v_mfma_f32_16x16x32_bf16 v[116:119], a[148:151], v[236:239], v[116:119]
    v_mfma_f32_16x16x32_bf16 v[120:123], a[152:155], v[236:239], v[120:123]
    ds_read_b64_tr_b16 a[202:203], v16 offset:4608
    ds_read_b64_tr_b16 a[204:205], v16 offset:4104
    v_mfma_f32_16x16x32_bf16 v[124:127], a[156:159], v[236:239], v[124:127]
    v_lshrrev_b32 v62, 2, v0
    v_mul_u32_u24 v62, 3072, v62
    v_and_b32 v63, 3, v0
    v_lshl_add_u32 v62, v63, 7, v62
    s_add_u32 s60, s99, 0
    s_mov_b64 exec, 65535
    buffer_load_dword a224, v62, s[8:11], s60 offen
    s_mov_b64 exec, -1
    v_mfma_f32_16x16x32_bf16 v[64:67], a[160:163], v[240:243], v[64:67]
    ds_read_b64_tr_b16 a[206:207], v16 offset:4616
    v_mfma_f32_16x16x32_bf16 v[68:71], a[164:167], v[240:243], v[68:71]
    v_mfma_f32_16x16x32_bf16 v[72:75], a[168:171], v[240:243], v[72:75]
    ds_read_b64_tr_b16 a[208:209], v13 offset:32768
    ds_read_b64_tr_b16 a[210:211], v13 offset:33280
    v_mfma_f32_16x16x32_bf16 v[76:79], a[172:175], v[240:243], v[76:79]
    v_mfma_f32_16x16x32_bf16 v[80:83], a[160:163], v[244:247], v[80:83]
    ds_read_b64_tr_b16 a[212:213], v13 offset:32776
    ds_read_b64_tr_b16 a[214:215], v13 offset:33288
    v_mfma_f32_16x16x32_bf16 v[84:87], a[164:167], v[244:247], v[84:87]
    v_mfma_f32_16x16x32_bf16 v[88:91], a[168:171], v[244:247], v[88:91]
    ds_read_b64_tr_b16 a[216:217], v14 offset:32768
    ds_read_b64_tr_b16 a[218:219], v14 offset:33280
    v_mfma_f32_16x16x32_bf16 v[92:95], a[172:175], v[244:247], v[92:95]
    v_mfma_f32_16x16x32_bf16 v[96:99], a[160:163], v[248:251], v[96:99]
    ds_read_b64_tr_b16 a[220:221], v14 offset:32776
    ds_read_b64_tr_b16 a[222:223], v14 offset:33288
    v_mfma_f32_16x16x32_bf16 v[100:103], a[164:167], v[248:251], v[100:103]
    v_mfma_f32_16x16x32_bf16 v[104:107], a[168:171], v[248:251], v[104:107]
    v_mfma_f32_16x16x32_bf16 v[108:111], a[172:175], v[248:251], v[108:111]
    v_mfma_f32_16x16x32_bf16 v[112:115], a[160:163], v[252:255], v[112:115]
    v_mfma_f32_16x16x32_bf16 v[116:119], a[164:167], v[252:255], v[116:119]
    v_mfma_f32_16x16x32_bf16 v[120:123], a[168:171], v[252:255], v[120:123]
    v_mfma_f32_16x16x32_bf16 v[124:127], a[172:175], v[252:255], v[124:127]
    s_waitcnt lgkmcnt(0)
    s_waitcnt vmcnt(13)
    v_mfma_f32_16x16x32_bf16 v[64:67], a[176:179], v[128:131], v[64:67]
    v_mfma_f32_16x16x32_bf16 v[68:71], a[180:183], v[128:131], v[68:71]
    s_add_u32 m0, s58, 0
    s_add_u32 s60, s80, 1024
    buffer_load_dwordx4 v17, s[8:11], s60 offen lds
    v_mfma_f32_16x16x32_bf16 v[72:75], a[184:187], v[128:131], v[72:75]
    v_mfma_f32_16x16x32_bf16 v[76:79], a[188:191], v[128:131], v[76:79]
    s_add_u32 m0, s58, 1024
    s_add_u32 s60, s80, 50176
    buffer_load_dwordx4 v17, s[8:11], s60 offen lds
    s_waitcnt vmcnt(14)
    v_mfma_f32_16x16x32_bf16 v[64:67], a[192:195], v[132:135], v[64:67]
    v_mfma_f32_16x16x32_bf16 v[68:71], a[196:199], v[132:135], v[68:71]
    s_add_u32 m0, s58, 2048
    s_add_u32 s60, s80, 99328
    buffer_load_dwordx4 v17, s[8:11], s60 offen lds
    v_mfma_f32_16x16x32_bf16 v[72:75], a[200:203], v[132:135], v[72:75]
    v_mfma_f32_16x16x32_bf16 v[76:79], a[204:207], v[132:135], v[76:79]
    s_waitcnt vmcnt(14)
    v_mfma_f32_16x16x32_bf16 v[64:67], a[208:211], v[136:139], v[64:67]
    v_mfma_f32_16x16x32_bf16 v[68:71], a[212:215], v[136:139], v[68:71]
    s_add_u32 m0, s58, 3072
    s_add_u32 s60, s80, 148480
    buffer_load_dwordx4 v17, s[8:11], s60 offen lds
    v_mfma_f32_16x16x32_bf16 v[72:75], a[216:219], v[136:139], v[72:75]
    v_mfma_f32_16x16x32_bf16 v[76:79], a[220:223], v[136:139], v[76:79]
    s_waitcnt vmcnt(14)
    v_mfma_f32_16x16x32_bf16 v[80:83], a[176:179], v[144:147], v[80:83]
    v_mfma_f32_16x16x32_bf16 v[84:87], a[180:183], v[144:147], v[84:87]
    s_add_u32 m0, s58, 4096
    s_add_u32 s60, s80, 197632
    buffer_load_dwordx4 v17, s[8:11], s60 offen lds
    v_mfma_f32_16x16x32_bf16 v[88:91], a[184:187], v[144:147], v[88:91]
    v_mfma_f32_16x16x32_bf16 v[92:95], a[188:191], v[144:147], v[92:95]
    s_add_u32 m0, s58, 5120
    s_add_u32 s60, s80, 246784
    buffer_load_dwordx4 v17, s[8:11], s60 offen lds
    s_waitcnt vmcnt(15)
    v_mfma_f32_16x16x32_bf16 v[80:83], a[192:195], v[148:151], v[80:83]
    v_mfma_f32_16x16x32_bf16 v[84:87], a[196:199], v[148:151], v[84:87]
    s_add_u32 m0, s58, 6144
    s_add_u32 s60, s80, 295936
    buffer_load_dwordx4 v17, s[8:11], s60 offen lds
    v_mfma_f32_16x16x32_bf16 v[88:91], a[200:203], v[148:151], v[88:91]
    v_mfma_f32_16x16x32_bf16 v[92:95], a[204:207], v[148:151], v[92:95]
    ds_write_b128 v61, v[64:67] offset:0
    ds_write_b128 v61, v[68:71] offset:1024
    s_waitcnt vmcnt(15)
    v_mfma_f32_16x16x32_bf16 v[80:83], a[208:211], v[152:155], v[80:83]
    v_mfma_f32_16x16x32_bf16 v[84:87], a[212:215], v[152:155], v[84:87]
    s_add_u32 m0, s58, 7168
    s_add_u32 s60, s80, 345088
    buffer_load_dwordx4 v17, s[8:11], s60 offen lds
    v_mfma_f32_16x16x32_bf16 v[88:91], a[216:219], v[152:155], v[88:91]
    v_mfma_f32_16x16x32_bf16 v[92:95], a[220:223], v[152:155], v[92:95]
    ds_write_b128 v61, v[72:75] offset:2048
    ds_write_b128 v61, v[76:79] offset:3072
    s_waitcnt vmcnt(15)
    v_mfma_f32_16x16x32_bf16 v[96:99], a[176:179], v[160:163], v[96:99]
    v_mfma_f32_16x16x32_bf16 v[100:103], a[180:183], v[160:163], v[100:103]
    v_mfma_f32_16x16x32_bf16 v[104:107], a[184:187], v[160:163], v[104:107]
    v_mfma_f32_16x16x32_bf16 v[108:111], a[188:191], v[160:163], v[108:111]
    s_waitcnt vmcnt(14)
    v_mfma_f32_16x16x32_bf16 v[96:99], a[192:195], v[164:167], v[96:99]
    v_mfma_f32_16x16x32_bf16 v[100:103], a[196:199], v[164:167], v[100:103]
    v_mfma_f32_16x16x32_bf16 v[104:107], a[200:203], v[164:167], v[104:107]
    v_mfma_f32_16x16x32_bf16 v[108:111], a[204:207], v[164:167], v[108:111]
    ds_write_b128 v61, v[80:83] offset:4096
    ds_write_b128 v61, v[84:87] offset:5120
    s_waitcnt vmcnt(12)
    v_mfma_f32_16x16x32_bf16 v[96:99], a[208:211], v[168:171], v[96:99]
    v_mfma_f32_16x16x32_bf16 v[100:103], a[212:215], v[168:171], v[100:103]
    v_mfma_f32_16x16x32_bf16 v[104:107], a[216:219], v[168:171], v[104:107]
    v_mfma_f32_16x16x32_bf16 v[108:111], a[220:223], v[168:171], v[108:111]
    ds_write_b128 v61, v[88:91] offset:6144
    ds_write_b128 v61, v[92:95] offset:7168
    s_waitcnt vmcnt(11)
    v_mfma_f32_16x16x32_bf16 v[112:115], a[176:179], v[176:179], v[112:115]
    v_mfma_f32_16x16x32_bf16 v[116:119], a[180:183], v[176:179], v[116:119]
    v_mfma_f32_16x16x32_bf16 v[120:123], a[184:187], v[176:179], v[120:123]
    v_mfma_f32_16x16x32_bf16 v[124:127], a[188:191], v[176:179], v[124:127]
    s_waitcnt vmcnt(10)
    v_mfma_f32_16x16x32_bf16 v[112:115], a[192:195], v[180:183], v[112:115]
    v_mfma_f32_16x16x32_bf16 v[116:119], a[196:199], v[180:183], v[116:119]
    v_mfma_f32_16x16x32_bf16 v[120:123], a[200:203], v[180:183], v[120:123]
    v_mfma_f32_16x16x32_bf16 v[124:127], a[204:207], v[180:183], v[124:127]
    ds_write_b128 v60, v[96:99] offset:0
    ds_write_b128 v60, v[100:103] offset:1024
    s_waitcnt vmcnt(9)
    v_mfma_f32_16x16x32_bf16 v[112:115], a[208:211], v[184:187], v[112:115]
    v_mfma_f32_16x16x32_bf16 v[116:119], a[212:215], v[184:187], v[116:119]
    v_mfma_f32_16x16x32_bf16 v[120:123], a[216:219], v[184:187], v[120:123]
    v_mfma_f32_16x16x32_bf16 v[124:127], a[220:223], v[184:187], v[124:127]
    ds_write_b128 v60, v[104:107] offset:2048
    ds_write_b128 v60, v[108:111] offset:3072
    s_waitcnt lgkmcnt(0)
    s_barrier
    ds_read_b128 v[128:131], v57 offset:0
    ds_read_b128 v[132:135], v57 offset:1024
    ds_read_b128 v[136:139], v57 offset:2048
    ds_read_b128 v[140:143], v57 offset:3072
    ds_read_b128 v[144:147], v58 offset:0
    ds_read_b128 v[148:151], v58 offset:1024
    ds_read_b128 v[152:155], v58 offset:2048
    ds_read_b128 v[156:159], v58 offset:3072
    ds_read_b128 v[160:163], v59 offset:0
    ds_read_b128 v[164:167], v59 offset:1024
    ds_read_b128 v[168:171], v59 offset:2048
    ds_read_b128 v[172:175], v59 offset:3072
    s_waitcnt lgkmcnt(8)
    v_pk_add_f32 v[112:113], v[112:113], v[128:129] op_sel:[0,0] op_sel_hi:[1,1]
    v_pk_add_f32 v[114:115], v[114:115], v[130:131] op_sel:[0,0] op_sel_hi:[1,1]
    v_pk_add_f32 v[116:117], v[116:117], v[132:133] op_sel:[0,0] op_sel_hi:[1,1]
    v_pk_add_f32 v[118:119], v[118:119], v[134:135] op_sel:[0,0] op_sel_hi:[1,1]
    v_pk_add_f32 v[120:121], v[120:121], v[136:137] op_sel:[0,0] op_sel_hi:[1,1]
    v_pk_add_f32 v[122:123], v[122:123], v[138:139] op_sel:[0,0] op_sel_hi:[1,1]
    v_pk_add_f32 v[124:125], v[124:125], v[140:141] op_sel:[0,0] op_sel_hi:[1,1]
    v_pk_add_f32 v[126:127], v[126:127], v[142:143] op_sel:[0,0] op_sel_hi:[1,1]
    s_waitcnt lgkmcnt(4)
    v_pk_add_f32 v[112:113], v[112:113], v[144:145] op_sel:[0,0] op_sel_hi:[1,1]
    v_pk_add_f32 v[114:115], v[114:115], v[146:147] op_sel:[0,0] op_sel_hi:[1,1]
    v_pk_add_f32 v[116:117], v[116:117], v[148:149] op_sel:[0,0] op_sel_hi:[1,1]
    v_pk_add_f32 v[118:119], v[118:119], v[150:151] op_sel:[0,0] op_sel_hi:[1,1]
    v_pk_add_f32 v[120:121], v[120:121], v[152:153] op_sel:[0,0] op_sel_hi:[1,1]
    v_pk_add_f32 v[122:123], v[122:123], v[154:155] op_sel:[0,0] op_sel_hi:[1,1]
    v_pk_add_f32 v[124:125], v[124:125], v[156:157] op_sel:[0,0] op_sel_hi:[1,1]
    v_pk_add_f32 v[126:127], v[126:127], v[158:159] op_sel:[0,0] op_sel_hi:[1,1]
    s_waitcnt lgkmcnt(0)
    v_pk_add_f32 v[112:113], v[112:113], v[160:161] op_sel:[0,0] op_sel_hi:[1,1]
    v_cvt_pk_bf16_f32 v20, v112, v113
    v_pk_add_f32 v[114:115], v[114:115], v[162:163] op_sel:[0,0] op_sel_hi:[1,1]
    v_cvt_pk_bf16_f32 v21, v114, v115
    v_pk_add_f32 v[116:117], v[116:117], v[164:165] op_sel:[0,0] op_sel_hi:[1,1]
    v_cvt_pk_bf16_f32 v22, v116, v117
    v_pk_add_f32 v[118:119], v[118:119], v[166:167] op_sel:[0,0] op_sel_hi:[1,1]
    v_cvt_pk_bf16_f32 v23, v118, v119
    buffer_store_dwordx4 v[20:23], v56, s[44:47], s89 offen sc1
    s_add_u32 s89, s89, s88
    v_pk_add_f32 v[120:121], v[120:121], v[168:169] op_sel:[0,0] op_sel_hi:[1,1]
    v_cvt_pk_bf16_f32 v24, v120, v121
    v_pk_add_f32 v[122:123], v[122:123], v[170:171] op_sel:[0,0] op_sel_hi:[1,1]
    v_cvt_pk_bf16_f32 v25, v122, v123
    v_pk_add_f32 v[124:125], v[124:125], v[172:173] op_sel:[0,0] op_sel_hi:[1,1]
    v_cvt_pk_bf16_f32 v26, v124, v125
    v_pk_add_f32 v[126:127], v[126:127], v[174:175] op_sel:[0,0] op_sel_hi:[1,1]
    v_cvt_pk_bf16_f32 v27, v126, v127
    buffer_store_dwordx4 v[24:27], v56, s[44:47], s89 offen sc1
    v_dot2_f32_bf16 v40, v20, s75, 0
    v_dot2_f32_bf16 v41, v20, v20, 0
    v_dot2_f32_bf16 v40, v21, s75, v40
    v_dot2_f32_bf16 v41, v21, v21, v41
    v_dot2_f32_bf16 v40, v22, s75, v40
    v_dot2_f32_bf16 v41, v22, v22, v41
    v_dot2_f32_bf16 v40, v23, s75, v40
    v_dot2_f32_bf16 v41, v23, v23, v41
    v_dot2_f32_bf16 v40, v24, s75, v40
    v_dot2_f32_bf16 v41, v24, v24, v41
    v_dot2_f32_bf16 v40, v25, s75, v40
    v_dot2_f32_bf16 v41, v25, v25, v41
    v_dot2_f32_bf16 v40, v26, s75, v40
    v_dot2_f32_bf16 v41, v26, v26, v41
    v_dot2_f32_bf16 v40, v27, s75, v40
    v_dot2_f32_bf16 v41, v27, v27, v41
    s_nop 1
    v_mov_b32 v42, v40
    v_mov_b32 v43, v41
    s_nop 0
    v_permlane16_swap_b32 v40, v42
    v_permlane16_swap_b32 v41, v43
    v_add_f32 v40, v40, v42
    v_add_f32 v41, v41, v43
    v_mov_b32 v42, v40
    v_mov_b32 v43, v41
    s_nop 0
    v_permlane32_swap_b32 v40, v42
    v_permlane32_swap_b32 v41, v43
    v_add_f32 v40, v40, v42
    v_add_f32 v41, v41, v43
    s_mov_b64 exec, 0xffff
    buffer_store_dwordx2 v[40:41], v29, s[36:39], s66 offen sc1
    s_mov_b64 exec, -1
    s_add_u32 m0, s58, 32768
    s_add_u32 s60, s80, 2048
    buffer_load_dwordx4 v17, s[8:11], s60 offen lds
    s_add_u32 m0, s58, 33792
    s_add_u32 s60, s80, 51200
    buffer_load_dwordx4 v17, s[8:11], s60 offen lds
    s_add_u32 m0, s58, 34816
    s_add_u32 s60, s80, 100352
    buffer_load_dwordx4 v17, s[8:11], s60 offen lds
    s_add_u32 m0, s58, 35840
    s_add_u32 s60, s80, 149504
    buffer_load_dwordx4 v17, s[8:11], s60 offen lds
    s_add_u32 m0, s58, 36864
    s_add_u32 s60, s80, 198656
    buffer_load_dwordx4 v17, s[8:11], s60 offen lds
    s_add_u32 m0, s58, 37888
    s_add_u32 s60, s80, 247808
    buffer_load_dwordx4 v17, s[8:11], s60 offen lds
    s_add_u32 m0, s58, 38912
    s_add_u32 s60, s80, 296960
    buffer_load_dwordx4 v17, s[8:11], s60 offen lds
    s_add_u32 m0, s58, 39936
    s_add_u32 s60, s80, 346112
    buffer_load_dwordx4 v17, s[8:11], s60 offen lds
    s_mov_b32 s51, 1
    s_add_u32 s84, s84, 128
    s_waitcnt vmcnt(0)
    s_barrier
    s_mov_b32 s101, 50
REDO_18:
    s_lshl_b32 s90, s56, 14
    s_add_u32 s90, s90, 10485760
    s_lshl_b32 s61, s56, 10
    s_add_u32 s61, s61, 1310720
    s_mov_b32 s72, 20000
PST_19:
    buffer_load_dwordx2 v[112:113], v29, s[36:39], s61 offen offset:0 sc1
    buffer_load_dwordx2 v[114:115], v29, s[36:39], s61 offen offset:128 sc1
    buffer_load_dwordx2 v[116:117], v29, s[36:39], s61 offen offset:1024 sc1
    buffer_load_dwordx2 v[118:119], v29, s[36:39], s61 offen offset:1152 sc1
    s_waitcnt vmcnt(0)
    v_max3_u32 v63, v112, v114, v116
    v_max_u32 v63, v63, v118
    v_cmp_eq_u32 vcc, -1, v63
    s_nop 0
    s_cmp_eq_u64 vcc, 0
    s_cbranch_scc1 PSTD_20
    s_sub_u32 s72, s72, 1
    s_cbranch_scc0 PST_19
PSTD_20:
    v_mov_b32 v61, 0
    s_mov_b32 s63, s90
    s_and_b32 s64, s53, 3
    s_lshl_b32 s64, s64, 12
    s_add_u32 s90, s63, s64
    buffer_load_dwordx4 v[128:131], v1, s[36:39], s90 offen offset:0 sc1
    buffer_load_dwordx4 v[132:135], v2, s[36:39], s90 offen offset:0 sc1
    buffer_load_dwordx4 v[136:139], v1, s[36:39], s90 offen offset:1024 sc1
    buffer_load_dwordx4 v[140:143], v2, s[36:39], s90 offen offset:1024 sc1
    buffer_load_dwordx4 v[144:147], v1, s[36:39], s90 offen offset:2048 sc1
    buffer_load_dwordx4 v[148:151], v2, s[36:39], s90 offen offset:2048 sc1
    buffer_load_dwordx4 v[152:155], v1, s[36:39], s90 offen offset:3072 sc1
    buffer_load_dwordx4 v[156:159], v2, s[36:39], s90 offen offset:3072 sc1
    s_add_u32 s64, s64, 4096
    s_and_b32 s64, s64, 0x3fff
    s_add_u32 s90, s63, s64
    buffer_load_dwordx4 v[160:163], v1, s[36:39], s90 offen offset:0 sc1
    buffer_load_dwordx4 v[164:167], v2, s[36:39], s90 offen offset:0 sc1
    buffer_load_dwordx4 v[168:171], v1, s[36:39], s90 offen offset:1024 sc1
    buffer_load_dwordx4 v[172:175], v2, s[36:39], s90 offen offset:1024 sc1
    buffer_load_dwordx4 v[176:179], v1, s[36:39], s90 offen offset:2048 sc1
    buffer_load_dwordx4 v[180:183], v2, s[36:39], s90 offen offset:2048 sc1
    buffer_load_dwordx4 v[184:187], v1, s[36:39], s90 offen offset:3072 sc1
    buffer_load_dwordx4 v[188:191], v2, s[36:39], s90 offen offset:3072 sc1
    ds_read_b64_tr_b16 a[0:1], v5 offset:0
    ds_read_b64_tr_b16 a[2:3], v5 offset:256
    ds_read_b64_tr_b16 a[4:5], v6 offset:0
    ds_read_b64_tr_b16 a[6:7], v6 offset:256
    ds_read_b64_tr_b16 a[8:9], v5 offset:32768
    ds_read_b64_tr_b16 a[10:11], v5 offset:33024
    ds_read_b64_tr_b16 a[12:13], v6 offset:32768
    ds_read_b64_tr_b16 a[14:15], v6 offset:33024
    ds_read_b64_tr_b16 a[16:17], v5 offset:2048
    ds_read_b64_tr_b16 a[18:19], v5 offset:2304
    ds_read_b64_tr_b16 a[20:21], v6 offset:2048
    ds_read_b64_tr_b16 a[22:23], v6 offset:2304
    ds_read_b64_tr_b16 a[24:25], v5 offset:34816
    ds_read_b64_tr_b16 a[26:27], v5 offset:35072
    ds_read_b64_tr_b16 a[28:29], v6 offset:34816
    ds_read_b64_tr_b16 a[30:31], v6 offset:35072
    s_waitcnt vmcnt(14) lgkmcnt(8)
    v_mfma_f32_16x16x32_bf16 v[64:67], v[128:131], a[0:3], 0
    ds_read_b64_tr_b16 a[32:33], v5 offset:4096
    v_add_f32 v44, v112, v114
    v_mfma_f32_16x16x32_bf16 v[80:83], v[132:135], a[0:3], 0
    ds_read_b64_tr_b16 a[34:35], v5 offset:4352
    s_add_u32 s64, s64, 4096
    s_and_b32 s64, s64, 0x3fff
    s_add_u32 s90, s63, s64
    buffer_load_dwordx4 v[192:195], v1, s[36:39], s90 offen offset:0 sc1
    v_mfma_f32_16x16x32_bf16 v[68:71], v[128:131], a[4:7], 0
    ds_read_b64_tr_b16 a[36:37], v6 offset:4096
    v_add_f32 v45, v113, v115
    v_mfma_f32_16x16x32_bf16 v[84:87], v[132:135], a[4:7], 0
    ds_read_b64_tr_b16 a[38:39], v6 offset:4352
    buffer_load_dwordx4 v[196:199], v2, s[36:39], s90 offen offset:0 sc1
    v_mfma_f32_16x16x32_bf16 v[72:75], v[128:131], a[8:11], 0
    ds_read_b64_tr_b16 a[40:41], v5 offset:36864
    v_add_f32 v46, v116, v118
    v_mfma_f32_16x16x32_bf16 v[88:91], v[132:135], a[8:11], 0
    ds_read_b64_tr_b16 a[42:43], v5 offset:37120
    buffer_load_dwordx4 v[200:203], v1, s[36:39], s90 offen offset:1024 sc1
    v_mfma_f32_16x16x32_bf16 v[76:79], v[128:131], a[12:15], 0
    ds_read_b64_tr_b16 a[44:45], v6 offset:36864
    v_add_f32 v47, v117, v119
    v_mfma_f32_16x16x32_bf16 v[92:95], v[132:135], a[12:15], 0
    ds_read_b64_tr_b16 a[46:47], v6 offset:37120
    buffer_load_dwordx4 v[204:207], v2, s[36:39], s90 offen offset:1024 sc1
    v_max3_u32 v61, v61, v128, v132
    v_lshrrev_b32 v62, 3, v0
    v_mul_u32_u24 v62, 1024, v62
    v_and_b32 v63, 7, v0
    v_lshl_add_u32 v62, v63, 7, v62
    s_add_u32 s60, s86, 0
    s_mov_b32 exec_hi, 0
    buffer_load_dword a224, v62, s[12:15], s60 offen
    s_mov_b64 exec, -1
    s_waitcnt vmcnt(17) lgkmcnt(8)
    v_mfma_f32_16x16x32_bf16 v[64:67], v[136:139], a[16:19], v[64:67]
    ds_read_b64_tr_b16 a[0:1], v5 offset:6144
    v_mov_b32 v48, v44
    v_mfma_f32_16x16x32_bf16 v[80:83], v[140:143], a[16:19], v[80:83]
    ds_read_b64_tr_b16 a[2:3], v5 offset:6400
    buffer_load_dwordx4 v[208:211], v1, s[36:39], s90 offen offset:2048 sc1
    v_mfma_f32_16x16x32_bf16 v[68:71], v[136:139], a[20:23], v[68:71]
    ds_read_b64_tr_b16 a[4:5], v6 offset:6144
    v_mov_b32 v49, v45
    v_mfma_f32_16x16x32_bf16 v[84:87], v[140:143], a[20:23], v[84:87]
    ds_read_b64_tr_b16 a[6:7], v6 offset:6400
    buffer_load_dwordx4 v[212:215], v2, s[36:39], s90 offen offset:2048 sc1
    v_mfma_f32_16x16x32_bf16 v[72:75], v[136:139], a[24:27], v[72:75]
    ds_read_b64_tr_b16 a[8:9], v5 offset:38912
    v_mov_b32 v50, v46
    v_mfma_f32_16x16x32_bf16 v[88:91], v[140:143], a[24:27], v[88:91]
    ds_read_b64_tr_b16 a[10:11], v5 offset:39168
    buffer_load_dwordx4 v[216:219], v1, s[36:39], s90 offen offset:3072 sc1
    v_mfma_f32_16x16x32_bf16 v[76:79], v[136:139], a[28:31], v[76:79]
    ds_read_b64_tr_b16 a[12:13], v6 offset:38912
    v_mov_b32 v51, v47
    v_mfma_f32_16x16x32_bf16 v[92:95], v[140:143], a[28:31], v[92:95]
    ds_read_b64_tr_b16 a[14:15], v6 offset:39168
    buffer_load_dwordx4 v[220:223], v2, s[36:39], s90 offen offset:3072 sc1
    v_max3_u32 v61, v61, v136, v140
    s_waitcnt vmcnt(19) lgkmcnt(8)
    v_mfma_f32_16x16x32_bf16 v[64:67], v[144:147], a[32:35], v[64:67]
    ds_read_b64_tr_b16 a[16:17], v5 offset:8192
    v_permlane16_swap_b32 v44, v48
    v_mfma_f32_16x16x32_bf16 v[80:83], v[148:151], a[32:35], v[80:83]
    ds_read_b64_tr_b16 a[18:19], v5 offset:8448
    s_add_u32 s64, s64, 4096
    s_and_b32 s64, s64, 0x3fff
    s_add_u32 s90, s63, s64
    buffer_load_dwordx4 v[224:227], v1, s[36:39], s90 offen offset:0 sc1
    v_mfma_f32_16x16x32_bf16 v[68:71], v[144:147], a[36:39], v[68:71]
    ds_read_b64_tr_b16 a[20:21], v6 offset:8192
    v_permlane16_swap_b32 v45, v49
    v_mfma_f32_16x16x32_bf16 v[84:87], v[148:151], a[36:39], v[84:87]
    ds_read_b64_tr_b16 a[22:23], v6 offset:8448
    buffer_load_dwordx4 v[228:231], v2, s[36:39], s90 offen offset:0 sc1
    v_mfma_f32_16x16x32_bf16 v[72:75], v[144:147], a[40:43], v[72:75]
    ds_read_b64_tr_b16 a[24:25], v5 offset:40960
    v_permlane16_swap_b32 v46, v50
    v_mfma_f32_16x16x32_bf16 v[88:91], v[148:151], a[40:43], v[88:91]
    ds_read_b64_tr_b16 a[26:27], v5 offset:41216
    buffer_load_dwordx4 v[232:235], v1, s[36:39], s90 offen offset:1024 sc1
    v_mfma_f32_16x16x32_bf16 v[76:79], v[144:147], a[44:47], v[76:79]
    ds_read_b64_tr_b16 a[28:29], v6 offset:40960
    v_permlane16_swap_b32 v47, v51
    v_mfma_f32_16x16x32_bf16 v[92:95], v[148:151], a[44:47], v[92:95]
    ds_read_b64_tr_b16 a[30:31], v6 offset:41216
    buffer_load_dwordx4 v[236:239], v2, s[36:39], s90 offen offset:1024 sc1
    v_max3_u32 v61, v61, v144, v148
    s_waitcnt vmcnt(21) lgkmcnt(8)
    v_mfma_f32_16x16x32_bf16 v[64:67], v[152:155], a[0:3], v[64:67]
    ds_read_b64_tr_b16 a[32:33], v5 offset:10240
    v_add_f32 v44, v44, v48
    v_mfma_f32_16x16x32_bf16 v[80:83], v[156:159], a[0:3], v[80:83]
    ds_read_b64_tr_b16 a[34:35], v5 offset:10496
    buffer_load_dwordx4 v[240:243], v1, s[36:39], s90 offen offset:2048 sc1
    v_mfma_f32_16x16x32_bf16 v[68:71], v[152:155], a[4:7], v[68:71]
    ds_read_b64_tr_b16 a[36:37], v6 offset:10240
    v_add_f32 v45, v45, v49
    v_mfma_f32_16x16x32_bf16 v[84:87], v[156:159], a[4:7], v[84:87]
    ds_read_b64_tr_b16 a[38:39], v6 offset:10496
    buffer_load_dwordx4 v[244:247], v2, s[36:39], s90 offen offset:2048 sc1
    v_mfma_f32_16x16x32_bf16 v[72:75], v[152:155], a[8:11], v[72:75]
    ds_read_b64_tr_b16 a[40:41], v5 offset:43008
    v_add_f32 v46, v46, v50
    v_mfma_f32_16x16x32_bf16 v[88:91], v[156:159], a[8:11], v[88:91]
    ds_read_b64_tr_b16 a[42:43], v5 offset:43264
    buffer_load_dwordx4 v[248:251], v1, s[36:39], s90 offen offset:3072 sc1
    v_mfma_f32_16x16x32_bf16 v[76:79], v[152:155], a[12:15], v[76:79]
    ds_read_b64_tr_b16 a[44:45], v6 offset:43008
    v_add_f32 v47, v47, v51
    v_mfma_f32_16x16x32_bf16 v[92:95], v[156:159], a[12:15], v[92:95]
    ds_read_b64_tr_b16 a[46:47], v6 offset:43264
    buffer_load_dwordx4 v[252:255], v2, s[36:39], s90 offen offset:3072 sc1
    v_max3_u32 v61, v61, v152, v156
    s_waitcnt vmcnt(23) lgkmcnt(8)
    v_mfma_f32_16x16x32_bf16 v[64:67], v[160:163], a[16:19], v[64:67]
    ds_read_b64_tr_b16 a[0:1], v5 offset:12288
    v_mov_b32 v48, v44
    v_mfma_f32_16x16x32_bf16 v[80:83], v[164:167], a[16:19], v[80:83]
    ds_read_b64_tr_b16 a[2:3], v5 offset:12544
    s_add_u32 m0, s58, 65536
    s_add_u32 s60, s80, 0
    buffer_load_dwordx4 v17, s[8:11], s60 offen lds
    v_mfma_f32_16x16x32_bf16 v[68:71], v[160:163], a[20:23], v[68:71]
    ds_read_b64_tr_b16 a[4:5], v6 offset:12288
    v_mov_b32 v49, v45
    v_mfma_f32_16x16x32_bf16 v[84:87], v[164:167], a[20:23], v[84:87]
    ds_read_b64_tr_b16 a[6:7], v6 offset:12544
    s_add_u32 m0, s58, 66560
    s_add_u32 s60, s80, 49152
    buffer_load_dwordx4 v17, s[8:11], s60 offen lds
    v_mfma_f32_16x16x32_bf16 v[72:75], v[160:163], a[24:27], v[72:75]
    ds_read_b64_tr_b16 a[8:9], v5 offset:45056
    v_mov_b32 v50, v46
    v_mfma_f32_16x16x32_bf16 v[88:91], v[164:167], a[24:27], v[88:91]
    ds_read_b64_tr_b16 a[10:11], v5 offset:45312
    s_add_u32 m0, s58, 67584
    s_add_u32 s60, s80, 98304
    buffer_load_dwordx4 v17, s[8:11], s60 offen lds
    v_mfma_f32_16x16x32_bf16 v[76:79], v[160:163], a[28:31], v[76:79]
    ds_read_b64_tr_b16 a[12:13], v6 offset:45056
    v_mov_b32 v51, v47
    v_mfma_f32_16x16x32_bf16 v[92:95], v[164:167], a[28:31], v[92:95]
    ds_read_b64_tr_b16 a[14:15], v6 offset:45312
    s_add_u32 m0, s58, 68608
    s_add_u32 s60, s80, 147456
    buffer_load_dwordx4 v17, s[8:11], s60 offen lds
    v_max3_u32 v61, v61, v160, v164
    s_waitcnt vmcnt(25) lgkmcnt(8)
    v_mfma_f32_16x16x32_bf16 v[64:67], v[168:171], a[32:35], v[64:67]
    ds_read_b64_tr_b16 a[16:17], v5 offset:14336
    v_permlane32_swap_b32 v44, v48
    v_mfma_f32_16x16x32_bf16 v[80:83], v[172:175], a[32:35], v[80:83]
    ds_read_b64_tr_b16 a[18:19], v5 offset:14592
    s_add_u32 m0, s58, 69632
    s_add_u32 s60, s80, 196608
    buffer_load_dwordx4 v17, s[8:11], s60 offen lds
    v_mfma_f32_16x16x32_bf16 v[68:71], v[168:171], a[36:39], v[68:71]
    ds_read_b64_tr_b16 a[20:21], v6 offset:14336
    v_permlane32_swap_b32 v45, v49
    v_mfma_f32_16x16x32_bf16 v[84:87], v[172:175], a[36:39], v[84:87]
    ds_read_b64_tr_b16 a[22:23], v6 offset:14592
    s_add_u32 m0, s58, 70656
    s_add_u32 s60, s80, 245760
    buffer_load_dwordx4 v17, s[8:11], s60 offen lds
    v_mfma_f32_16x16x32_bf16 v[72:75], v[168:171], a[40:43], v[72:75]
    ds_read_b64_tr_b16 a[24:25], v5 offset:47104
    v_permlane32_swap_b32 v46, v50
    v_mfma_f32_16x16x32_bf16 v[88:91], v[172:175], a[40:43], v[88:91]
    ds_read_b64_tr_b16 a[26:27], v5 offset:47360
    s_add_u32 m0, s58, 71680
    s_add_u32 s60, s80, 294912
    buffer_load_dwordx4 v17, s[8:11], s60 offen lds
    v_mfma_f32_16x16x32_bf16 v[76:79], v[168:171], a[44:47], v[76:79]
    ds_read_b64_tr_b16 a[28:29], v6 offset:47104
    v_permlane32_swap_b32 v47, v51
    v_mfma_f32_16x16x32_bf16 v[92:95], v[172:175], a[44:47], v[92:95]
    ds_read_b64_tr_b16 a[30:31], v6 offset:47360
    s_add_u32 m0, s58, 72704
    s_add_u32 s60, s80, 344064
    buffer_load_dwordx4 v17, s[8:11], s60 offen lds
    v_max3_u32 v61, v61, v168, v172
    s_waitcnt vmcnt(27) lgkmcnt(8)
    v_mfma_f32_16x16x32_bf16 v[64:67], v[176:179], a[0:3], v[64:67]
    ds_read_b64_tr_b16 a[32:33], v5 offset:16384
    v_add_f32 v44, v44, v48
    v_mfma_f32_16x16x32_bf16 v[80:83], v[180:183], a[0:3], v[80:83]
    ds_read_b64_tr_b16 a[34:35], v5 offset:16640
    v_mfma_f32_16x16x32_bf16 v[68:71], v[176:179], a[4:7], v[68:71]
    ds_read_b64_tr_b16 a[36:37], v6 offset:16384
    v_add_f32 v45, v45, v49
    v_mfma_f32_16x16x32_bf16 v[84:87], v[180:183], a[4:7], v[84:87]
    ds_read_b64_tr_b16 a[38:39], v6 offset:16640
    v_add_f32 v46, v46, v50
    v_mfma_f32_16x16x32_bf16 v[72:75], v[176:179], a[8:11], v[72:75]
    ds_read_b64_tr_b16 a[40:41], v5 offset:49152
    v_add_f32 v47, v47, v51
    v_mfma_f32_16x16x32_bf16 v[88:91], v[180:183], a[8:11], v[88:91]
    ds_read_b64_tr_b16 a[42:43], v5 offset:49408
    v_mul_f32 v57, 0xbb000000, v44
    v_mfma_f32_16x16x32_bf16 v[76:79], v[176:179], a[12:15], v[76:79]
    ds_read_b64_tr_b16 a[44:45], v6 offset:49152
    v_mul_f32 v59, 0xbb000000, v46
    v_mfma_f32_16x16x32_bf16 v[92:95], v[180:183], a[12:15], v[92:95]
    ds_read_b64_tr_b16 a[46:47], v6 offset:49408
    v_mul_f32 v45, 0x3b000000, v45
    v_max3_u32 v61, v61, v176, v180
    s_waitcnt vmcnt(25) lgkmcnt(8)
    v_mfma_f32_16x16x32_bf16 v[64:67], v[184:187], a[16:19], v[64:67]
    ds_read_b64_tr_b16 a[0:1], v5 offset:18432
    v_mul_f32 v47, 0x3b000000, v47
    v_mfma_f32_16x16x32_bf16 v[80:83], v[188:191], a[16:19], v[80:83]
    ds_read_b64_tr_b16 a[2:3], v5 offset:18688
    v_fma_f32 v45, -v57, v57, v45
    v_mfma_f32_16x16x32_bf16 v[68:71], v[184:187], a[20:23], v[68:71]
    ds_read_b64_tr_b16 a[4:5], v6 offset:18432
    v_fma_f32 v47, -v59, v59, v47
    v_mfma_f32_16x16x32_bf16 v[84:87], v[188:191], a[20:23], v[84:87]
    ds_read_b64_tr_b16 a[6:7], v6 offset:18688
    v_max_f32 v45, 0, v45
    v_mfma_f32_16x16x32_bf16 v[72:75], v[184:187], a[24:27], v[72:75]
    ds_read_b64_tr_b16 a[8:9], v5 offset:51200
    v_max_f32 v47, 0, v47
    v_mfma_f32_16x16x32_bf16 v[88:91], v[188:191], a[24:27], v[88:91]
    ds_read_b64_tr_b16 a[10:11], v5 offset:51456
    v_add_f32 v45, 0x3727c5ac, v45
    v_mfma_f32_16x16x32_bf16 v[76:79], v[184:187], a[28:31], v[76:79]
    ds_read_b64_tr_b16 a[12:13], v6 offset:51200
    v_add_f32 v47, 0x3727c5ac, v47
    v_mfma_f32_16x16x32_bf16 v[92:95], v[188:191], a[28:31], v[92:95]
    ds_read_b64_tr_b16 a[14:15], v6 offset:51456
    v_rsq_f32 v56, v45
    v_max3_u32 v61, v61, v184, v188
    s_waitcnt vmcnt(23) lgkmcnt(8)
    v_mfma_f32_16x16x32_bf16 v[64:67], v[192:195], a[32:35], v[64:67]
    ds_read_b64_tr_b16 a[16:17], v5 offset:20480
    v_rsq_f32 v58, v47
    v_mfma_f32_16x16x32_bf16 v[80:83], v[196:199], a[32:35], v[80:83]
    ds_read_b64_tr_b16 a[18:19], v5 offset:20736
    ds_bpermute_b32 v96, v30, v56 offset:0
    v_mfma_f32_16x16x32_bf16 v[68:71], v[192:195], a[36:39], v[68:71]
    ds_read_b64_tr_b16 a[20:21], v6 offset:20480
    ds_bpermute_b32 v97, v30, v56 offset:4
    v_mfma_f32_16x16x32_bf16 v[84:87], v[196:199], a[36:39], v[84:87]
    ds_read_b64_tr_b16 a[22:23], v6 offset:20736
    ds_bpermute_b32 v98, v30, v56 offset:8
    v_mfma_f32_16x16x32_bf16 v[72:75], v[192:195], a[40:43], v[72:75]
    ds_read_b64_tr_b16 a[24:25], v5 offset:53248
    ds_bpermute_b32 v99, v30, v56 offset:12
    v_mfma_f32_16x16x32_bf16 v[88:91], v[196:199], a[40:43], v[88:91]
    ds_read_b64_tr_b16 a[26:27], v5 offset:53504
    ds_bpermute_b32 v100, v30, v58 offset:0
    v_mfma_f32_16x16x32_bf16 v[76:79], v[192:195], a[44:47], v[76:79]
    ds_read_b64_tr_b16 a[28:29], v6 offset:53248
    ds_bpermute_b32 v101, v30, v58 offset:4
    v_mfma_f32_16x16x32_bf16 v[92:95], v[196:199], a[44:47], v[92:95]
    ds_read_b64_tr_b16 a[30:31], v6 offset:53504
    ds_bpermute_b32 v102, v30, v58 offset:8
    v_max3_u32 v61, v61, v192, v196
    s_waitcnt vmcnt(21) lgkmcnt(15)
    v_mfma_f32_16x16x32_bf16 v[64:67], v[200:203], a[0:3], v[64:67]
    ds_read_b64_tr_b16 a[32:33], v5 offset:22528
    ds_bpermute_b32 v103, v30, v58 offset:12
    v_mfma_f32_16x16x32_bf16 v[80:83], v[204:207], a[0:3], v[80:83]
    ds_read_b64_tr_b16 a[34:35], v5 offset:22784
    ds_bpermute_b32 v104, v30, v57 offset:0
    v_mfma_f32_16x16x32_bf16 v[68:71], v[200:203], a[4:7], v[68:71]
    ds_read_b64_tr_b16 a[36:37], v6 offset:22528
    ds_bpermute_b32 v105, v30, v57 offset:4
    v_mfma_f32_16x16x32_bf16 v[84:87], v[204:207], a[4:7], v[84:87]
    ds_read_b64_tr_b16 a[38:39], v6 offset:22784
    ds_bpermute_b32 v106, v30, v57 offset:8
    v_mfma_f32_16x16x32_bf16 v[72:75], v[200:203], a[8:11], v[72:75]
    ds_read_b64_tr_b16 a[40:41], v5 offset:55296
    ds_bpermute_b32 v107, v30, v57 offset:12
    v_mfma_f32_16x16x32_bf16 v[88:91], v[204:207], a[8:11], v[88:91]
    ds_read_b64_tr_b16 a[42:43], v5 offset:55552
    ds_bpermute_b32 v108, v30, v59 offset:0
    v_mfma_f32_16x16x32_bf16 v[76:79], v[200:203], a[12:15], v[76:79]
    ds_read_b64_tr_b16 a[44:45], v6 offset:55296
    ds_bpermute_b32 v109, v30, v59 offset:4
    v_mfma_f32_16x16x32_bf16 v[92:95], v[204:207], a[12:15], v[92:95]
    ds_read_b64_tr_b16 a[46:47], v6 offset:55552
    ds_bpermute_b32 v110, v30, v59 offset:8
    v_max3_u32 v61, v61, v200, v204
    s_waitcnt vmcnt(18) lgkmcnt(15)
    v_mfma_f32_16x16x32_bf16 v[64:67], v[208:211], a[16:19], v[64:67]
    ds_read_b64_tr_b16 a[0:1], v5 offset:24576
    ds_bpermute_b32 v111, v30, v59 offset:12
    v_mfma_f32_16x16x32_bf16 v[80:83], v[212:215], a[16:19], v[80:83]
    ds_read_b64_tr_b16 a[2:3], v5 offset:24832
    v_accvgpr_read_b32 v40, a232
    v_mfma_f32_16x16x32_bf16 v[68:71], v[208:211], a[20:23], v[68:71]
    ds_read_b64_tr_b16 a[4:5], v6 offset:24576
    v_accvgpr_read_b32 v41, a236
    v_mfma_f32_16x16x32_bf16 v[84:87], v[212:215], a[20:23], v[84:87]
    ds_read_b64_tr_b16 a[6:7], v6 offset:24832
    v_accvgpr_read_b32 v42, a240
    v_mfma_f32_16x16x32_bf16 v[72:75], v[208:211], a[24:27], v[72:75]
    ds_read_b64_tr_b16 a[8:9], v5 offset:57344
    v_accvgpr_read_b32 v43, a244
    v_mfma_f32_16x16x32_bf16 v[88:91], v[212:215], a[24:27], v[88:91]
    ds_read_b64_tr_b16 a[10:11], v5 offset:57600
    v_mfma_f32_16x16x32_bf16 v[76:79], v[208:211], a[28:31], v[76:79]
    ds_read_b64_tr_b16 a[12:13], v6 offset:57344
    v_mfma_f32_16x16x32_bf16 v[92:95], v[212:215], a[28:31], v[92:95]
    ds_read_b64_tr_b16 a[14:15], v6 offset:57600
    v_max3_u32 v61, v61, v208, v212
    s_waitcnt vmcnt(16) lgkmcnt(10)
    v_mfma_f32_16x16x32_bf16 v[64:67], v[216:219], a[32:35], v[64:67]
    ds_read_b64_tr_b16 a[16:17], v5 offset:26624
    v_mfma_f32_16x16x32_bf16 v[80:83], v[220:223], a[32:35], v[80:83]
    ds_read_b64_tr_b16 a[18:19], v5 offset:26880
    v_mfma_f32_16x16x32_bf16 v[68:71], v[216:219], a[36:39], v[68:71]
    ds_read_b64_tr_b16 a[20:21], v6 offset:26624
    v_mfma_f32_16x16x32_bf16 v[84:87], v[220:223], a[36:39], v[84:87]
    ds_read_b64_tr_b16 a[22:23], v6 offset:26880
    v_mfma_f32_16x16x32_bf16 v[72:75], v[216:219], a[40:43], v[72:75]
    ds_read_b64_tr_b16 a[24:25], v5 offset:59392
    v_mfma_f32_16x16x32_bf16 v[88:91], v[220:223], a[40:43], v[88:91]
    ds_read_b64_tr_b16 a[26:27], v5 offset:59648
    v_mfma_f32_16x16x32_bf16 v[76:79], v[216:219], a[44:47], v[76:79]
    ds_read_b64_tr_b16 a[28:29], v6 offset:59392
    v_mfma_f32_16x16x32_bf16 v[92:95], v[220:223], a[44:47], v[92:95]
    ds_read_b64_tr_b16 a[30:31], v6 offset:59648
    v_max3_u32 v61, v61, v216, v220
    s_waitcnt vmcnt(14) lgkmcnt(8)
    v_mfma_f32_16x16x32_bf16 v[64:67], v[224:227], a[0:3], v[64:67]
    ds_read_b64_tr_b16 a[32:33], v5 offset:28672
    v_mfma_f32_16x16x32_bf16 v[80:83], v[228:231], a[0:3], v[80:83]
    ds_read_b64_tr_b16 a[34:35], v5 offset:28928
    v_mfma_f32_16x16x32_bf16 v[68:71], v[224:227], a[4:7], v[68:71]
    ds_read_b64_tr_b16 a[36:37], v6 offset:28672
    v_mfma_f32_16x16x32_bf16 v[84:87], v[228:231], a[4:7], v[84:87]
    ds_read_b64_tr_b16 a[38:39], v6 offset:28928
    v_mfma_f32_16x16x32_bf16 v[72:75], v[224:227], a[8:11], v[72:75]
    ds_read_b64_tr_b16 a[40:41], v5 offset:61440
    v_mfma_f32_16x16x32_bf16 v[88:91], v[228:231], a[8:11], v[88:91]
    ds_read_b64_tr_b16 a[42:43], v5 offset:61696
    v_mfma_f32_16x16x32_bf16 v[76:79], v[224:227], a[12:15], v[76:79]
    ds_read_b64_tr_b16 a[44:45], v6 offset:61440
    v_mfma_f32_16x16x32_bf16 v[92:95], v[228:231], a[12:15], v[92:95]
    ds_read_b64_tr_b16 a[46:47], v6 offset:61696
    v_max3_u32 v61, v61, v224, v228
    s_waitcnt vmcnt(12) lgkmcnt(8)
    v_mfma_f32_16x16x32_bf16 v[64:67], v[232:235], a[16:19], v[64:67]
    ds_read_b64_tr_b16 a[0:1], v5 offset:30720
    v_mfma_f32_16x16x32_bf16 v[80:83], v[236:239], a[16:19], v[80:83]
    ds_read_b64_tr_b16 a[2:3], v5 offset:30976
    v_mfma_f32_16x16x32_bf16 v[68:71], v[232:235], a[20:23], v[68:71]
    ds_read_b64_tr_b16 a[4:5], v6 offset:30720
    v_mfma_f32_16x16x32_bf16 v[84:87], v[236:239], a[20:23], v[84:87]
    ds_read_b64_tr_b16 a[6:7], v6 offset:30976
    v_mfma_f32_16x16x32_bf16 v[72:75], v[232:235], a[24:27], v[72:75]
    ds_read_b64_tr_b16 a[8:9], v5 offset:63488
    v_mfma_f32_16x16x32_bf16 v[88:91], v[236:239], a[24:27], v[88:91]
    ds_read_b64_tr_b16 a[10:11], v5 offset:63744
    v_mfma_f32_16x16x32_bf16 v[76:79], v[232:235], a[28:31], v[76:79]
    ds_read_b64_tr_b16 a[12:13], v6 offset:63488
    v_mfma_f32_16x16x32_bf16 v[92:95], v[236:239], a[28:31], v[92:95]
    ds_read_b64_tr_b16 a[14:15], v6 offset:63744
    v_max3_u32 v61, v61, v232, v236
    s_waitcnt vmcnt(10) lgkmcnt(8)
    v_mfma_f32_16x16x32_bf16 v[64:67], v[240:243], a[32:35], v[64:67]
    v_mfma_f32_16x16x32_bf16 v[80:83], v[244:247], a[32:35], v[80:83]
    v_mfma_f32_16x16x32_bf16 v[68:71], v[240:243], a[36:39], v[68:71]
    v_mfma_f32_16x16x32_bf16 v[84:87], v[244:247], a[36:39], v[84:87]
    v_mfma_f32_16x16x32_bf16 v[72:75], v[240:243], a[40:43], v[72:75]
    v_mfma_f32_16x16x32_bf16 v[88:91], v[244:247], a[40:43], v[88:91]
    v_mfma_f32_16x16x32_bf16 v[76:79], v[240:243], a[44:47], v[76:79]
    v_mfma_f32_16x16x32_bf16 v[92:95], v[244:247], a[44:47], v[92:95]
    v_max3_u32 v61, v61, v240, v244
    s_waitcnt vmcnt(8) lgkmcnt(0)
    v_mfma_f32_16x16x32_bf16 v[64:67], v[248:251], a[0:3], v[64:67]
    v_mfma_f32_16x16x32_bf16 v[80:83], v[252:255], a[0:3], v[80:83]
    v_mfma_f32_16x16x32_bf16 v[68:71], v[248:251], a[4:7], v[68:71]
    v_mfma_f32_16x16x32_bf16 v[84:87], v[252:255], a[4:7], v[84:87]
    v_mfma_f32_16x16x32_bf16 v[72:75], v[248:251], a[8:11], v[72:75]
    v_mfma_f32_16x16x32_bf16 v[88:91], v[252:255], a[8:11], v[88:91]
    v_mfma_f32_16x16x32_bf16 v[76:79], v[248:251], a[12:15], v[76:79]
    v_mfma_f32_16x16x32_bf16 v[92:95], v[252:255], a[12:15], v[92:95]
    v_max3_u32 v61, v61, v248, v252
    v_cmp_eq_u32 vcc, -1, v61
    s_nop 0
    s_cmp_eq_u64 vcc, 0
    s_cbranch_scc1 REDOD_21
    s_waitcnt vmcnt(0) lgkmcnt(0)
    s_sub_u32 s101, s101, 1
    s_nop 7
    s_cbranch_scc0 REDO_18
REDOD_21:
    s_waitcnt vmcnt(0)
    s_barrier
    s_waitcnt lgkmcnt(0)
    v_pk_fma_f32 v[64:65], v[40:41], v[104:105], v[64:65] op_sel:[0,0,0] op_sel_hi:[0,1,1]
    v_pk_fma_f32 v[66:67], v[40:41], v[106:107], v[66:67] op_sel:[0,0,0] op_sel_hi:[0,1,1]
    v_pk_fma_f32 v[64:65], v[64:65], v[96:97], s[78:79] op_sel:[0,0,0] op_sel_hi:[1,1,0]
    v_pk_fma_f32 v[66:67], v[66:67], v[98:99], s[78:79] op_sel:[0,0,0] op_sel_hi:[1,1,0]
    v_pk_mul_f32 v[48:49], s[76:77], v[64:65] op_sel:[0,0] op_sel_hi:[0,1]
    v_pk_mul_f32 v[50:51], s[76:77], v[66:67] op_sel:[0,0] op_sel_hi:[0,1]
    v_exp_f32 v48, v48 clamp
    v_exp_f32 v50, v50 clamp
    v_exp_f32 v49, v49 clamp
    v_exp_f32 v51, v51 clamp
    v_max_f32 v64, s78, v64
    v_max_f32 v66, s78, v66
    s_add_u32 m0, s58, 98304
    s_add_u32 s100, s82, 0
    buffer_load_dwordx4 v19, s[12:15], s100 offen offset:0 lds
    v_max_f32 v65, s78, v65
    v_max_f32 v67, s78, v67
    v_pk_add_f32 v[64:65], v[64:65], v[48:49] op_sel:[0,0] op_sel_hi:[1,1]
    v_pk_add_f32 v[66:67], v[66:67], v[50:51] op_sel:[0,0] op_sel_hi:[1,1]
    v_cvt_pk_bf16_f32 v112, v64, v65
    v_cvt_pk_bf16_f32 v113, v66, v67
    v_pk_fma_f32 v[80:81], v[40:41], v[108:109], v[80:81] op_sel:[0,0,0] op_sel_hi:[0,1,1]
    v_pk_fma_f32 v[82:83], v[40:41], v[110:111], v[82:83] op_sel:[0,0,0] op_sel_hi:[0,1,1]
    v_pk_fma_f32 v[80:81], v[80:81], v[100:101], s[78:79] op_sel:[0,0,0] op_sel_hi:[1,1,0]
    v_pk_fma_f32 v[82:83], v[82:83], v[102:103], s[78:79] op_sel:[0,0,0] op_sel_hi:[1,1,0]
    v_pk_mul_f32 v[52:53], s[76:77], v[80:81] op_sel:[0,0] op_sel_hi:[0,1]
    v_pk_mul_f32 v[54:55], s[76:77], v[82:83] op_sel:[0,0] op_sel_hi:[0,1]
    buffer_load_dwordx4 v19, s[12:15], s100 offen offset:1024 lds
    v_exp_f32 v52, v52 clamp
    v_exp_f32 v54, v54 clamp
    v_exp_f32 v53, v53 clamp
    v_exp_f32 v55, v55 clamp
    v_max_f32 v80, s78, v80
    v_max_f32 v82, s78, v82
    v_max_f32 v81, s78, v81
    v_max_f32 v83, s78, v83
    v_pk_add_f32 v[80:81], v[80:81], v[52:53] op_sel:[0,0] op_sel_hi:[1,1]
    v_pk_add_f32 v[82:83], v[82:83], v[54:55] op_sel:[0,0] op_sel_hi:[1,1]
    v_cvt_pk_bf16_f32 v114, v80, v81
    v_cvt_pk_bf16_f32 v115, v82, v83
    buffer_load_dwordx4 v19, s[12:15], s100 offen offset:2048 lds
    v_pk_fma_f32 v[68:69], v[40:41], v[104:105], v[68:69] op_sel:[1,0,0] op_sel_hi:[1,1,1]
    v_pk_fma_f32 v[70:71], v[40:41], v[106:107], v[70:71] op_sel:[1,0,0] op_sel_hi:[1,1,1]
    v_pk_fma_f32 v[68:69], v[68:69], v[96:97], s[78:79] op_sel:[0,0,0] op_sel_hi:[1,1,0]
    v_pk_fma_f32 v[70:71], v[70:71], v[98:99], s[78:79] op_sel:[0,0,0] op_sel_hi:[1,1,0]
    v_pk_mul_f32 v[48:49], s[76:77], v[68:69] op_sel:[0,0] op_sel_hi:[0,1]
    v_pk_mul_f32 v[50:51], s[76:77], v[70:71] op_sel:[0,0] op_sel_hi:[0,1]
    v_exp_f32 v48, v48 clamp
    v_exp_f32 v50, v50 clamp
    v_exp_f32 v49, v49 clamp
    v_exp_f32 v51, v51 clamp
    v_max_f32 v68, s78, v68
    v_max_f32 v70, s78, v70
    buffer_load_dwordx4 v19, s[12:15], s100 offen offset:3072 lds
    v_max_f32 v69, s78, v69
    v_max_f32 v71, s78, v71
    v_pk_add_f32 v[68:69], v[68:69], v[48:49] op_sel:[0,0] op_sel_hi:[1,1]
    v_pk_add_f32 v[70:71], v[70:71], v[50:51] op_sel:[0,0] op_sel_hi:[1,1]
    v_cvt_pk_bf16_f32 v116, v68, v69
    v_cvt_pk_bf16_f32 v117, v70, v71
    v_pk_fma_f32 v[84:85], v[40:41], v[108:109], v[84:85] op_sel:[1,0,0] op_sel_hi:[1,1,1]
    v_pk_fma_f32 v[86:87], v[40:41], v[110:111], v[86:87] op_sel:[1,0,0] op_sel_hi:[1,1,1]
    v_pk_fma_f32 v[84:85], v[84:85], v[100:101], s[78:79] op_sel:[0,0,0] op_sel_hi:[1,1,0]
    v_pk_fma_f32 v[86:87], v[86:87], v[102:103], s[78:79] op_sel:[0,0,0] op_sel_hi:[1,1,0]
    v_pk_mul_f32 v[52:53], s[76:77], v[84:85] op_sel:[0,0] op_sel_hi:[0,1]
    v_pk_mul_f32 v[54:55], s[76:77], v[86:87] op_sel:[0,0] op_sel_hi:[0,1]
    s_add_u32 m0, s58, 102400
    s_add_u32 s100, s82, 32768
    buffer_load_dwordx4 v19, s[12:15], s100 offen offset:0 lds
    v_exp_f32 v52, v52 clamp
    v_exp_f32 v54, v54 clamp
    v_exp_f32 v53, v53 clamp
    v_exp_f32 v55, v55 clamp
    v_max_f32 v84, s78, v84
    v_max_f32 v86, s78, v86
    v_max_f32 v85, s78, v85
    v_max_f32 v87, s78, v87
    v_pk_add_f32 v[84:85], v[84:85], v[52:53] op_sel:[0,0] op_sel_hi:[1,1]
    v_pk_add_f32 v[86:87], v[86:87], v[54:55] op_sel:[0,0] op_sel_hi:[1,1]
    v_cvt_pk_bf16_f32 v118, v84, v85
    v_cvt_pk_bf16_f32 v119, v86, v87
    buffer_load_dwordx4 v19, s[12:15], s100 offen offset:1024 lds
    v_pk_fma_f32 v[72:73], v[42:43], v[104:105], v[72:73] op_sel:[0,0,0] op_sel_hi:[0,1,1]
    v_pk_fma_f32 v[74:75], v[42:43], v[106:107], v[74:75] op_sel:[0,0,0] op_sel_hi:[0,1,1]
    v_pk_mul_f32 v[72:73], v[72:73], v[96:97] op_sel:[0,0] op_sel_hi:[1,1]
    v_pk_mul_f32 v[74:75], v[74:75], v[98:99] op_sel:[0,0] op_sel_hi:[1,1]
    v_cvt_pk_bf16_f32 v120, v72, v73
    v_cvt_pk_bf16_f32 v121, v74, v75
    v_pk_fma_f32 v[88:89], v[42:43], v[108:109], v[88:89] op_sel:[0,0,0] op_sel_hi:[0,1,1]
    v_pk_fma_f32 v[90:91], v[42:43], v[110:111], v[90:91] op_sel:[0,0,0] op_sel_hi:[0,1,1]
    v_pk_mul_f32 v[88:89], v[88:89], v[100:101] op_sel:[0,0] op_sel_hi:[1,1]
    v_pk_mul_f32 v[90:91], v[90:91], v[102:103] op_sel:[0,0] op_sel_hi:[1,1]
    v_cvt_pk_bf16_f32 v122, v88, v89
    v_cvt_pk_bf16_f32 v123, v90, v91
    buffer_load_dwordx4 v19, s[12:15], s100 offen offset:2048 lds
    v_pk_fma_f32 v[76:77], v[42:43], v[104:105], v[76:77] op_sel:[1,0,0] op_sel_hi:[1,1,1]
    v_pk_fma_f32 v[78:79], v[42:43], v[106:107], v[78:79] op_sel:[1,0,0] op_sel_hi:[1,1,1]
    v_pk_mul_f32 v[76:77], v[76:77], v[96:97] op_sel:[0,0] op_sel_hi:[1,1]
    v_pk_mul_f32 v[78:79], v[78:79], v[98:99] op_sel:[0,0] op_sel_hi:[1,1]
    v_cvt_pk_bf16_f32 v124, v76, v77
    v_cvt_pk_bf16_f32 v125, v78, v79
    v_pk_fma_f32 v[92:93], v[42:43], v[108:109], v[92:93] op_sel:[1,0,0] op_sel_hi:[1,1,1]
    v_pk_fma_f32 v[94:95], v[42:43], v[110:111], v[94:95] op_sel:[1,0,0] op_sel_hi:[1,1,1]
    v_pk_mul_f32 v[92:93], v[92:93], v[100:101] op_sel:[0,0] op_sel_hi:[1,1]
    v_pk_mul_f32 v[94:95], v[94:95], v[102:103] op_sel:[0,0] op_sel_hi:[1,1]
    v_cvt_pk_bf16_f32 v126, v92, v93
    v_cvt_pk_bf16_f32 v127, v94, v95
    buffer_load_dwordx4 v19, s[12:15], s100 offen offset:3072 lds
    v_mfma_f32_16x16x32_bf16 v[64:67], v[112:115], v[120:123], 0
    v_mfma_f32_16x16x32_bf16 v[72:75], a[228:231], v[112:115], 0
    v_mfma_f32_16x16x32_bf16 v[68:71], v[116:119], v[124:127], 0
    v_mfma_f32_16x16x32_bf16 v[76:79], a[228:231], v[116:119], 0
    s_lshl_b32 s61, s48, 12
    v_add_u32 v60, s61, v1
    v_add_u32 v61, s61, v31
    s_lshr_b32 s61, s48, 1
    s_and_b32 s62, s48, 1
    s_lshl_b32 s63, s61, 10
    s_lshl_b32 s64, s62, 9
    s_add_u32 s63, s63, s64
    v_add_u32 v54, s63, v28
    s_lshl_b32 s63, s61, 6
    v_add_u32 v55, s63, v31
    s_lshl_b32 s63, s53, 1
    s_add_u32 s63, s63, s61
    s_mul_i32 s63, s63, 1280
    s_add_u32 s63, s63, 155648
    s_lshl_b32 s64, s62, 9
    s_add_u32 s64, s64, s63
    s_lshl_b32 s62, s62, 28
    s_add_u32 s63, s63, s62
    ds_write_b128 v60, v[64:67] offset:0
    ds_write_b32 v61, v72 offset:2048
    ds_write_b128 v60, v[68:71] offset:1024
    ds_write_b32 v61, v76 offset:2112
    ds_read_b64_tr_b16 a[0:1], v7 offset:0
    ds_read_b64_tr_b16 a[2:3], v7 offset:256
    ds_read_b64_tr_b16 a[4:5], v8 offset:0
    ds_read_b64_tr_b16 a[6:7], v8 offset:256
    ds_read_b64_tr_b16 a[16:17], v7 offset:2048
    ds_read_b64_tr_b16 a[18:19], v7 offset:2304
    ds_read_b64_tr_b16 a[20:21], v8 offset:2048
    ds_read_b64_tr_b16 a[22:23], v8 offset:2304
    s_waitcnt lgkmcnt(4)
    v_mfma_f32_16x16x32_bf16 v[96:99], a[0:3], v[128:131], 0
    ds_read_b64_tr_b16 a[32:33], v7 offset:4096
    v_accvgpr_read_b32 v40, a248
    v_mfma_f32_16x16x32_bf16 v[104:107], a[0:3], v[132:135], 0
    ds_read_b64_tr_b16 a[34:35], v7 offset:4352
    s_add_u32 m0, s58, 131072
    s_add_u32 s100, s82, 65536
    buffer_load_dwordx4 v19, s[12:15], s100 offen offset:0 lds
    v_mfma_f32_16x16x32_bf16 v[100:103], a[4:7], v[128:131], 0
    ds_read_b64_tr_b16 a[36:37], v8 offset:4096
    v_accvgpr_read_b32 v41, a249
    v_mfma_f32_16x16x32_bf16 v[108:111], a[4:7], v[132:135], 0
    ds_read_b64_tr_b16 a[38:39], v8 offset:4352
    v_accvgpr_read_b32 v42, a250
    s_waitcnt lgkmcnt(4)
    v_mfma_f32_16x16x32_bf16 v[96:99], a[16:19], v[136:139], v[96:99]
    ds_read_b64_tr_b16 a[0:1], v7 offset:6144
    v_accvgpr_read_b32 v43, a251
    v_mfma_f32_16x16x32_bf16 v[104:107], a[16:19], v[140:143], v[104:107]
    ds_read_b64_tr_b16 a[2:3], v7 offset:6400
    buffer_load_dwordx4 v19, s[12:15], s100 offen offset:1024 lds
    v_mfma_f32_16x16x32_bf16 v[100:103], a[20:23], v[136:139], v[100:103]
    ds_read_b64_tr_b16 a[4:5], v8 offset:6144
    v_accvgpr_read_b32 v44, a252
    v_mfma_f32_16x16x32_bf16 v[108:111], a[20:23], v[140:143], v[108:111]
    ds_read_b64_tr_b16 a[6:7], v8 offset:6400
    v_accvgpr_read_b32 v45, a253
    s_barrier
    ds_read2st64_b32 v[64:65], v54 offset0:0 offset1:1
    ds_read_b32 v72, v55 offset:2048
    ds_read2st64_b32 v[66:67], v54 offset0:16 offset1:17
    ds_read_b32 v73, v55 offset:6144
    ds_read2st64_b32 v[68:69], v54 offset0:32 offset1:33
    ds_read_b32 v74, v55 offset:10240
    ds_read2st64_b32 v[70:71], v54 offset0:48 offset1:49
    ds_read_b32 v75, v55 offset:14336
    s_waitcnt lgkmcnt(12)
    v_mfma_f32_16x16x32_bf16 v[96:99], a[32:35], v[144:147], v[96:99]
    ds_read_b64_tr_b16 a[16:17], v7 offset:8192
    v_accvgpr_read_b32 v46, a254
    v_mfma_f32_16x16x32_bf16 v[104:107], a[32:35], v[148:151], v[104:107]
    ds_read_b64_tr_b16 a[18:19], v7 offset:8448
    buffer_load_dwordx4 v19, s[12:15], s100 offen offset:2048 lds
    v_mfma_f32_16x16x32_bf16 v[100:103], a[36:39], v[144:147], v[100:103]
    ds_read_b64_tr_b16 a[20:21], v8 offset:8192
    v_accvgpr_read_b32 v47, a255
    v_mfma_f32_16x16x32_bf16 v[108:111], a[36:39], v[148:151], v[108:111]
    ds_read_b64_tr_b16 a[22:23], v8 offset:8448
    s_waitcnt lgkmcnt(12)
    v_mfma_f32_16x16x32_bf16 v[96:99], a[0:3], v[152:155], v[96:99]
    ds_read_b64_tr_b16 a[32:33], v7 offset:10240
    v_mfma_f32_16x16x32_bf16 v[104:107], a[0:3], v[156:159], v[104:107]
    ds_read_b64_tr_b16 a[34:35], v7 offset:10496
    buffer_load_dwordx4 v19, s[12:15], s100 offen offset:3072 lds
    v_mfma_f32_16x16x32_bf16 v[100:103], a[4:7], v[152:155], v[100:103]
    ds_read_b64_tr_b16 a[36:37], v8 offset:10240
    v_mfma_f32_16x16x32_bf16 v[108:111], a[4:7], v[156:159], v[108:111]
    ds_read_b64_tr_b16 a[38:39], v8 offset:10496
    s_waitcnt lgkmcnt(8)
    v_add_f32 v64, v64, v66
    v_add_f32 v65, v65, v67
    v_add_f32 v68, v68, v70
    v_add_f32 v69, v69, v71
    v_add_f32 v72, v72, v73
    v_add_f32 v74, v74, v75
    v_add_f32 v64, v64, v68
    v_add_f32 v65, v65, v69
    v_add_f32 v72, v72, v74
    buffer_atomic_add_f32 v64, v28, s[36:39], s64 offen sc1
    buffer_atomic_add_f32 v65, v28, s[36:39], s64 offen offset:256 sc1
    s_mov_b64 exec, 0xffff
    buffer_atomic_add_f32 v72, v31, s[36:39], s63 offen offset:1024 sc1
    s_mov_b64 exec, -1
    s_waitcnt lgkmcnt(4)
    v_mfma_f32_16x16x32_bf16 v[96:99], a[16:19], v[160:163], v[96:99]
    ds_read_b64_tr_b16 a[0:1], v7 offset:12288
    v_mfma_f32_16x16x32_bf16 v[104:107], a[16:19], v[164:167], v[104:107]
    ds_read_b64_tr_b16 a[2:3], v7 offset:12544
    s_add_u32 m0, s58, 135168
    s_add_u32 s100, s82, 98304
    buffer_load_dwordx4 v19, s[12:15], s100 offen offset:0 lds
    v_mfma_f32_16x16x32_bf16 v[100:103], a[20:23], v[160:163], v[100:103]
    ds_read_b64_tr_b16 a[4:5], v8 offset:12288
    v_mfma_f32_16x16x32_bf16 v[108:111], a[20:23], v[164:167], v[108:111]
    ds_read_b64_tr_b16 a[6:7], v8 offset:12544
    s_waitcnt lgkmcnt(4)
    v_mfma_f32_16x16x32_bf16 v[96:99], a[32:35], v[168:171], v[96:99]
    ds_read_b64_tr_b16 a[16:17], v7 offset:14336
    v_mfma_f32_16x16x32_bf16 v[104:107], a[32:35], v[172:175], v[104:107]
    ds_read_b64_tr_b16 a[18:19], v7 offset:14592
    buffer_load_dwordx4 v19, s[12:15], s100 offen offset:1024 lds
    v_mfma_f32_16x16x32_bf16 v[100:103], a[36:39], v[168:171], v[100:103]
    ds_read_b64_tr_b16 a[20:21], v8 offset:14336
    v_mfma_f32_16x16x32_bf16 v[108:111], a[36:39], v[172:175], v[108:111]
    ds_read_b64_tr_b16 a[22:23], v8 offset:14592
    s_waitcnt lgkmcnt(4)
    v_mfma_f32_16x16x32_bf16 v[96:99], a[0:3], v[176:179], v[96:99]
    ds_read_b64_tr_b16 a[32:33], v7 offset:16384
    v_mfma_f32_16x16x32_bf16 v[104:107], a[0:3], v[180:183], v[104:107]
    ds_read_b64_tr_b16 a[34:35], v7 offset:16640
    buffer_load_dwordx4 v19, s[12:15], s100 offen offset:2048 lds
    v_mfma_f32_16x16x32_bf16 v[100:103], a[4:7], v[176:179], v[100:103]
    ds_read_b64_tr_b16 a[36:37], v8 offset:16384
    v_mfma_f32_16x16x32_bf16 v[108:111], a[4:7], v[180:183], v[108:111]
    ds_read_b64_tr_b16 a[38:39], v8 offset:16640
    s_waitcnt lgkmcnt(4)
    v_mfma_f32_16x16x32_bf16 v[96:99], a[16:19], v[184:187], v[96:99]
    ds_read_b64_tr_b16 a[0:1], v7 offset:18432
    v_mfma_f32_16x16x32_bf16 v[104:107], a[16:19], v[188:191], v[104:107]
    ds_read_b64_tr_b16 a[2:3], v7 offset:18688
    buffer_load_dwordx4 v19, s[12:15], s100 offen offset:3072 lds
    v_mfma_f32_16x16x32_bf16 v[100:103], a[20:23], v[184:187], v[100:103]
    ds_read_b64_tr_b16 a[4:5], v8 offset:18432
    v_mfma_f32_16x16x32_bf16 v[108:111], a[20:23], v[188:191], v[108:111]
    ds_read_b64_tr_b16 a[6:7], v8 offset:18688
    s_waitcnt lgkmcnt(4)
    v_mfma_f32_16x16x32_bf16 v[96:99], a[32:35], v[192:195], v[96:99]
    ds_read_b64_tr_b16 a[16:17], v7 offset:20480
    v_mfma_f32_16x16x32_bf16 v[104:107], a[32:35], v[196:199], v[104:107]
    ds_read_b64_tr_b16 a[18:19], v7 offset:20736
    v_mfma_f32_16x16x32_bf16 v[100:103], a[36:39], v[192:195], v[100:103]
    ds_read_b64_tr_b16 a[20:21], v8 offset:20480
    v_mfma_f32_16x16x32_bf16 v[108:111], a[36:39], v[196:199], v[108:111]
    ds_read_b64_tr_b16 a[22:23], v8 offset:20736
    s_waitcnt lgkmcnt(4)
    v_mfma_f32_16x16x32_bf16 v[96:99], a[0:3], v[200:203], v[96:99]
    ds_read_b64_tr_b16 a[32:33], v7 offset:22528
    v_mfma_f32_16x16x32_bf16 v[104:107], a[0:3], v[204:207], v[104:107]
    ds_read_b64_tr_b16 a[34:35], v7 offset:22784
    v_mfma_f32_16x16x32_bf16 v[100:103], a[4:7], v[200:203], v[100:103]
    ds_read_b64_tr_b16 a[36:37], v8 offset:22528
    v_mfma_f32_16x16x32_bf16 v[108:111], a[4:7], v[204:207], v[108:111]
    ds_read_b64_tr_b16 a[38:39], v8 offset:22784
    s_waitcnt lgkmcnt(4)
    v_mfma_f32_16x16x32_bf16 v[96:99], a[16:19], v[208:211], v[96:99]
    ds_read_b64_tr_b16 a[0:1], v7 offset:24576
    v_mfma_f32_16x16x32_bf16 v[104:107], a[16:19], v[212:215], v[104:107]
    ds_read_b64_tr_b16 a[2:3], v7 offset:24832
    v_mfma_f32_16x16x32_bf16 v[100:103], a[20:23], v[208:211], v[100:103]
    ds_read_b64_tr_b16 a[4:5], v8 offset:24576
    v_mfma_f32_16x16x32_bf16 v[108:111], a[20:23], v[212:215], v[108:111]
    ds_read_b64_tr_b16 a[6:7], v8 offset:24832
    s_waitcnt lgkmcnt(4)
    v_mfma_f32_16x16x32_bf16 v[96:99], a[32:35], v[216:219], v[96:99]
    ds_read_b64_tr_b16 a[16:17], v7 offset:26624
    v_mfma_f32_16x16x32_bf16 v[104:107], a[32:35], v[220:223], v[104:107]
    ds_read_b64_tr_b16 a[18:19], v7 offset:26880
    v_mfma_f32_16x16x32_bf16 v[100:103], a[36:39], v[216:219], v[100:103]
    ds_read_b64_tr_b16 a[20:21], v8 offset:26624
    v_mfma_f32_16x16x32_bf16 v[108:111], a[36:39], v[220:223], v[108:111]
    ds_read_b64_tr_b16 a[22:23], v8 offset:26880
    s_waitcnt lgkmcnt(4)
    v_mfma_f32_16x16x32_bf16 v[96:99], a[0:3], v[224:227], v[96:99]
    ds_read_b64_tr_b16 a[32:33], v7 offset:28672
    v_mfma_f32_16x16x32_bf16 v[104:107], a[0:3], v[228:231], v[104:107]
    ds_read_b64_tr_b16 a[34:35], v7 offset:28928
    v_mfma_f32_16x16x32_bf16 v[100:103], a[4:7], v[224:227], v[100:103]
    ds_read_b64_tr_b16 a[36:37], v8 offset:28672
    v_mfma_f32_16x16x32_bf16 v[108:111], a[4:7], v[228:231], v[108:111]
    ds_read_b64_tr_b16 a[38:39], v8 offset:28928
    s_waitcnt lgkmcnt(4)
    v_mfma_f32_16x16x32_bf16 v[96:99], a[16:19], v[232:235], v[96:99]
    ds_read_b64_tr_b16 a[0:1], v7 offset:30720
    v_mfma_f32_16x16x32_bf16 v[104:107], a[16:19], v[236:239], v[104:107]
    ds_read_b64_tr_b16 a[2:3], v7 offset:30976
    v_mfma_f32_16x16x32_bf16 v[100:103], a[20:23], v[232:235], v[100:103]
    ds_read_b64_tr_b16 a[4:5], v8 offset:30720
    v_mfma_f32_16x16x32_bf16 v[108:111], a[20:23], v[236:239], v[108:111]
    ds_read_b64_tr_b16 a[6:7], v8 offset:30976
    s_waitcnt lgkmcnt(4)
    v_mfma_f32_16x16x32_bf16 v[96:99], a[32:35], v[240:243], v[96:99]
    v_mfma_f32_16x16x32_bf16 v[104:107], a[32:35], v[244:247], v[104:107]
    v_mfma_f32_16x16x32_bf16 v[100:103], a[36:39], v[240:243], v[100:103]
    v_mfma_f32_16x16x32_bf16 v[108:111], a[36:39], v[244:247], v[108:111]
    s_waitcnt lgkmcnt(0)
    v_mfma_f32_16x16x32_bf16 v[96:99], a[0:3], v[248:251], v[96:99]
    v_mfma_f32_16x16x32_bf16 v[104:107], a[0:3], v[252:255], v[104:107]
    v_mfma_f32_16x16x32_bf16 v[100:103], a[4:7], v[248:251], v[100:103]
    v_mfma_f32_16x16x32_bf16 v[108:111], a[4:7], v[252:255], v[108:111]
    s_lshl_b32 s61, s56, 14
    s_lshl_b32 s62, s53, 10
    s_add_u32 s61, s61, s62
    s_add_u32 s61, s61, 4194304
    s_nop 0
    v_pk_fma_f32 v[96:97], v[40:41], v[56:57], v[96:97] op_sel:[0,1,0] op_sel_hi:[1,1,1]
    v_pk_fma_f32 v[98:99], v[42:43], v[56:57], v[98:99] op_sel:[0,1,0] op_sel_hi:[1,1,1]
    v_pk_fma_f32 v[96:97], v[96:97], v[56:57], s[78:79] op_sel:[0,0,0] op_sel_hi:[1,0,0]
    v_pk_fma_f32 v[98:99], v[98:99], v[56:57], s[78:79] op_sel:[0,0,0] op_sel_hi:[1,0,0]
    v_pk_mul_f32 v[48:49], s[76:77], v[96:97] op_sel:[0,0] op_sel_hi:[0,1]
    v_pk_mul_f32 v[50:51], s[76:77], v[98:99] op_sel:[0,0] op_sel_hi:[0,1]
    v_exp_f32 v48, v48 clamp
    v_exp_f32 v50, v50 clamp
    v_exp_f32 v49, v49 clamp
    v_exp_f32 v51, v51 clamp
    v_max_f32 v96, s78, v96
    v_max_f32 v98, s78, v98
    v_max_f32 v97, s78, v97
    v_max_f32 v99, s78, v99
    v_pk_add_f32 v[96:97], v[96:97], v[48:49] op_sel:[0,0] op_sel_hi:[1,1]
    v_pk_add_f32 v[98:99], v[98:99], v[50:51] op_sel:[0,0] op_sel_hi:[1,1]
    v_cvt_pk_bf16_f32 v112, v96, v97
    v_cvt_pk_bf16_f32 v113, v98, v99
    v_pk_fma_f32 v[100:101], v[44:45], v[56:57], v[100:101] op_sel:[0,1,0] op_sel_hi:[1,1,1]
    v_pk_fma_f32 v[102:103], v[46:47], v[56:57], v[102:103] op_sel:[0,1,0] op_sel_hi:[1,1,1]
    v_pk_fma_f32 v[100:101], v[100:101], v[56:57], s[78:79] op_sel:[0,0,0] op_sel_hi:[1,0,0]
    v_pk_fma_f32 v[102:103], v[102:103], v[56:57], s[78:79] op_sel:[0,0,0] op_sel_hi:[1,0,0]
    v_pk_mul_f32 v[52:53], s[76:77], v[100:101] op_sel:[0,0] op_sel_hi:[0,1]
    v_pk_mul_f32 v[54:55], s[76:77], v[102:103] op_sel:[0,0] op_sel_hi:[0,1]
    v_exp_f32 v52, v52 clamp
    v_exp_f32 v54, v54 clamp
    v_exp_f32 v53, v53 clamp
    v_exp_f32 v55, v55 clamp
    v_max_f32 v100, s78, v100
    v_max_f32 v102, s78, v102
    v_max_f32 v101, s78, v101
    v_max_f32 v103, s78, v103
    v_pk_add_f32 v[100:101], v[100:101], v[52:53] op_sel:[0,0] op_sel_hi:[1,1]
    v_pk_add_f32 v[102:103], v[102:103], v[54:55] op_sel:[0,0] op_sel_hi:[1,1]
    v_cvt_pk_bf16_f32 v114, v100, v101
    v_cvt_pk_bf16_f32 v115, v102, v103
    buffer_store_dwordx4 v[112:115], v1, s[36:39], s61 offen sc1
    v_pk_fma_f32 v[104:105], v[40:41], v[58:59], v[104:105] op_sel:[0,1,0] op_sel_hi:[1,1,1]
    v_pk_fma_f32 v[106:107], v[42:43], v[58:59], v[106:107] op_sel:[0,1,0] op_sel_hi:[1,1,1]
    v_pk_fma_f32 v[104:105], v[104:105], v[58:59], s[78:79] op_sel:[0,0,0] op_sel_hi:[1,0,0]
    v_pk_fma_f32 v[106:107], v[106:107], v[58:59], s[78:79] op_sel:[0,0,0] op_sel_hi:[1,0,0]
    v_pk_mul_f32 v[48:49], s[76:77], v[104:105] op_sel:[0,0] op_sel_hi:[0,1]
    v_pk_mul_f32 v[50:51], s[76:77], v[106:107] op_sel:[0,0] op_sel_hi:[0,1]
    v_exp_f32 v48, v48 clamp
    v_exp_f32 v50, v50 clamp
    v_exp_f32 v49, v49 clamp
    v_exp_f32 v51, v51 clamp
    v_max_f32 v104, s78, v104
    v_max_f32 v106, s78, v106
    v_max_f32 v105, s78, v105
    v_max_f32 v107, s78, v107
    v_pk_add_f32 v[104:105], v[104:105], v[48:49] op_sel:[0,0] op_sel_hi:[1,1]
    v_pk_add_f32 v[106:107], v[106:107], v[50:51] op_sel:[0,0] op_sel_hi:[1,1]
    v_cvt_pk_bf16_f32 v116, v104, v105
    v_cvt_pk_bf16_f32 v117, v106, v107
    v_pk_fma_f32 v[108:109], v[44:45], v[58:59], v[108:109] op_sel:[0,1,0] op_sel_hi:[1,1,1]
    v_pk_fma_f32 v[110:111], v[46:47], v[58:59], v[110:111] op_sel:[0,1,0] op_sel_hi:[1,1,1]
    v_pk_fma_f32 v[108:109], v[108:109], v[58:59], s[78:79] op_sel:[0,0,0] op_sel_hi:[1,0,0]
    v_pk_fma_f32 v[110:111], v[110:111], v[58:59], s[78:79] op_sel:[0,0,0] op_sel_hi:[1,0,0]
    v_pk_mul_f32 v[52:53], s[76:77], v[108:109] op_sel:[0,0] op_sel_hi:[0,1]
    v_pk_mul_f32 v[54:55], s[76:77], v[110:111] op_sel:[0,0] op_sel_hi:[0,1]
    v_exp_f32 v52, v52 clamp
    v_exp_f32 v54, v54 clamp
    v_exp_f32 v53, v53 clamp
    v_exp_f32 v55, v55 clamp
    v_max_f32 v108, s78, v108
    v_max_f32 v110, s78, v110
    v_max_f32 v109, s78, v109
    v_max_f32 v111, s78, v111
    v_pk_add_f32 v[108:109], v[108:109], v[52:53] op_sel:[0,0] op_sel_hi:[1,1]
    v_pk_add_f32 v[110:111], v[110:111], v[54:55] op_sel:[0,0] op_sel_hi:[1,1]
    v_cvt_pk_bf16_f32 v118, v108, v109
    v_cvt_pk_bf16_f32 v119, v110, v111
    buffer_store_dwordx4 v[116:119], v2, s[36:39], s61 offen sc1
    s_lshl_b32 s68, s53, 7
    s_lshl_b32 s61, s49, 3
    s_add_u32 s68, s68, s61
    s_lshl_b32 s61, s52, 2
    s_add_u32 s68, s68, s61
    s_add_u32 s68, s68, 16384
    s_waitcnt vmcnt(2)
    ds_read_b64_tr_b16 a[0:1], v13 offset:32768
    ds_read_b64_tr_b16 a[2:3], v13 offset:33280
    ds_read_b64_tr_b16 a[4:5], v13 offset:32776
    ds_read_b64_tr_b16 a[6:7], v13 offset:33288
    ds_read_b64_tr_b16 a[8:9], v14 offset:32768
    ds_read_b64_tr_b16 a[10:11], v14 offset:33280
    ds_read_b64_tr_b16 a[12:13], v14 offset:32776
    ds_read_b64_tr_b16 a[14:15], v14 offset:33288
    ds_read_b64_tr_b16 a[16:17], v13 offset:36864
    ds_read_b64_tr_b16 a[18:19], v13 offset:37376
    ds_read_b64_tr_b16 a[20:21], v13 offset:36872
    ds_read_b64_tr_b16 a[22:23], v13 offset:37384
    ds_read_b64_tr_b16 a[24:25], v14 offset:36864
    ds_read_b64_tr_b16 a[26:27], v14 offset:37376
    ds_read_b64_tr_b16 a[28:29], v14 offset:36872
    ds_read_b64_tr_b16 a[30:31], v14 offset:37384
    ds_read_b64_tr_b16 a[32:33], v15 offset:0
    ds_read_b64_tr_b16 a[34:35], v15 offset:512
    ds_read_b64_tr_b16 a[36:37], v15 offset:8
    ds_read_b64_tr_b16 a[38:39], v15 offset:520
    ds_read_b64_tr_b16 a[40:41], v16 offset:0
    ds_read_b64_tr_b16 a[42:43], v16 offset:512
    ds_read_b64_tr_b16 a[44:45], v16 offset:8
    ds_read_b64_tr_b16 a[46:47], v16 offset:520
    ds_read_b64_tr_b16 v[240:241], v15 offset:4096
    ds_read_b64_tr_b16 v[242:243], v15 offset:4608
    ds_read_b64_tr_b16 v[244:245], v15 offset:4104
    ds_read_b64_tr_b16 v[246:247], v15 offset:4616
    ds_read_b64_tr_b16 v[248:249], v16 offset:4096
    ds_read_b64_tr_b16 v[250:251], v16 offset:4608
    ds_read_b64_tr_b16 v[252:253], v16 offset:4104
    ds_read_b64_tr_b16 v[254:255], v16 offset:4616
    s_waitcnt vmcnt(0)
    s_barrier
    s_cmp_lg_u32 s48, 0
    s_cbranch_scc1 SK_22
    v_lshlrev_b32 v62, 11, v0
    v_mov_b32 v63, 1
    s_mov_b64 exec, 0xff
    buffer_store_dword v63, v62, s[36:39], s68 offen sc1
    s_mov_b64 exec, -1
SK_22:
    s_add_u32 m0, s58, 32768
    s_add_u32 s100, s81, 0
    buffer_load_dwordx4 v18, s[20:23], s100 offen offset:0 lds
    buffer_load_dwordx4 v32, s[20:23], s100 offen offset:1024 lds
    buffer_load_dwordx4 v33, s[20:23], s100 offen offset:2048 lds
    s_add_u32 m0, s58, 35840
    s_add_u32 s100, s81, 132096
    buffer_load_dwordx4 v18, s[20:23], s100 offen offset:0 lds
    buffer_load_dwordx4 v32, s[20:23], s100 offen offset:1024 lds
    buffer_load_dwordx4 v33, s[20:23], s100 offen offset:2048 lds
    s_add_u32 m0, s58, 38912
    s_add_u32 s100, s81, 264192
    buffer_load_dwordx4 v18, s[20:23], s100 offen offset:0 lds
    buffer_load_dwordx4 v32, s[20:23], s100 offen offset:1024 lds
    s_lshl_b32 s73, s51, 13
    s_mov_b32 s74, 2097152
    s_lshl_b32 s61, s48, 9
    s_lshl_b32 s62, s49, 11
    s_add_u32 s61, s61, s62
    s_lshl_b32 s62, s51, 14
    v_lshlrev_b32 v62, 3, v30
    v_add_u32 v62, v62, v31
    s_add_u32 s61, s61, s62
    s_add_u32 s61, s61, 0
    s_mov_b32 s85, 1
    buffer_load_dword v64, v62, s[36:39], s61 offen sc1
    v_add_u32 v3, 12288, v1
    v_add_u32 v4, 24576, v1
    v_add_u32 v38, 36864, v1
    v_and_b32 v39, 12, v28
    s_mov_b32 s65, s61
    s_add_u32 s61, s58, 0
    v_add_u32 v61, s61, v1
    v_add_u32 v60, 65536, v61
    s_add_u32 s60, s48, 1
    s_and_b32 s60, s60, 3
    s_lshl_b32 s60, s60, 13
    s_add_u32 s60, s60, 65536
    v_add_u32 v57, s60, v1
    s_add_u32 s60, s48, 2
    s_and_b32 s60, s60, 3
    s_lshl_b32 s60, s60, 13
    s_add_u32 s60, s60, 4096
    v_add_u32 v58, s60, v1
    s_add_u32 s60, s48, 3
    s_and_b32 s60, s60, 3
    s_lshl_b32 s60, s60, 13
    s_add_u32 s60, s60, 0
    v_add_u32 v59, s60, v1
    s_mul_i32 s63, s48, 10240
    s_mul_i32 s62, s51, 40960
    s_add_u32 s63, s63, s62
    s_add_u32 s63, s63, 114688
    s_lshl_b32 s62, s48, 12
    s_add_u32 s62, s62, s74
    s_add_u32 s62, s62, 2097152
    v_lshlrev_b32 v40, 16, v20
    v_and_b32 v41, 0xffff0000, v20
    v_lshlrev_b32 v42, 16, v21
    v_and_b32 v43, 0xffff0000, v21
    v_lshlrev_b32 v44, 16, v22
    v_and_b32 v45, 0xffff0000, v22
    v_lshlrev_b32 v46, 16, v23
    v_and_b32 v47, 0xffff0000, v23
    v_lshlrev_b32 v48, 16, v24
    v_and_b32 v49, 0xffff0000, v24
    v_lshlrev_b32 v50, 16, v25
    v_and_b32 v51, 0xffff0000, v25
    v_lshlrev_b32 v52, 16, v26
    v_and_b32 v53, 0xffff0000, v26
    v_lshlrev_b32 v54, 16, v27
    v_and_b32 v55, 0xffff0000, v27
    v_mov_b32 v20, s78
    v_mov_b32 v21, s78
    v_mov_b32 v22, s78
    v_mov_b32 v23, s78
    s_waitcnt vmcnt(0)
    v_and_b32 v64, s85, v64
    v_cmp_ne_u32 vcc, s85, v64
    s_nop 0
    s_cmp_eq_u64 vcc, 0
    s_cbranch_scc1 POLLD_24
    v_lshrrev_b32 v65, 4, v0
    v_mul_u32_u24 v65, 2752, v65
    v_and_b32 v66, 15, v0
    v_min_u32 v66, 12, v66
    v_lshl_add_u32 v65, v66, 7, v65
    s_add_u32 s60, s87, 0
    buffer_load_dword a224, v65, s[20:23], s60 offen
    s_mov_b32 s72, 30000
POLL_23:
    buffer_load_dword v63, v62, s[36:39], s65 offen sc1
    s_waitcnt vmcnt(0)
    v_and_b32 v63, s85, v63
    v_cmp_ne_u32 vcc, s85, v63
    s_nop 0
    s_cmp_eq_u64 vcc, 0
    s_cbranch_scc1 POLLD_24
    s_sub_u32 s72, s72, 1
    s_cbranch_scc0 POLL_23
POLLD_24:
    buffer_load_dwordx4 v[128:131], v1, s[36:39], s63 offen sc1
    buffer_load_dwordx4 v[132:135], v1, s[36:39], s63 offen offset:1280 sc1
    buffer_load_dwordx4 v[160:163], v34, s[36:39], s63 offen sc1
    s_add_u32 s63, s63, 2560
    s_lshl_b32 s64, s91, 14
    s_add_u32 s64, s64, s62
    buffer_load_dwordx4 v[176:179], v1, s[36:39], s64 offen offset:0 sc1
    buffer_load_dwordx4 v[136:139], v1, s[36:39], s63 offen sc1
    buffer_load_dwordx4 v[140:143], v1, s[36:39], s63 offen offset:1280 sc1
    buffer_load_dwordx4 v[164:167], v34, s[36:39], s63 offen sc1
    s_add_u32 s63, s63, 2560
    buffer_load_dwordx4 v[180:183], v1, s[36:39], s64 offen offset:1024 sc1
    buffer_load_dwordx4 v[144:147], v1, s[36:39], s63 offen sc1
    buffer_load_dwordx4 v[148:151], v1, s[36:39], s63 offen offset:1280 sc1
    buffer_load_dwordx4 v[168:171], v34, s[36:39], s63 offen sc1
    s_add_u32 s63, s63, 2560
    buffer_load_dwordx4 v[184:187], v1, s[36:39], s64 offen offset:2048 sc1
    buffer_load_dwordx4 v[152:155], v1, s[36:39], s63 offen sc1
    buffer_load_dwordx4 v[156:159], v1, s[36:39], s63 offen offset:1280 sc1
    buffer_load_dwordx4 v[172:175], v34, s[36:39], s63 offen sc1
    buffer_load_dwordx4 v[188:191], v1, s[36:39], s64 offen offset:3072 sc1
    s_lshl_b32 s64, s92, 14
    s_add_u32 s64, s64, s62
    buffer_load_dwordx4 v[192:195], v1, s[36:39], s64 offen offset:0 sc1
    buffer_load_dwordx4 v[196:199], v1, s[36:39], s64 offen offset:1024 sc1
    buffer_load_dwordx4 v[200:203], v1, s[36:39], s64 offen offset:2048 sc1
    buffer_load_dwordx4 v[204:207], v1, s[36:39], s64 offen offset:3072 sc1
    s_mov_b32 s44, s36
    s_mov_b32 s45, s37
    s_mov_b32 s46, s38
    s_mov_b32 s47, s39
    s_lshl_b32 s89, s94, 14
    s_lshl_b32 s61, s55, 11
    s_add_u32 s89, s89, s61
    s_add_u32 s89, s89, s74
    s_add_u32 s89, s89, 6291456
    s_mov_b32 s88, 1024
    v_mov_b32 v56, v1
    s_lshr_b32 s69, s94, 1
    s_lshl_b32 s69, s69, 5
    s_add_u32 s69, s69, s55
    s_lshl_b32 s69, s69, 2
    s_and_b32 s61, s48, 1
    s_add_u32 s69, s69, s61
    s_add_u32 s68, s69, s73
    s_add_u32 s68, s68, 32768
    s_lshl_b32 s59, s94, 10
    s_lshl_b32 s61, s55, 7
    s_add_u32 s59, s59, s61
    s_lshl_b32 s67, s51, 17
    s_add_u32 s67, s67, 1048576
    s_add_u32 s66, s67, s59
    s_waitcnt lgkmcnt(0)
    s_waitcnt vmcnt(17)
    v_cvt_pk_bf16_f32 v128, v128, v129
    v_cvt_pk_bf16_f32 v129, v130, v131
    v_cvt_pk_bf16_f32 v132, v132, v133
    v_cvt_pk_bf16_f32 v133, v134, v135
    v_mov_b32 v130, 0
    v_mov_b32 v131, 0
    v_cvt_pk_bf16_f32 v160, v160, v161
    v_cvt_pk_bf16_f32 v161, v162, v163
    v_and_b32 v162, v36, v160
    v_and_b32 v163, v36, v161
    v_and_b32 v160, v35, v160
    v_and_b32 v161, v35, v161
    s_waitcnt vmcnt(16)
    s_nop 0
    v_mfma_f32_16x16x32_bf16 v[104:107], v[160:163], v[176:179], v[20:23]
    v_mfma_f32_16x16x32_bf16 v[96:99], v[128:131], v[176:179], 0
    v_mfma_f32_16x16x32_bf16 v[100:103], v[130:133], v[176:179], 0
    s_lshl_b32 s64, s93, 14
    s_add_u32 s64, s64, s62
    buffer_load_dwordx4 v[208:211], v1, s[36:39], s64 offen offset:0 sc1
    s_waitcnt vmcnt(14)
    v_cvt_pk_bf16_f32 v136, v136, v137
    v_cvt_pk_bf16_f32 v137, v138, v139
    v_cvt_pk_bf16_f32 v140, v140, v141
    v_cvt_pk_bf16_f32 v141, v142, v143
    v_mov_b32 v138, 0
    v_mov_b32 v139, 0
    v_cvt_pk_bf16_f32 v164, v164, v165
    v_cvt_pk_bf16_f32 v165, v166, v167
    v_and_b32 v166, v36, v164
    v_and_b32 v167, v36, v165
    v_and_b32 v164, v35, v164
    v_and_b32 v165, v35, v165
    s_waitcnt vmcnt(13)
    s_nop 0
    v_mfma_f32_16x16x32_bf16 v[116:119], v[164:167], v[180:183], v[20:23]
    v_mfma_f32_16x16x32_bf16 v[108:111], v[136:139], v[180:183], 0
    v_mfma_f32_16x16x32_bf16 v[112:115], v[138:141], v[180:183], 0
    buffer_load_dwordx4 v[212:215], v1, s[36:39], s64 offen offset:1024 sc1
    v_rcp_f32 v24, v104
    v_rcp_f32 v25, v105
    v_mul_f32 v96, v96, v24
    v_mul_f32 v97, v97, v24
    v_cvt_pk_bf16_f32 v120, v96, v97
    v_mul_f32 v98, v98, v24
    v_mul_f32 v99, v99, v24
    v_cvt_pk_bf16_f32 v121, v98, v99
    v_mul_f32 v100, v100, v25
    v_mul_f32 v101, v101, v25
    v_cvt_pk_bf16_f32 v122, v100, v101
    v_mul_f32 v102, v102, v25
    v_mul_f32 v103, v103, v25
    v_cvt_pk_bf16_f32 v123, v102, v103
    s_nop 1
    v_mfma_f32_16x16x32_bf16 v[64:67], a[0:3], v[120:123], 0
    v_rcp_f32 v26, v116
    v_rcp_f32 v27, v117
    s_waitcnt vmcnt(11)
    v_cvt_pk_bf16_f32 v144, v144, v145
    v_cvt_pk_bf16_f32 v145, v146, v147
    v_cvt_pk_bf16_f32 v148, v148, v149
    v_cvt_pk_bf16_f32 v149, v150, v151
    v_mov_b32 v146, 0
    v_mov_b32 v147, 0
    v_cvt_pk_bf16_f32 v168, v168, v169
    v_cvt_pk_bf16_f32 v169, v170, v171
    v_and_b32 v170, v36, v168
    v_and_b32 v171, v36, v169
    v_and_b32 v168, v35, v168
    v_and_b32 v169, v35, v169
    s_waitcnt vmcnt(10)
    s_nop 0
    v_mfma_f32_16x16x32_bf16 v[104:107], v[168:171], v[184:187], v[20:23]
    v_mul_f32 v108, v108, v26
    v_mul_f32 v109, v109, v26
    v_mfma_f32_16x16x32_bf16 v[68:71], a[4:7], v[120:123], 0
    v_cvt_pk_bf16_f32 v124, v108, v109
    v_mul_f32 v110, v110, v26
    v_mfma_f32_16x16x32_bf16 v[96:99], v[144:147], v[184:187], 0
    v_mul_f32 v111, v111, v26
    v_cvt_pk_bf16_f32 v125, v110, v111
    v_mfma_f32_16x16x32_bf16 v[72:75], a[8:11], v[120:123], 0
    v_mul_f32 v112, v112, v27
    v_mul_f32 v113, v113, v27
    v_mfma_f32_16x16x32_bf16 v[100:103], v[146:149], v[184:187], 0
    v_cvt_pk_bf16_f32 v126, v112, v113
    v_mul_f32 v114, v114, v27
    v_mfma_f32_16x16x32_bf16 v[76:79], a[12:15], v[120:123], 0
    v_mul_f32 v115, v115, v27
    v_cvt_pk_bf16_f32 v127, v114, v115
    buffer_load_dwordx4 v[216:219], v1, s[36:39], s64 offen offset:2048 sc1
    s_nop 0
    v_mfma_f32_16x16x32_bf16 v[64:67], a[16:19], v[124:127], v[64:67]
    v_rcp_f32 v24, v104
    v_rcp_f32 v25, v105
    s_waitcnt vmcnt(8)
    v_cvt_pk_bf16_f32 v152, v152, v153
    v_cvt_pk_bf16_f32 v153, v154, v155
    v_cvt_pk_bf16_f32 v156, v156, v157
    v_cvt_pk_bf16_f32 v157, v158, v159
    v_mov_b32 v154, 0
    v_mov_b32 v155, 0
    v_cvt_pk_bf16_f32 v172, v172, v173
    v_cvt_pk_bf16_f32 v173, v174, v175
    v_and_b32 v174, v36, v172
    v_and_b32 v175, v36, v173
    v_and_b32 v172, v35, v172
    v_and_b32 v173, v35, v173
    s_waitcnt vmcnt(7)
    s_nop 0
    v_mfma_f32_16x16x32_bf16 v[116:119], v[172:175], v[188:191], v[20:23]
    v_mul_f32 v96, v96, v24
    v_mul_f32 v97, v97, v24
    v_mfma_f32_16x16x32_bf16 v[68:71], a[20:23], v[124:127], v[68:71]
    v_cvt_pk_bf16_f32 v120, v96, v97
    v_mul_f32 v98, v98, v24
    v_mfma_f32_16x16x32_bf16 v[108:111], v[152:155], v[188:191], 0
    v_mul_f32 v99, v99, v24
    v_cvt_pk_bf16_f32 v121, v98, v99
    v_mfma_f32_16x16x32_bf16 v[72:75], a[24:27], v[124:127], v[72:75]
    v_mul_f32 v100, v100, v25
    v_mul_f32 v101, v101, v25
    v_mfma_f32_16x16x32_bf16 v[112:115], v[154:157], v[188:191], 0
    v_cvt_pk_bf16_f32 v122, v100, v101
    v_mul_f32 v102, v102, v25
    v_mfma_f32_16x16x32_bf16 v[76:79], a[28:31], v[124:127], v[76:79]
    v_mul_f32 v103, v103, v25
    v_cvt_pk_bf16_f32 v123, v102, v103
    buffer_load_dwordx4 v[220:223], v1, s[36:39], s64 offen offset:3072 sc1
    s_nop 0
    v_mfma_f32_16x16x32_bf16 v[64:67], a[32:35], v[120:123], v[64:67]
    v_rcp_f32 v26, v116
    v_rcp_f32 v27, v117
    s_waitcnt vmcnt(7)
    v_mfma_f32_16x16x32_bf16 v[104:107], v[160:163], v[192:195], v[20:23]
    v_mul_f32 v108, v108, v26
    v_mul_f32 v109, v109, v26
    v_mfma_f32_16x16x32_bf16 v[68:71], a[36:39], v[120:123], v[68:71]
    v_cvt_pk_bf16_f32 v124, v108, v109
    v_mul_f32 v110, v110, v26
    v_mfma_f32_16x16x32_bf16 v[96:99], v[128:131], v[192:195], 0
    v_mul_f32 v111, v111, v26
    v_cvt_pk_bf16_f32 v125, v110, v111
    v_mfma_f32_16x16x32_bf16 v[72:75], a[40:43], v[120:123], v[72:75]
    v_mul_f32 v112, v112, v27
    v_mul_f32 v113, v113, v27
    v_mfma_f32_16x16x32_bf16 v[100:103], v[130:133], v[192:195], 0
    v_cvt_pk_bf16_f32 v126, v112, v113
    v_mul_f32 v114, v114, v27
    v_mfma_f32_16x16x32_bf16 v[76:79], a[44:47], v[120:123], v[76:79]
    v_mul_f32 v115, v115, v27
    v_cvt_pk_bf16_f32 v127, v114, v115
    s_lshl_b32 s64, s94, 14
    s_add_u32 s64, s64, s62
    buffer_load_dwordx4 v[224:227], v1, s[36:39], s64 offen offset:0 sc1
    v_mfma_f32_16x16x32_bf16 v[64:67], v[240:243], v[124:127], v[64:67]
    v_rcp_f32 v24, v104
    v_rcp_f32 v25, v105
    s_waitcnt vmcnt(7)
    v_mfma_f32_16x16x32_bf16 v[116:119], v[164:167], v[196:199], v[20:23]
    v_mul_f32 v96, v96, v24
    v_mul_f32 v97, v97, v24
    v_mfma_f32_16x16x32_bf16 v[68:71], v[244:247], v[124:127], v[68:71]
    v_cvt_pk_bf16_f32 v120, v96, v97
    v_mul_f32 v98, v98, v24
    v_mfma_f32_16x16x32_bf16 v[108:111], v[136:139], v[196:199], 0
    v_mul_f32 v99, v99, v24
    v_cvt_pk_bf16_f32 v121, v98, v99
    v_mfma_f32_16x16x32_bf16 v[72:75], v[248:251], v[124:127], v[72:75]
    v_mul_f32 v100, v100, v25
    v_mul_f32 v101, v101, v25
    v_mfma_f32_16x16x32_bf16 v[112:115], v[138:141], v[196:199], 0
    v_cvt_pk_bf16_f32 v122, v100, v101
    v_mul_f32 v102, v102, v25
    v_mfma_f32_16x16x32_bf16 v[76:79], v[252:255], v[124:127], v[76:79]
    v_mul_f32 v103, v103, v25
    v_cvt_pk_bf16_f32 v123, v102, v103
    buffer_load_dwordx4 v[228:231], v1, s[36:39], s64 offen offset:1024 sc1
    s_nop 0
    v_mfma_f32_16x16x32_bf16 v[80:83], a[0:3], v[120:123], 0
    v_rcp_f32 v26, v116
    v_rcp_f32 v27, v117
    s_waitcnt vmcnt(7)
    v_mfma_f32_16x16x32_bf16 v[104:107], v[168:171], v[200:203], v[20:23]
    v_mul_f32 v108, v108, v26
    v_mul_f32 v109, v109, v26
    v_mfma_f32_16x16x32_bf16 v[84:87], a[4:7], v[120:123], 0
    v_cvt_pk_bf16_f32 v124, v108, v109
    v_mul_f32 v110, v110, v26
    v_mfma_f32_16x16x32_bf16 v[96:99], v[144:147], v[200:203], 0
    v_mul_f32 v111, v111, v26
    v_cvt_pk_bf16_f32 v125, v110, v111
    v_mfma_f32_16x16x32_bf16 v[88:91], a[8:11], v[120:123], 0
    v_mul_f32 v112, v112, v27
    v_mul_f32 v113, v113, v27
    v_mfma_f32_16x16x32_bf16 v[100:103], v[146:149], v[200:203], 0
    v_cvt_pk_bf16_f32 v126, v112, v113
    v_mul_f32 v114, v114, v27
    v_mfma_f32_16x16x32_bf16 v[92:95], a[12:15], v[120:123], 0
    v_mul_f32 v115, v115, v27
    v_cvt_pk_bf16_f32 v127, v114, v115
    buffer_load_dwordx4 v[232:235], v1, s[36:39], s64 offen offset:2048 sc1
    s_nop 0
    v_mfma_f32_16x16x32_bf16 v[80:83], a[16:19], v[124:127], v[80:83]
    v_rcp_f32 v24, v104
    v_rcp_f32 v25, v105
    s_waitcnt vmcnt(7)
    v_mfma_f32_16x16x32_bf16 v[116:119], v[172:175], v[204:207], v[20:23]
    v_mul_f32 v96, v96, v24
    v_mul_f32 v97, v97, v24
    v_mfma_f32_16x16x32_bf16 v[84:87], a[20:23], v[124:127], v[84:87]
    v_cvt_pk_bf16_f32 v120, v96, v97
    v_mul_f32 v98, v98, v24
    v_mfma_f32_16x16x32_bf16 v[108:111], v[152:155], v[204:207], 0
    v_mul_f32 v99, v99, v24
    v_cvt_pk_bf16_f32 v121, v98, v99
    v_mfma_f32_16x16x32_bf16 v[88:91], a[24:27], v[124:127], v[88:91]
    v_mul_f32 v100, v100, v25
    v_mul_f32 v101, v101, v25
    v_mfma_f32_16x16x32_bf16 v[112:115], v[154:157], v[204:207], 0
    v_cvt_pk_bf16_f32 v122, v100, v101
    v_mul_f32 v102, v102, v25
    v_mfma_f32_16x16x32_bf16 v[92:95], a[28:31], v[124:127], v[92:95]
    v_mul_f32 v103, v103, v25
    v_cvt_pk_bf16_f32 v123, v102, v103
    buffer_load_dwordx4 v[236:239], v1, s[36:39], s64 offen offset:3072 sc1
    ds_write_b128 v61, v[64:67] offset:0
    ds_write_b128 v61, v[68:71] offset:1024
    v_mfma_f32_16x16x32_bf16 v[80:83], a[32:35], v[120:123], v[80:83]
    v_rcp_f32 v26, v116
    v_rcp_f32 v27, v117
    s_waitcnt vmcnt(7)
    v_mfma_f32_16x16x32_bf16 v[104:107], v[160:163], v[208:211], v[20:23]
    v_mul_f32 v108, v108, v26
    v_mul_f32 v109, v109, v26
    v_mfma_f32_16x16x32_bf16 v[84:87], a[36:39], v[120:123], v[84:87]
    v_cvt_pk_bf16_f32 v124, v108, v109
    v_mul_f32 v110, v110, v26
    v_mfma_f32_16x16x32_bf16 v[96:99], v[128:131], v[208:211], 0
    v_mul_f32 v111, v111, v26
    v_cvt_pk_bf16_f32 v125, v110, v111
    s_add_u32 m0, s58, 98304
    s_add_u32 s100, s81, 0
    buffer_load_dwordx4 v18, s[16:19], s100 offen offset:0 lds
    v_mfma_f32_16x16x32_bf16 v[88:91], a[40:43], v[120:123], v[88:91]
    v_mul_f32 v112, v112, v27
    v_mul_f32 v113, v113, v27
    v_mfma_f32_16x16x32_bf16 v[100:103], v[130:133], v[208:211], 0
    v_cvt_pk_bf16_f32 v126, v112, v113
    v_mul_f32 v114, v114, v27
    v_mfma_f32_16x16x32_bf16 v[92:95], a[44:47], v[120:123], v[92:95]
    v_mul_f32 v115, v115, v27
    v_cvt_pk_bf16_f32 v127, v114, v115
    buffer_load_dwordx4 v32, s[16:19], s100 offen offset:1024 lds
    ds_write_b128 v61, v[72:75] offset:2048
    ds_write_b128 v61, v[76:79] offset:3072
    v_mfma_f32_16x16x32_bf16 v[80:83], v[240:243], v[124:127], v[80:83]
    v_rcp_f32 v24, v104
    v_rcp_f32 v25, v105
    s_waitcnt vmcnt(8)
    v_mfma_f32_16x16x32_bf16 v[116:119], v[164:167], v[212:215], v[20:23]
    v_mul_f32 v96, v96, v24
    v_mul_f32 v97, v97, v24
    v_mfma_f32_16x16x32_bf16 v[84:87], v[244:247], v[124:127], v[84:87]
    v_cvt_pk_bf16_f32 v120, v96, v97
    v_mul_f32 v98, v98, v24
    v_mfma_f32_16x16x32_bf16 v[108:111], v[136:139], v[212:215], 0
    v_mul_f32 v99, v99, v24
    v_cvt_pk_bf16_f32 v121, v98, v99
    buffer_load_dwordx4 v33, s[16:19], s100 offen offset:2048 lds
    v_mfma_f32_16x16x32_bf16 v[88:91], v[248:251], v[124:127], v[88:91]
    v_mul_f32 v100, v100, v25
    v_mul_f32 v101, v101, v25
    v_mfma_f32_16x16x32_bf16 v[112:115], v[138:141], v[212:215], 0
    v_cvt_pk_bf16_f32 v122, v100, v101
    v_mul_f32 v102, v102, v25
    v_mfma_f32_16x16x32_bf16 v[92:95], v[252:255], v[124:127], v[92:95]
    v_mul_f32 v103, v103, v25
    v_cvt_pk_bf16_f32 v123, v102, v103
    s_add_u32 m0, s58, 131072
    s_add_u32 s100, s81, 64
    buffer_load_dwordx4 v18, s[16:19], s100 offen offset:0 lds
    v_mfma_f32_16x16x32_bf16 v[64:67], a[0:3], v[120:123], 0
    v_rcp_f32 v26, v116
    v_rcp_f32 v27, v117
    s_waitcnt vmcnt(9)
    v_mfma_f32_16x16x32_bf16 v[104:107], v[168:171], v[216:219], v[20:23]
    v_mul_f32 v108, v108, v26
    v_mul_f32 v109, v109, v26
    v_mfma_f32_16x16x32_bf16 v[68:71], a[4:7], v[120:123], 0
    v_cvt_pk_bf16_f32 v124, v108, v109
    v_mul_f32 v110, v110, v26
    v_mfma_f32_16x16x32_bf16 v[96:99], v[144:147], v[216:219], 0
    v_mul_f32 v111, v111, v26
    v_cvt_pk_bf16_f32 v125, v110, v111
    buffer_load_dwordx4 v32, s[16:19], s100 offen offset:1024 lds
    v_mfma_f32_16x16x32_bf16 v[72:75], a[8:11], v[120:123], 0
    v_mul_f32 v112, v112, v27
    v_mul_f32 v113, v113, v27
    v_mfma_f32_16x16x32_bf16 v[100:103], v[146:149], v[216:219], 0
    v_cvt_pk_bf16_f32 v126, v112, v113
    v_mul_f32 v114, v114, v27
    v_mfma_f32_16x16x32_bf16 v[76:79], a[12:15], v[120:123], 0
    v_mul_f32 v115, v115, v27
    v_cvt_pk_bf16_f32 v127, v114, v115
    buffer_load_dwordx4 v33, s[16:19], s100 offen offset:2048 lds
    s_nop 0
    v_mfma_f32_16x16x32_bf16 v[64:67], a[16:19], v[124:127], v[64:67]
    v_rcp_f32 v24, v104
    v_rcp_f32 v25, v105
    s_waitcnt vmcnt(10)
    v_mfma_f32_16x16x32_bf16 v[116:119], v[172:175], v[220:223], v[20:23]
    v_mul_f32 v96, v96, v24
    v_mul_f32 v97, v97, v24
    v_mfma_f32_16x16x32_bf16 v[68:71], a[20:23], v[124:127], v[68:71]
    v_cvt_pk_bf16_f32 v120, v96, v97
    v_mul_f32 v98, v98, v24
    v_mfma_f32_16x16x32_bf16 v[108:111], v[152:155], v[220:223], 0
    v_mul_f32 v99, v99, v24
    v_cvt_pk_bf16_f32 v121, v98, v99
    s_add_u32 m0, s58, 101376
    s_add_u32 s100, s81, 132096
    buffer_load_dwordx4 v18, s[16:19], s100 offen offset:0 lds
    v_mfma_f32_16x16x32_bf16 v[72:75], a[24:27], v[124:127], v[72:75]
    v_mul_f32 v100, v100, v25
    v_mul_f32 v101, v101, v25
    v_mfma_f32_16x16x32_bf16 v[112:115], v[154:157], v[220:223], 0
    v_cvt_pk_bf16_f32 v122, v100, v101
    v_mul_f32 v102, v102, v25
    v_mfma_f32_16x16x32_bf16 v[76:79], a[28:31], v[124:127], v[76:79]
    v_mul_f32 v103, v103, v25
    v_cvt_pk_bf16_f32 v123, v102, v103
    buffer_load_dwordx4 v32, s[16:19], s100 offen offset:1024 lds
    ds_write_b128 v61, v[80:83] offset:4096
    ds_write_b128 v61, v[84:87] offset:5120
    v_mfma_f32_16x16x32_bf16 v[64:67], a[32:35], v[120:123], v[64:67]
    v_rcp_f32 v26, v116
    v_rcp_f32 v27, v117
    s_waitcnt vmcnt(11)
    v_mfma_f32_16x16x32_bf16 v[104:107], v[160:163], v[224:227], v[20:23]
    v_mul_f32 v108, v108, v26
    v_mul_f32 v109, v109, v26
    v_mfma_f32_16x16x32_bf16 v[68:71], a[36:39], v[120:123], v[68:71]
    v_cvt_pk_bf16_f32 v124, v108, v109
    v_mul_f32 v110, v110, v26
    v_mfma_f32_16x16x32_bf16 v[96:99], v[128:131], v[224:227], 0
    v_mul_f32 v111, v111, v26
    v_cvt_pk_bf16_f32 v125, v110, v111
    buffer_load_dwordx4 v33, s[16:19], s100 offen offset:2048 lds
    v_mfma_f32_16x16x32_bf16 v[72:75], a[40:43], v[120:123], v[72:75]
    v_mul_f32 v112, v112, v27
    v_mul_f32 v113, v113, v27
    v_mfma_f32_16x16x32_bf16 v[100:103], v[130:133], v[224:227], 0
    v_cvt_pk_bf16_f32 v126, v112, v113
    v_mul_f32 v114, v114, v27
    v_mfma_f32_16x16x32_bf16 v[76:79], a[44:47], v[120:123], v[76:79]
    v_mul_f32 v115, v115, v27
    v_cvt_pk_bf16_f32 v127, v114, v115
    s_add_u32 m0, s58, 134144
    s_add_u32 s100, s81, 132160
    buffer_load_dwordx4 v18, s[16:19], s100 offen offset:0 lds
    ds_write_b128 v61, v[88:91] offset:6144
    ds_write_b128 v61, v[92:95] offset:7168
    v_mfma_f32_16x16x32_bf16 v[64:67], v[240:243], v[124:127], v[64:67]
    v_rcp_f32 v24, v104
    v_rcp_f32 v25, v105
    s_waitcnt vmcnt(12)
    v_mfma_f32_16x16x32_bf16 v[116:119], v[164:167], v[228:231], v[20:23]
    v_mul_f32 v96, v96, v24
    v_mul_f32 v97, v97, v24
    v_mfma_f32_16x16x32_bf16 v[68:71], v[244:247], v[124:127], v[68:71]
    v_cvt_pk_bf16_f32 v120, v96, v97
    v_mul_f32 v98, v98, v24
    v_mfma_f32_16x16x32_bf16 v[108:111], v[136:139], v[228:231], 0
    v_mul_f32 v99, v99, v24
    v_cvt_pk_bf16_f32 v121, v98, v99
    buffer_load_dwordx4 v32, s[16:19], s100 offen offset:1024 lds
    v_mfma_f32_16x16x32_bf16 v[72:75], v[248:251], v[124:127], v[72:75]
    v_mul_f32 v100, v100, v25
    v_mul_f32 v101, v101, v25
    v_mfma_f32_16x16x32_bf16 v[112:115], v[138:141], v[228:231], 0
    v_cvt_pk_bf16_f32 v122, v100, v101
    v_mul_f32 v102, v102, v25
    v_mfma_f32_16x16x32_bf16 v[76:79], v[252:255], v[124:127], v[76:79]
    v_mul_f32 v103, v103, v25
    v_cvt_pk_bf16_f32 v123, v102, v103
    buffer_load_dwordx4 v33, s[16:19], s100 offen offset:2048 lds
    s_nop 0
    v_mfma_f32_16x16x32_bf16 v[80:83], a[0:3], v[120:123], v[40:43]
    v_rcp_f32 v26, v116
    v_rcp_f32 v27, v117
    s_waitcnt vmcnt(13)
    v_mfma_f32_16x16x32_bf16 v[104:107], v[168:171], v[232:235], v[20:23]
    v_mul_f32 v108, v108, v26
    v_mul_f32 v109, v109, v26
    v_mfma_f32_16x16x32_bf16 v[84:87], a[4:7], v[120:123], v[44:47]
    v_cvt_pk_bf16_f32 v124, v108, v109
    v_mul_f32 v110, v110, v26
    v_mfma_f32_16x16x32_bf16 v[96:99], v[144:147], v[232:235], 0
    v_mul_f32 v111, v111, v26
    v_cvt_pk_bf16_f32 v125, v110, v111
    s_add_u32 m0, s58, 104448
    s_add_u32 s100, s81, 264192
    buffer_load_dwordx4 v18, s[16:19], s100 offen offset:0 lds
    v_mfma_f32_16x16x32_bf16 v[88:91], a[8:11], v[120:123], v[48:51]
    v_mul_f32 v112, v112, v27
    v_mul_f32 v113, v113, v27
    v_mfma_f32_16x16x32_bf16 v[100:103], v[146:149], v[232:235], 0
    v_cvt_pk_bf16_f32 v126, v112, v113
    v_mul_f32 v114, v114, v27
    v_mfma_f32_16x16x32_bf16 v[92:95], a[12:15], v[120:123], v[52:55]
    v_mul_f32 v115, v115, v27
    v_cvt_pk_bf16_f32 v127, v114, v115
    buffer_load_dwordx4 v32, s[16:19], s100 offen offset:1024 lds
    s_nop 0
    v_mfma_f32_16x16x32_bf16 v[80:83], a[16:19], v[124:127], v[80:83]
    v_rcp_f32 v24, v104
    v_rcp_f32 v25, v105
    s_waitcnt vmcnt(14)
    v_mfma_f32_16x16x32_bf16 v[116:119], v[172:175], v[236:239], v[20:23]
    v_mul_f32 v96, v96, v24
    v_mul_f32 v97, v97, v24
    v_mfma_f32_16x16x32_bf16 v[84:87], a[20:23], v[124:127], v[84:87]
    v_cvt_pk_bf16_f32 v120, v96, v97
    v_mul_f32 v98, v98, v24
    v_mfma_f32_16x16x32_bf16 v[108:111], v[152:155], v[236:239], 0
    v_mul_f32 v99, v99, v24
    v_cvt_pk_bf16_f32 v121, v98, v99
    s_add_u32 m0, s58, 137216
    s_add_u32 s100, s81, 264256
    buffer_load_dwordx4 v18, s[16:19], s100 offen offset:0 lds
    v_mfma_f32_16x16x32_bf16 v[88:91], a[24:27], v[124:127], v[88:91]
    v_mul_f32 v100, v100, v25
    v_mul_f32 v101, v101, v25
    v_mfma_f32_16x16x32_bf16 v[112:115], v[154:157], v[236:239], 0
    v_cvt_pk_bf16_f32 v122, v100, v101
    v_mul_f32 v102, v102, v25
    v_mfma_f32_16x16x32_bf16 v[92:95], a[28:31], v[124:127], v[92:95]
    v_mul_f32 v103, v103, v25
    v_cvt_pk_bf16_f32 v123, v102, v103
    buffer_load_dwordx4 v32, s[16:19], s100 offen offset:1024 lds
    ds_write_b128 v60, v[64:67] offset:0
    ds_write_b128 v60, v[68:71] offset:1024
    v_mfma_f32_16x16x32_bf16 v[80:83], a[32:35], v[120:123], v[80:83]
    v_rcp_f32 v26, v116
    v_rcp_f32 v27, v117
    v_mul_f32 v108, v108, v26
    v_mul_f32 v109, v109, v26
    v_mfma_f32_16x16x32_bf16 v[84:87], a[36:39], v[120:123], v[84:87]
    v_cvt_pk_bf16_f32 v124, v108, v109
    v_mul_f32 v110, v110, v26
    v_mul_f32 v111, v111, v26
    v_cvt_pk_bf16_f32 v125, v110, v111
    v_mfma_f32_16x16x32_bf16 v[88:91], a[40:43], v[120:123], v[88:91]
    v_mul_f32 v112, v112, v27
    v_mul_f32 v113, v113, v27
    v_cvt_pk_bf16_f32 v126, v112, v113
    v_mfma_f32_16x16x32_bf16 v[92:95], a[44:47], v[120:123], v[92:95]
    v_mul_f32 v114, v114, v27
    v_mul_f32 v115, v115, v27
    v_cvt_pk_bf16_f32 v127, v114, v115
    ds_write_b128 v60, v[72:75] offset:2048
    ds_write_b128 v60, v[76:79] offset:3072
    v_mfma_f32_16x16x32_bf16 v[80:83], v[240:243], v[124:127], v[80:83]
    v_mfma_f32_16x16x32_bf16 v[84:87], v[244:247], v[124:127], v[84:87]
    v_mfma_f32_16x16x32_bf16 v[88:91], v[248:251], v[124:127], v[88:91]
    v_mfma_f32_16x16x32_bf16 v[92:95], v[252:255], v[124:127], v[92:95]
    s_waitcnt lgkmcnt(0)
    s_barrier
    ds_read_b128 v[96:99], v57 offset:0
    ds_read_b128 v[100:103], v57 offset:1024
    ds_read_b128 v[104:107], v57 offset:2048
    ds_read_b128 v[108:111], v57 offset:3072
    ds_read_b128 v[112:115], v58 offset:0
    ds_read_b128 v[116:119], v58 offset:1024
    ds_read_b128 v[120:123], v58 offset:2048
    ds_read_b128 v[124:127], v58 offset:3072
    ds_read_b128 v[128:131], v59 offset:0
    ds_read_b128 v[132:135], v59 offset:1024
    ds_read_b128 v[136:139], v59 offset:2048
    ds_read_b128 v[140:143], v59 offset:3072
    s_waitcnt lgkmcnt(8)
    v_pk_add_f32 v[80:81], v[80:81], v[96:97] op_sel:[0,0] op_sel_hi:[1,1]
    v_pk_add_f32 v[82:83], v[82:83], v[98:99] op_sel:[0,0] op_sel_hi:[1,1]
    v_pk_add_f32 v[84:85], v[84:85], v[100:101] op_sel:[0,0] op_sel_hi:[1,1]
    v_pk_add_f32 v[86:87], v[86:87], v[102:103] op_sel:[0,0] op_sel_hi:[1,1]
    v_pk_add_f32 v[88:89], v[88:89], v[104:105] op_sel:[0,0] op_sel_hi:[1,1]
    v_pk_add_f32 v[90:91], v[90:91], v[106:107] op_sel:[0,0] op_sel_hi:[1,1]
    v_pk_add_f32 v[92:93], v[92:93], v[108:109] op_sel:[0,0] op_sel_hi:[1,1]
    v_pk_add_f32 v[94:95], v[94:95], v[110:111] op_sel:[0,0] op_sel_hi:[1,1]
    s_waitcnt lgkmcnt(4)
    v_pk_add_f32 v[80:81], v[80:81], v[112:113] op_sel:[0,0] op_sel_hi:[1,1]
    v_pk_add_f32 v[82:83], v[82:83], v[114:115] op_sel:[0,0] op_sel_hi:[1,1]
    v_pk_add_f32 v[84:85], v[84:85], v[116:117] op_sel:[0,0] op_sel_hi:[1,1]
    v_pk_add_f32 v[86:87], v[86:87], v[118:119] op_sel:[0,0] op_sel_hi:[1,1]
    v_pk_add_f32 v[88:89], v[88:89], v[120:121] op_sel:[0,0] op_sel_hi:[1,1]
    v_pk_add_f32 v[90:91], v[90:91], v[122:123] op_sel:[0,0] op_sel_hi:[1,1]
    v_pk_add_f32 v[92:93], v[92:93], v[124:125] op_sel:[0,0] op_sel_hi:[1,1]
    v_pk_add_f32 v[94:95], v[94:95], v[126:127] op_sel:[0,0] op_sel_hi:[1,1]
    s_waitcnt lgkmcnt(0)
    v_pk_add_f32 v[80:81], v[80:81], v[128:129] op_sel:[0,0] op_sel_hi:[1,1]
    v_cvt_pk_bf16_f32 v20, v80, v81
    v_pk_add_f32 v[82:83], v[82:83], v[130:131] op_sel:[0,0] op_sel_hi:[1,1]
    v_cvt_pk_bf16_f32 v21, v82, v83
    v_pk_add_f32 v[84:85], v[84:85], v[132:133] op_sel:[0,0] op_sel_hi:[1,1]
    v_cvt_pk_bf16_f32 v22, v84, v85
    v_pk_add_f32 v[86:87], v[86:87], v[134:135] op_sel:[0,0] op_sel_hi:[1,1]
    v_cvt_pk_bf16_f32 v23, v86, v87
    buffer_store_dwordx4 v[20:23], v56, s[44:47], s89 offen sc1
    s_add_u32 s89, s89, s88
    v_pk_add_f32 v[88:89], v[88:89], v[136:137] op_sel:[0,0] op_sel_hi:[1,1]
    v_cvt_pk_bf16_f32 v24, v88, v89
    v_pk_add_f32 v[90:91], v[90:91], v[138:139] op_sel:[0,0] op_sel_hi:[1,1]
    v_cvt_pk_bf16_f32 v25, v90, v91
    v_pk_add_f32 v[92:93], v[92:93], v[140:141] op_sel:[0,0] op_sel_hi:[1,1]
    v_cvt_pk_bf16_f32 v26, v92, v93
    v_pk_add_f32 v[94:95], v[94:95], v[142:143] op_sel:[0,0] op_sel_hi:[1,1]
    v_cvt_pk_bf16_f32 v27, v94, v95
    buffer_store_dwordx4 v[24:27], v56, s[44:47], s89 offen sc1
    v_dot2_f32_bf16 v40, v20, s75, 0
    v_dot2_f32_bf16 v41, v20, v20, 0
    v_dot2_f32_bf16 v40, v21, s75, v40
    v_dot2_f32_bf16 v41, v21, v21, v41
    v_dot2_f32_bf16 v40, v22, s75, v40
    v_dot2_f32_bf16 v41, v22, v22, v41
    v_dot2_f32_bf16 v40, v23, s75, v40
    v_dot2_f32_bf16 v41, v23, v23, v41
    v_dot2_f32_bf16 v40, v24, s75, v40
    v_dot2_f32_bf16 v41, v24, v24, v41
    v_dot2_f32_bf16 v40, v25, s75, v40
    v_dot2_f32_bf16 v41, v25, v25, v41
    v_dot2_f32_bf16 v40, v26, s75, v40
    v_dot2_f32_bf16 v41, v26, v26, v41
    v_dot2_f32_bf16 v40, v27, s75, v40
    v_dot2_f32_bf16 v41, v27, v27, v41
    s_nop 1
    v_mov_b32 v42, v40
    v_mov_b32 v43, v41
    s_nop 0
    v_permlane16_swap_b32 v40, v42
    v_permlane16_swap_b32 v41, v43
    v_add_f32 v40, v40, v42
    v_add_f32 v41, v41, v43
    v_mov_b32 v42, v40
    v_mov_b32 v43, v41
    s_nop 0
    v_permlane32_swap_b32 v40, v42
    v_permlane32_swap_b32 v41, v43
    v_add_f32 v40, v40, v42
    v_add_f32 v41, v41, v43
    s_mov_b64 exec, 0xffff
    buffer_store_dwordx2 v[40:41], v29, s[36:39], s66 offen sc1
    s_mov_b64 exec, -1
    s_waitcnt vmcnt(3)
    s_barrier
    s_add_u32 m0, s58, 0
    s_add_u32 s100, s81, 64
    buffer_load_dwordx4 v18, s[20:23], s100 offen offset:0 lds
    buffer_load_dwordx4 v32, s[20:23], s100 offen offset:1024 lds
    buffer_load_dwordx4 v33, s[20:23], s100 offen offset:2048 lds
    s_add_u32 m0, s58, 65536
    s_add_u32 s100, s81, 128
    buffer_load_dwordx4 v18, s[20:23], s100 offen offset:0 lds
    buffer_load_dwordx4 v32, s[20:23], s100 offen offset:1024 lds
    buffer_load_dwordx4 v33, s[20:23], s100 offen offset:2048 lds
    s_add_u32 m0, s58, 3072
    s_add_u32 s100, s81, 132160
    buffer_load_dwordx4 v18, s[20:23], s100 offen offset:0 lds
    buffer_load_dwordx4 v32, s[20:23], s100 offen offset:1024 lds
    buffer_load_dwordx4 v33, s[20:23], s100 offen offset:2048 lds
    s_lshl_b32 s66, s54, 1
    s_add_u32 s66, s66, 98304
    s_add_u32 s65, s66, 0x2000
    s_mov_b32 s101, 50
REDO_25:
    buffer_load_dwordx4 v[64:67], v30, s[36:39], s66 offen offset:0 sc1
    buffer_load_dwordx4 v[68:71], v30, s[36:39], s66 offen offset:64 sc1
    buffer_load_dwordx4 v[72:75], v30, s[36:39], s65 offen offset:0 sc1
    buffer_load_dwordx4 v[76:79], v30, s[36:39], s65 offen offset:64 sc1
    buffer_load_dwordx4 v[96:99], v30, s[36:39], s66 offen offset:128 sc1
    buffer_load_dwordx4 v[100:103], v30, s[36:39], s66 offen offset:192 sc1
    buffer_load_dwordx4 v[104:107], v30, s[36:39], s65 offen offset:128 sc1
    buffer_load_dwordx4 v[108:111], v30, s[36:39], s65 offen offset:192 sc1
    s_mov_b32 s85, 0x0101
    s_lshl_b32 s61, s56, 10
    s_add_u32 s61, s61, s67
    s_mov_b32 s72, 20000
PST_26:
    buffer_load_dwordx2 v[48:49], v29, s[36:39], s61 offen offset:0 sc1
    buffer_load_dwordx2 v[50:51], v29, s[36:39], s61 offen offset:128 sc1
    buffer_load_dwordx2 v[52:53], v29, s[36:39], s61 offen offset:1024 sc1
    buffer_load_dwordx2 v[54:55], v29, s[36:39], s61 offen offset:1152 sc1
    s_waitcnt vmcnt(0)
    v_max3_u32 v63, v48, v50, v52
    v_max_u32 v63, v63, v54
    v_cmp_eq_u32 vcc, -1, v63
    s_nop 0
    s_cmp_eq_u64 vcc, 0
    s_cbranch_scc1 PSTD_27
    s_sub_u32 s72, s72, 1
    s_cbranch_scc0 PST_26
PSTD_27:
    v_mov_b32 v61, 0
    s_lshl_b32 s90, s56, 14
    s_add_u32 s90, s90, s74
    s_add_u32 s90, s90, 6291456
    s_mov_b32 s63, s90
    s_and_b32 s64, s53, 3
    s_lshl_b32 s64, s64, 12
    s_add_u32 s90, s63, s64
    buffer_load_dwordx4 v[128:131], v1, s[36:39], s90 offen offset:0 sc1
    buffer_load_dwordx4 v[132:135], v2, s[36:39], s90 offen offset:0 sc1
    buffer_load_dwordx4 v[136:139], v1, s[36:39], s90 offen offset:1024 sc1
    buffer_load_dwordx4 v[140:143], v2, s[36:39], s90 offen offset:1024 sc1
    buffer_load_dwordx4 v[144:147], v1, s[36:39], s90 offen offset:2048 sc1
    buffer_load_dwordx4 v[148:151], v2, s[36:39], s90 offen offset:2048 sc1
    buffer_load_dwordx4 v[152:155], v1, s[36:39], s90 offen offset:3072 sc1
    buffer_load_dwordx4 v[156:159], v2, s[36:39], s90 offen offset:3072 sc1
    s_add_u32 s64, s64, 4096
    s_and_b32 s64, s64, 0x3fff
    s_add_u32 s90, s63, s64
    buffer_load_dwordx4 v[160:163], v1, s[36:39], s90 offen offset:0 sc1
    buffer_load_dwordx4 v[164:167], v2, s[36:39], s90 offen offset:0 sc1
    buffer_load_dwordx4 v[168:171], v1, s[36:39], s90 offen offset:1024 sc1
    buffer_load_dwordx4 v[172:175], v2, s[36:39], s90 offen offset:1024 sc1
    s_mov_b32 s62, 8388608
    s_add_u32 s62, s62, 16777216
    s_mul_i32 s70, s56, 49152
    s_mul_i32 s61, s53, 3072
    s_add_u32 s70, s70, s61
    s_add_u32 s70, s70, s62
    s_mul_i32 s61, s48, 3072
    s_add_u32 s62, s62, s61
    s_mul_i32 s40, s91, 49152
    s_add_u32 s40, s40, s62
    s_mul_i32 s41, s92, 49152
    s_add_u32 s41, s41, s62
    s_mul_i32 s42, s93, 49152
    s_add_u32 s42, s42, s62
    s_mul_i32 s43, s94, 49152
    s_add_u32 s43, s43, s62
    s_lshl_b32 s62, s51, 14
    s_add_u32 s62, s62, 65536
    s_and_b32 s71, s56, 0xfc
    s_and_b32 s61, s53, 3
    s_add_u32 s71, s71, s61
    s_lshl_b32 s71, s71, 7
    s_and_b32 s61, s53, 12
    s_add_u32 s71, s71, s61
    s_and_b32 s61, s48, 1
    s_add_u32 s71, s71, s61
    s_add_u32 s71, s71, s62
    s_lshl_b32 s95, s94, 7
    s_add_u32 s95, s95, s62
    v_add_u32 v60, 49152, v1
    v_add_f32 v44, v48, v50
    v_add_f32 v45, v49, v51
    v_add_f32 v46, v52, v54
    v_add_f32 v47, v53, v55
    v_mov_b32 v48, v44
    v_mov_b32 v49, v45
    buffer_load_dwordx4 v[176:179], v1, s[36:39], s90 offen offset:2048 sc1
    v_mov_b32 v50, v46
    v_mov_b32 v51, v47
    v_permlane16_swap_b32 v44, v48
    v_permlane16_swap_b32 v45, v49
    v_permlane16_swap_b32 v46, v50
    v_permlane16_swap_b32 v47, v51
    buffer_load_dwordx4 v[180:183], v2, s[36:39], s90 offen offset:2048 sc1
    v_add_f32 v44, v44, v48
    v_add_f32 v45, v45, v49
    v_add_f32 v46, v46, v50
    v_add_f32 v47, v47, v51
    v_mov_b32 v48, v44
    v_mov_b32 v49, v45
    buffer_load_dwordx4 v[184:187], v1, s[36:39], s90 offen offset:3072 sc1
    v_mov_b32 v50, v46
    v_mov_b32 v51, v47
    v_permlane32_swap_b32 v44, v48
    v_permlane32_swap_b32 v45, v49
    v_permlane32_swap_b32 v46, v50
    v_permlane32_swap_b32 v47, v51
    buffer_load_dwordx4 v[188:191], v2, s[36:39], s90 offen offset:3072 sc1
    v_add_f32 v44, v44, v48
    v_add_f32 v45, v45, v49
    v_add_f32 v46, v46, v50
    v_add_f32 v47, v47, v51
    v_mul_f32 v57, 0xbb000000, v44
    v_mul_f32 v59, 0xbb000000, v46
    s_add_u32 s64, s64, 4096
    s_and_b32 s64, s64, 0x3fff
    s_add_u32 s90, s63, s64
    buffer_load_dwordx4 v[192:195], v1, s[36:39], s90 offen offset:0 sc1
    v_mul_f32 v45, 0x3b000000, v45
    v_mul_f32 v47, 0x3b000000, v47
    v_fma_f32 v45, -v57, v57, v45
    v_fma_f32 v47, -v59, v59, v47
    v_max_f32 v45, 0, v45
    v_max_f32 v47, 0, v47
    buffer_load_dwordx4 v[196:199], v2, s[36:39], s90 offen offset:0 sc1
    v_add_f32 v45, 0x3727c5ac, v45
    v_add_f32 v47, 0x3727c5ac, v47
    v_rcp_f32 v56, v45
    v_rcp_f32 v58, v47
    s_nop 0
    v_pk_mul_f32 v[80:81], v[58:59], v[64:65] op_sel:[1,0] op_sel_hi:[1,1]
    v_pk_mul_f32 v[64:65], v[56:57], v[64:65] op_sel:[1,0] op_sel_hi:[1,1]
    buffer_load_dwordx4 v[200:203], v1, s[36:39], s90 offen offset:1024 sc1
    v_pk_mul_f32 v[82:83], v[58:59], v[66:67] op_sel:[1,0] op_sel_hi:[1,1]
    v_pk_mul_f32 v[66:67], v[56:57], v[66:67] op_sel:[1,0] op_sel_hi:[1,1]
    v_pk_mul_f32 v[84:85], v[58:59], v[68:69] op_sel:[1,0] op_sel_hi:[1,1]
    v_pk_mul_f32 v[68:69], v[56:57], v[68:69] op_sel:[1,0] op_sel_hi:[1,1]
    v_pk_mul_f32 v[86:87], v[58:59], v[70:71] op_sel:[1,0] op_sel_hi:[1,1]
    v_pk_mul_f32 v[70:71], v[56:57], v[70:71] op_sel:[1,0] op_sel_hi:[1,1]
    buffer_load_dwordx4 v[204:207], v2, s[36:39], s90 offen offset:1024 sc1
    v_pk_mul_f32 v[88:89], v[58:59], v[72:73] op_sel:[1,0] op_sel_hi:[1,1]
    v_pk_mul_f32 v[72:73], v[56:57], v[72:73] op_sel:[1,0] op_sel_hi:[1,1]
    v_pk_mul_f32 v[90:91], v[58:59], v[74:75] op_sel:[1,0] op_sel_hi:[1,1]
    v_pk_mul_f32 v[74:75], v[56:57], v[74:75] op_sel:[1,0] op_sel_hi:[1,1]
    v_pk_mul_f32 v[92:93], v[58:59], v[76:77] op_sel:[1,0] op_sel_hi:[1,1]
    v_pk_mul_f32 v[76:77], v[56:57], v[76:77] op_sel:[1,0] op_sel_hi:[1,1]
    buffer_load_dwordx4 v[208:211], v1, s[36:39], s90 offen offset:2048 sc1
    v_pk_mul_f32 v[94:95], v[58:59], v[78:79] op_sel:[1,0] op_sel_hi:[1,1]
    v_pk_mul_f32 v[78:79], v[56:57], v[78:79] op_sel:[1,0] op_sel_hi:[1,1]
    ds_read_b64_tr_b16 a[0:1], v7 offset:32768
    ds_read_b64_tr_b16 a[2:3], v7 offset:33024
    ds_read_b64_tr_b16 a[4:5], v8 offset:32768
    ds_read_b64_tr_b16 a[6:7], v8 offset:33024
    ds_read_b64_tr_b16 a[8:9], v5 offset:32768
    ds_read_b64_tr_b16 a[10:11], v5 offset:33024
    ds_read_b64_tr_b16 a[12:13], v6 offset:32768
    ds_read_b64_tr_b16 a[14:15], v6 offset:33024
    ds_read_b64_tr_b16 a[16:17], v7 offset:34816
    ds_read_b64_tr_b16 a[18:19], v7 offset:35072
    ds_read_b64_tr_b16 a[20:21], v8 offset:34816
    ds_read_b64_tr_b16 a[22:23], v8 offset:35072
    ds_read_b64_tr_b16 a[24:25], v5 offset:34816
    ds_read_b64_tr_b16 a[26:27], v5 offset:35072
    ds_read_b64_tr_b16 a[28:29], v6 offset:34816
    ds_read_b64_tr_b16 a[30:31], v6 offset:35072
    s_waitcnt vmcnt(19) lgkmcnt(8)
    v_mfma_f32_16x16x32_bf16 v[64:67], a[0:3], v[128:131], v[64:67]
    ds_read_b64_tr_b16 a[32:33], v7 offset:36864
    v_mul_f32 v112, v59, v96
    v_mfma_f32_16x16x32_bf16 v[80:83], a[0:3], v[132:135], v[80:83]
    ds_read_b64_tr_b16 a[34:35], v7 offset:37120
    buffer_load_dwordx4 v[212:215], v2, s[36:39], s90 offen offset:2048 sc1
    v_mfma_f32_16x16x32_bf16 v[68:71], a[4:7], v[128:131], v[68:71]
    ds_read_b64_tr_b16 a[36:37], v8 offset:36864
    v_mul_f32 v96, v57, v96
    v_mfma_f32_16x16x32_bf16 v[84:87], a[4:7], v[132:135], v[84:87]
    ds_read_b64_tr_b16 a[38:39], v8 offset:37120
    buffer_load_dwordx4 v[216:219], v1, s[36:39], s90 offen offset:3072 sc1
    v_mfma_f32_16x16x32_bf16 v[72:75], a[8:11], v[128:131], v[72:75]
    ds_read_b64_tr_b16 a[40:41], v5 offset:36864
    v_mul_f32 v113, v59, v97
    v_mfma_f32_16x16x32_bf16 v[88:91], a[8:11], v[132:135], v[88:91]
    ds_read_b64_tr_b16 a[42:43], v5 offset:37120
    buffer_load_dwordx4 v[220:223], v2, s[36:39], s90 offen offset:3072 sc1
    v_mfma_f32_16x16x32_bf16 v[76:79], a[12:15], v[128:131], v[76:79]
    ds_read_b64_tr_b16 a[44:45], v6 offset:36864
    v_mul_f32 v97, v57, v97
    v_mfma_f32_16x16x32_bf16 v[92:95], a[12:15], v[132:135], v[92:95]
    ds_read_b64_tr_b16 a[46:47], v6 offset:37120
    s_add_u32 s64, s64, 4096
    s_and_b32 s64, s64, 0x3fff
    s_add_u32 s90, s63, s64
    buffer_load_dwordx4 v[224:227], v1, s[36:39], s90 offen offset:0 sc1
    v_max3_u32 v61, v61, v128, v132
    s_waitcnt vmcnt(21) lgkmcnt(8)
    v_mfma_f32_16x16x32_bf16 v[64:67], a[16:19], v[136:139], v[64:67]
    ds_read_b64_tr_b16 a[0:1], v7 offset:38912
    v_mul_f32 v114, v59, v98
    v_mfma_f32_16x16x32_bf16 v[80:83], a[16:19], v[140:143], v[80:83]
    ds_read_b64_tr_b16 a[2:3], v7 offset:39168
    buffer_load_dwordx4 v[228:231], v2, s[36:39], s90 offen offset:0 sc1
    v_mfma_f32_16x16x32_bf16 v[68:71], a[20:23], v[136:139], v[68:71]
    ds_read_b64_tr_b16 a[4:5], v8 offset:38912
    v_mul_f32 v98, v57, v98
    v_mfma_f32_16x16x32_bf16 v[84:87], a[20:23], v[140:143], v[84:87]
    ds_read_b64_tr_b16 a[6:7], v8 offset:39168
    buffer_load_dwordx4 v[232:235], v1, s[36:39], s90 offen offset:1024 sc1
    v_mfma_f32_16x16x32_bf16 v[72:75], a[24:27], v[136:139], v[72:75]
    ds_read_b64_tr_b16 a[8:9], v5 offset:38912
    v_mul_f32 v115, v59, v99
    v_mfma_f32_16x16x32_bf16 v[88:91], a[24:27], v[140:143], v[88:91]
    ds_read_b64_tr_b16 a[10:11], v5 offset:39168
    buffer_load_dwordx4 v[236:239], v2, s[36:39], s90 offen offset:1024 sc1
    v_mfma_f32_16x16x32_bf16 v[76:79], a[28:31], v[136:139], v[76:79]
    ds_read_b64_tr_b16 a[12:13], v6 offset:38912
    v_mul_f32 v99, v57, v99
    v_mfma_f32_16x16x32_bf16 v[92:95], a[28:31], v[140:143], v[92:95]
    ds_read_b64_tr_b16 a[14:15], v6 offset:39168
    buffer_load_dwordx4 v[240:243], v1, s[36:39], s90 offen offset:2048 sc1
    v_max3_u32 v61, v61, v136, v140
    s_waitcnt vmcnt(23) lgkmcnt(8)
    v_mfma_f32_16x16x32_bf16 v[64:67], a[32:35], v[144:147], v[64:67]
    ds_read_b64_tr_b16 a[16:17], v7 offset:40960
    v_mul_f32 v116, v59, v100
    v_mfma_f32_16x16x32_bf16 v[80:83], a[32:35], v[148:151], v[80:83]
    ds_read_b64_tr_b16 a[18:19], v7 offset:41216
    buffer_load_dwordx4 v[244:247], v2, s[36:39], s90 offen offset:2048 sc1
    v_mfma_f32_16x16x32_bf16 v[68:71], a[36:39], v[144:147], v[68:71]
    ds_read_b64_tr_b16 a[20:21], v8 offset:40960
    v_mul_f32 v100, v57, v100
    v_mfma_f32_16x16x32_bf16 v[84:87], a[36:39], v[148:151], v[84:87]
    ds_read_b64_tr_b16 a[22:23], v8 offset:41216
    buffer_load_dwordx4 v[248:251], v1, s[36:39], s90 offen offset:3072 sc1
    v_mfma_f32_16x16x32_bf16 v[72:75], a[40:43], v[144:147], v[72:75]
    ds_read_b64_tr_b16 a[24:25], v5 offset:40960
    v_mul_f32 v117, v59, v101
    v_mfma_f32_16x16x32_bf16 v[88:91], a[40:43], v[148:151], v[88:91]
    ds_read_b64_tr_b16 a[26:27], v5 offset:41216
    buffer_load_dwordx4 v[252:255], v2, s[36:39], s90 offen offset:3072 sc1
    v_mfma_f32_16x16x32_bf16 v[76:79], a[44:47], v[144:147], v[76:79]
    ds_read_b64_tr_b16 a[28:29], v6 offset:40960
    v_mul_f32 v101, v57, v101
    v_mfma_f32_16x16x32_bf16 v[92:95], a[44:47], v[148:151], v[92:95]
    ds_read_b64_tr_b16 a[30:31], v6 offset:41216
    s_add_u32 m0, s58, 68608
    s_add_u32 s100, s81, 132224
    buffer_load_dwordx4 v18, s[20:23], s100 offen offset:0 lds
    v_max3_u32 v61, v61, v144, v148
    s_waitcnt vmcnt(25) lgkmcnt(8)
    v_mfma_f32_16x16x32_bf16 v[64:67], a[0:3], v[152:155], v[64:67]
    ds_read_b64_tr_b16 a[32:33], v7 offset:43008
    v_mul_f32 v118, v59, v102
    v_mfma_f32_16x16x32_bf16 v[80:83], a[0:3], v[156:159], v[80:83]
    ds_read_b64_tr_b16 a[34:35], v7 offset:43264
    buffer_load_dwordx4 v32, s[20:23], s100 offen offset:1024 lds
    v_mfma_f32_16x16x32_bf16 v[68:71], a[4:7], v[152:155], v[68:71]
    ds_read_b64_tr_b16 a[36:37], v8 offset:43008
    v_mul_f32 v102, v57, v102
    v_mfma_f32_16x16x32_bf16 v[84:87], a[4:7], v[156:159], v[84:87]
    ds_read_b64_tr_b16 a[38:39], v8 offset:43264
    buffer_load_dwordx4 v33, s[20:23], s100 offen offset:2048 lds
    v_mfma_f32_16x16x32_bf16 v[72:75], a[8:11], v[152:155], v[72:75]
    ds_read_b64_tr_b16 a[40:41], v5 offset:43008
    v_mul_f32 v119, v59, v103
    v_mfma_f32_16x16x32_bf16 v[88:91], a[8:11], v[156:159], v[88:91]
    ds_read_b64_tr_b16 a[42:43], v5 offset:43264
    s_add_u32 m0, s58, 6144
    s_add_u32 s100, s81, 264256
    buffer_load_dwordx4 v18, s[20:23], s100 offen offset:0 lds
    v_mfma_f32_16x16x32_bf16 v[76:79], a[12:15], v[152:155], v[76:79]
    ds_read_b64_tr_b16 a[44:45], v6 offset:43008
    v_mul_f32 v103, v57, v103
    v_mfma_f32_16x16x32_bf16 v[92:95], a[12:15], v[156:159], v[92:95]
    ds_read_b64_tr_b16 a[46:47], v6 offset:43264
    buffer_load_dwordx4 v32, s[20:23], s100 offen offset:1024 lds
    v_max3_u32 v61, v61, v152, v156
    s_waitcnt vmcnt(27) lgkmcnt(8)
    v_mfma_f32_16x16x32_bf16 v[64:67], a[16:19], v[160:163], v[64:67]
    ds_read_b64_tr_b16 a[0:1], v7 offset:45056
    v_mul_f32 v120, v59, v104
    v_mfma_f32_16x16x32_bf16 v[80:83], a[16:19], v[164:167], v[80:83]
    ds_read_b64_tr_b16 a[2:3], v7 offset:45312
    s_add_u32 m0, s58, 71680
    s_add_u32 s100, s81, 264320
    buffer_load_dwordx4 v18, s[20:23], s100 offen offset:0 lds
    v_mfma_f32_16x16x32_bf16 v[68:71], a[20:23], v[160:163], v[68:71]
    ds_read_b64_tr_b16 a[4:5], v8 offset:45056
    v_mul_f32 v104, v57, v104
    v_mfma_f32_16x16x32_bf16 v[84:87], a[20:23], v[164:167], v[84:87]
    ds_read_b64_tr_b16 a[6:7], v8 offset:45312
    buffer_load_dwordx4 v32, s[20:23], s100 offen offset:1024 lds
    v_mfma_f32_16x16x32_bf16 v[72:75], a[24:27], v[160:163], v[72:75]
    ds_read_b64_tr_b16 a[8:9], v5 offset:45056
    v_mul_f32 v121, v59, v105
    v_mfma_f32_16x16x32_bf16 v[88:91], a[24:27], v[164:167], v[88:91]
    ds_read_b64_tr_b16 a[10:11], v5 offset:45312
    v_mfma_f32_16x16x32_bf16 v[76:79], a[28:31], v[160:163], v[76:79]
    ds_read_b64_tr_b16 a[12:13], v6 offset:45056
    v_mul_f32 v105, v57, v105
    v_mfma_f32_16x16x32_bf16 v[92:95], a[28:31], v[164:167], v[92:95]
    ds_read_b64_tr_b16 a[14:15], v6 offset:45312
    v_mul_f32 v122, v59, v106
    v_max3_u32 v61, v61, v160, v164
    s_waitcnt vmcnt(27) lgkmcnt(8)
    v_mfma_f32_16x16x32_bf16 v[64:67], a[32:35], v[168:171], v[64:67]
    ds_read_b64_tr_b16 a[16:17], v7 offset:47104
    v_mul_f32 v106, v57, v106
    v_mfma_f32_16x16x32_bf16 v[80:83], a[32:35], v[172:175], v[80:83]
    ds_read_b64_tr_b16 a[18:19], v7 offset:47360
    v_mul_f32 v123, v59, v107
    v_mfma_f32_16x16x32_bf16 v[68:71], a[36:39], v[168:171], v[68:71]
    ds_read_b64_tr_b16 a[20:21], v8 offset:47104
    v_mul_f32 v107, v57, v107
    v_mfma_f32_16x16x32_bf16 v[84:87], a[36:39], v[172:175], v[84:87]
    ds_read_b64_tr_b16 a[22:23], v8 offset:47360
    v_mul_f32 v124, v59, v108
    v_mfma_f32_16x16x32_bf16 v[72:75], a[40:43], v[168:171], v[72:75]
    ds_read_b64_tr_b16 a[24:25], v5 offset:47104
    v_mul_f32 v108, v57, v108
    v_mfma_f32_16x16x32_bf16 v[88:91], a[40:43], v[172:175], v[88:91]
    ds_read_b64_tr_b16 a[26:27], v5 offset:47360
    v_mul_f32 v125, v59, v109
    v_mfma_f32_16x16x32_bf16 v[76:79], a[44:47], v[168:171], v[76:79]
    ds_read_b64_tr_b16 a[28:29], v6 offset:47104
    v_mul_f32 v109, v57, v109
    v_mfma_f32_16x16x32_bf16 v[92:95], a[44:47], v[172:175], v[92:95]
    ds_read_b64_tr_b16 a[30:31], v6 offset:47360
    v_mul_f32 v126, v59, v110
    v_max3_u32 v61, v61, v168, v172
    s_waitcnt vmcnt(25) lgkmcnt(8)
    v_mfma_f32_16x16x32_bf16 v[64:67], a[0:3], v[176:179], v[64:67]
    ds_read_b64_tr_b16 a[32:33], v7 offset:49152
    v_mul_f32 v110, v57, v110
    v_mfma_f32_16x16x32_bf16 v[80:83], a[0:3], v[180:183], v[80:83]
    ds_read_b64_tr_b16 a[34:35], v7 offset:49408
    v_mul_f32 v127, v59, v111
    v_mfma_f32_16x16x32_bf16 v[68:71], a[4:7], v[176:179], v[68:71]
    ds_read_b64_tr_b16 a[36:37], v8 offset:49152
    v_mul_f32 v111, v57, v111
    v_mfma_f32_16x16x32_bf16 v[84:87], a[4:7], v[180:183], v[84:87]
    ds_read_b64_tr_b16 a[38:39], v8 offset:49408
    v_mfma_f32_16x16x32_bf16 v[72:75], a[8:11], v[176:179], v[72:75]
    ds_read_b64_tr_b16 a[40:41], v5 offset:49152
    v_mfma_f32_16x16x32_bf16 v[88:91], a[8:11], v[180:183], v[88:91]
    ds_read_b64_tr_b16 a[42:43], v5 offset:49408
    v_mfma_f32_16x16x32_bf16 v[76:79], a[12:15], v[176:179], v[76:79]
    ds_read_b64_tr_b16 a[44:45], v6 offset:49152
    v_mfma_f32_16x16x32_bf16 v[92:95], a[12:15], v[180:183], v[92:95]
    ds_read_b64_tr_b16 a[46:47], v6 offset:49408
    v_max3_u32 v61, v61, v176, v180
    s_waitcnt vmcnt(23) lgkmcnt(8)
    v_mfma_f32_16x16x32_bf16 v[64:67], a[16:19], v[184:187], v[64:67]
    ds_read_b64_tr_b16 a[0:1], v7 offset:51200
    v_mfma_f32_16x16x32_bf16 v[80:83], a[16:19], v[188:191], v[80:83]
    ds_read_b64_tr_b16 a[2:3], v7 offset:51456
    v_mfma_f32_16x16x32_bf16 v[68:71], a[20:23], v[184:187], v[68:71]
    ds_read_b64_tr_b16 a[4:5], v8 offset:51200
    v_mfma_f32_16x16x32_bf16 v[84:87], a[20:23], v[188:191], v[84:87]
    ds_read_b64_tr_b16 a[6:7], v8 offset:51456
    v_mfma_f32_16x16x32_bf16 v[72:75], a[24:27], v[184:187], v[72:75]
    ds_read_b64_tr_b16 a[8:9], v5 offset:51200
    v_mfma_f32_16x16x32_bf16 v[88:91], a[24:27], v[188:191], v[88:91]
    ds_read_b64_tr_b16 a[10:11], v5 offset:51456
    v_mfma_f32_16x16x32_bf16 v[76:79], a[28:31], v[184:187], v[76:79]
    ds_read_b64_tr_b16 a[12:13], v6 offset:51200
    v_mfma_f32_16x16x32_bf16 v[92:95], a[28:31], v[188:191], v[92:95]
    ds_read_b64_tr_b16 a[14:15], v6 offset:51456
    v_max3_u32 v61, v61, v184, v188
    s_waitcnt vmcnt(21) lgkmcnt(8)
    v_mfma_f32_16x16x32_bf16 v[64:67], a[32:35], v[192:195], v[64:67]
    ds_read_b64_tr_b16 a[16:17], v7 offset:53248
    v_mfma_f32_16x16x32_bf16 v[80:83], a[32:35], v[196:199], v[80:83]
    ds_read_b64_tr_b16 a[18:19], v7 offset:53504
    v_mfma_f32_16x16x32_bf16 v[68:71], a[36:39], v[192:195], v[68:71]
    ds_read_b64_tr_b16 a[20:21], v8 offset:53248
    v_mfma_f32_16x16x32_bf16 v[84:87], a[36:39], v[196:199], v[84:87]
    ds_read_b64_tr_b16 a[22:23], v8 offset:53504
    v_mfma_f32_16x16x32_bf16 v[72:75], a[40:43], v[192:195], v[72:75]
    ds_read_b64_tr_b16 a[24:25], v5 offset:53248
    v_mfma_f32_16x16x32_bf16 v[88:91], a[40:43], v[196:199], v[88:91]
    ds_read_b64_tr_b16 a[26:27], v5 offset:53504
    v_mfma_f32_16x16x32_bf16 v[76:79], a[44:47], v[192:195], v[76:79]
    ds_read_b64_tr_b16 a[28:29], v6 offset:53248
    v_mfma_f32_16x16x32_bf16 v[92:95], a[44:47], v[196:199], v[92:95]
    ds_read_b64_tr_b16 a[30:31], v6 offset:53504
    v_max3_u32 v61, v61, v192, v196
    s_waitcnt vmcnt(19) lgkmcnt(8)
    v_mfma_f32_16x16x32_bf16 v[64:67], a[0:3], v[200:203], v[64:67]
    ds_read_b64_tr_b16 a[32:33], v7 offset:55296
    v_mfma_f32_16x16x32_bf16 v[80:83], a[0:3], v[204:207], v[80:83]
    ds_read_b64_tr_b16 a[34:35], v7 offset:55552
    v_mfma_f32_16x16x32_bf16 v[68:71], a[4:7], v[200:203], v[68:71]
    ds_read_b64_tr_b16 a[36:37], v8 offset:55296
    v_mfma_f32_16x16x32_bf16 v[84:87], a[4:7], v[204:207], v[84:87]
    ds_read_b64_tr_b16 a[38:39], v8 offset:55552
    v_mfma_f32_16x16x32_bf16 v[72:75], a[8:11], v[200:203], v[72:75]
    ds_read_b64_tr_b16 a[40:41], v5 offset:55296
    v_mfma_f32_16x16x32_bf16 v[88:91], a[8:11], v[204:207], v[88:91]
    ds_read_b64_tr_b16 a[42:43], v5 offset:55552
    v_mfma_f32_16x16x32_bf16 v[76:79], a[12:15], v[200:203], v[76:79]
    ds_read_b64_tr_b16 a[44:45], v6 offset:55296
    v_mfma_f32_16x16x32_bf16 v[92:95], a[12:15], v[204:207], v[92:95]
    ds_read_b64_tr_b16 a[46:47], v6 offset:55552
    v_max3_u32 v61, v61, v200, v204
    s_waitcnt vmcnt(17) lgkmcnt(8)
    v_mfma_f32_16x16x32_bf16 v[64:67], a[16:19], v[208:211], v[64:67]
    ds_read_b64_tr_b16 a[0:1], v7 offset:57344
    v_mfma_f32_16x16x32_bf16 v[80:83], a[16:19], v[212:215], v[80:83]
    ds_read_b64_tr_b16 a[2:3], v7 offset:57600
    v_mfma_f32_16x16x32_bf16 v[68:71], a[20:23], v[208:211], v[68:71]
    ds_read_b64_tr_b16 a[4:5], v8 offset:57344
    v_mfma_f32_16x16x32_bf16 v[84:87], a[20:23], v[212:215], v[84:87]
    ds_read_b64_tr_b16 a[6:7], v8 offset:57600
    v_mfma_f32_16x16x32_bf16 v[72:75], a[24:27], v[208:211], v[72:75]
    ds_read_b64_tr_b16 a[8:9], v5 offset:57344
    v_mfma_f32_16x16x32_bf16 v[88:91], a[24:27], v[212:215], v[88:91]
    ds_read_b64_tr_b16 a[10:11], v5 offset:57600
    v_mfma_f32_16x16x32_bf16 v[76:79], a[28:31], v[208:211], v[76:79]
    ds_read_b64_tr_b16 a[12:13], v6 offset:57344
    v_mfma_f32_16x16x32_bf16 v[92:95], a[28:31], v[212:215], v[92:95]
    ds_read_b64_tr_b16 a[14:15], v6 offset:57600
    v_max3_u32 v61, v61, v208, v212
    s_waitcnt vmcnt(15) lgkmcnt(8)
    v_mfma_f32_16x16x32_bf16 v[64:67], a[32:35], v[216:219], v[64:67]
    ds_read_b64_tr_b16 a[16:17], v7 offset:59392
    v_mfma_f32_16x16x32_bf16 v[80:83], a[32:35], v[220:223], v[80:83]
    ds_read_b64_tr_b16 a[18:19], v7 offset:59648
    v_mfma_f32_16x16x32_bf16 v[68:71], a[36:39], v[216:219], v[68:71]
    ds_read_b64_tr_b16 a[20:21], v8 offset:59392
    v_mfma_f32_16x16x32_bf16 v[84:87], a[36:39], v[220:223], v[84:87]
    ds_read_b64_tr_b16 a[22:23], v8 offset:59648
    v_mfma_f32_16x16x32_bf16 v[72:75], a[40:43], v[216:219], v[72:75]
    ds_read_b64_tr_b16 a[24:25], v5 offset:59392
    v_mfma_f32_16x16x32_bf16 v[88:91], a[40:43], v[220:223], v[88:91]
    ds_read_b64_tr_b16 a[26:27], v5 offset:59648
    v_mfma_f32_16x16x32_bf16 v[76:79], a[44:47], v[216:219], v[76:79]
    ds_read_b64_tr_b16 a[28:29], v6 offset:59392
    v_mfma_f32_16x16x32_bf16 v[92:95], a[44:47], v[220:223], v[92:95]
    ds_read_b64_tr_b16 a[30:31], v6 offset:59648
    v_max3_u32 v61, v61, v216, v220
    s_waitcnt vmcnt(13) lgkmcnt(8)
    v_mfma_f32_16x16x32_bf16 v[64:67], a[0:3], v[224:227], v[64:67]
    ds_read_b64_tr_b16 a[32:33], v7 offset:61440
    v_mfma_f32_16x16x32_bf16 v[80:83], a[0:3], v[228:231], v[80:83]
    ds_read_b64_tr_b16 a[34:35], v7 offset:61696
    v_mfma_f32_16x16x32_bf16 v[68:71], a[4:7], v[224:227], v[68:71]
    ds_read_b64_tr_b16 a[36:37], v8 offset:61440
    v_mfma_f32_16x16x32_bf16 v[84:87], a[4:7], v[228:231], v[84:87]
    ds_read_b64_tr_b16 a[38:39], v8 offset:61696
    v_mfma_f32_16x16x32_bf16 v[72:75], a[8:11], v[224:227], v[72:75]
    ds_read_b64_tr_b16 a[40:41], v5 offset:61440
    v_mfma_f32_16x16x32_bf16 v[88:91], a[8:11], v[228:231], v[88:91]
    ds_read_b64_tr_b16 a[42:43], v5 offset:61696
    v_mfma_f32_16x16x32_bf16 v[76:79], a[12:15], v[224:227], v[76:79]
    ds_read_b64_tr_b16 a[44:45], v6 offset:61440
    v_mfma_f32_16x16x32_bf16 v[92:95], a[12:15], v[228:231], v[92:95]
    ds_read_b64_tr_b16 a[46:47], v6 offset:61696
    v_max3_u32 v61, v61, v224, v228
    s_waitcnt vmcnt(11) lgkmcnt(8)
    v_mfma_f32_16x16x32_bf16 v[64:67], a[16:19], v[232:235], v[64:67]
    ds_read_b64_tr_b16 a[0:1], v7 offset:63488
    v_mfma_f32_16x16x32_bf16 v[80:83], a[16:19], v[236:239], v[80:83]
    ds_read_b64_tr_b16 a[2:3], v7 offset:63744
    v_mfma_f32_16x16x32_bf16 v[68:71], a[20:23], v[232:235], v[68:71]
    ds_read_b64_tr_b16 a[4:5], v8 offset:63488
    v_mfma_f32_16x16x32_bf16 v[84:87], a[20:23], v[236:239], v[84:87]
    ds_read_b64_tr_b16 a[6:7], v8 offset:63744
    v_mfma_f32_16x16x32_bf16 v[72:75], a[24:27], v[232:235], v[72:75]
    ds_read_b64_tr_b16 a[8:9], v5 offset:63488
    v_mfma_f32_16x16x32_bf16 v[88:91], a[24:27], v[236:239], v[88:91]
    ds_read_b64_tr_b16 a[10:11], v5 offset:63744
    v_mfma_f32_16x16x32_bf16 v[76:79], a[28:31], v[232:235], v[76:79]
    ds_read_b64_tr_b16 a[12:13], v6 offset:63488
    v_mfma_f32_16x16x32_bf16 v[92:95], a[28:31], v[236:239], v[92:95]
    ds_read_b64_tr_b16 a[14:15], v6 offset:63744
    v_max3_u32 v61, v61, v232, v236
    s_waitcnt vmcnt(9) lgkmcnt(8)
    v_mfma_f32_16x16x32_bf16 v[64:67], a[32:35], v[240:243], v[64:67]
    v_mfma_f32_16x16x32_bf16 v[80:83], a[32:35], v[244:247], v[80:83]
    v_mfma_f32_16x16x32_bf16 v[68:71], a[36:39], v[240:243], v[68:71]
    v_mfma_f32_16x16x32_bf16 v[84:87], a[36:39], v[244:247], v[84:87]
    v_mfma_f32_16x16x32_bf16 v[72:75], a[40:43], v[240:243], v[72:75]
    v_mfma_f32_16x16x32_bf16 v[88:91], a[40:43], v[244:247], v[88:91]
    v_mfma_f32_16x16x32_bf16 v[76:79], a[44:47], v[240:243], v[76:79]
    v_mfma_f32_16x16x32_bf16 v[92:95], a[44:47], v[244:247], v[92:95]
    v_max3_u32 v61, v61, v240, v244
    s_waitcnt vmcnt(7) lgkmcnt(0)
    v_mfma_f32_16x16x32_bf16 v[64:67], a[0:3], v[248:251], v[64:67]
    v_mfma_f32_16x16x32_bf16 v[80:83], a[0:3], v[252:255], v[80:83]
    v_mfma_f32_16x16x32_bf16 v[68:71], a[4:7], v[248:251], v[68:71]
    v_mfma_f32_16x16x32_bf16 v[84:87], a[4:7], v[252:255], v[84:87]
    v_mfma_f32_16x16x32_bf16 v[72:75], a[8:11], v[248:251], v[72:75]
    v_mfma_f32_16x16x32_bf16 v[88:91], a[8:11], v[252:255], v[88:91]
    v_mfma_f32_16x16x32_bf16 v[76:79], a[12:15], v[248:251], v[76:79]
    v_mfma_f32_16x16x32_bf16 v[92:95], a[12:15], v[252:255], v[92:95]
    v_max3_u32 v61, v61, v248, v252
    v_cmp_eq_u32 vcc, -1, v61
    s_nop 0
    s_cmp_eq_u64 vcc, 0
    s_cbranch_scc1 REDOD_28
    s_waitcnt vmcnt(0) lgkmcnt(0)
    s_sub_u32 s101, s101, 1
    s_nop 7
    s_cbranch_scc0 REDO_25
REDOD_28:
    s_waitcnt vmcnt(0)
    s_barrier
    ds_read_b64_tr_b16 a[0:1], v9 offset:0
    ds_read_b64_tr_b16 a[2:3], v9 offset:256
    ds_read_b64_tr_b16 a[4:5], v10 offset:0
    ds_read_b64_tr_b16 a[6:7], v10 offset:256
    ds_read_b64_tr_b16 a[8:9], v5 offset:0
    ds_read_b64_tr_b16 a[10:11], v5 offset:256
    ds_read_b64_tr_b16 a[12:13], v6 offset:0
    ds_read_b64_tr_b16 a[14:15], v6 offset:256
    ds_read_b64_tr_b16 a[16:17], v9 offset:2048
    ds_read_b64_tr_b16 a[18:19], v9 offset:2304
    ds_read_b64_tr_b16 a[20:21], v10 offset:2048
    ds_read_b64_tr_b16 a[22:23], v10 offset:2304
    ds_read_b64_tr_b16 a[24:25], v5 offset:2048
    ds_read_b64_tr_b16 a[26:27], v5 offset:2304
    ds_read_b64_tr_b16 a[28:29], v6 offset:2048
    ds_read_b64_tr_b16 a[30:31], v6 offset:2304
    s_waitcnt lgkmcnt(8)
    v_mfma_f32_16x16x32_bf16 v[96:99], a[0:3], v[128:131], v[96:99]
    ds_read_b64_tr_b16 a[32:33], v9 offset:4096
    v_max_f32 v64, 0, v64
    v_max_f32 v65, 0, v65
    v_mfma_f32_16x16x32_bf16 v[112:115], a[0:3], v[132:135], v[112:115]
    ds_read_b64_tr_b16 a[34:35], v9 offset:4352
    buffer_load_dwordx4 v[40:43], v30, s[36:39], s66 offen offset:256 sc1
    v_mfma_f32_16x16x32_bf16 v[100:103], a[4:7], v[128:131], v[100:103]
    ds_read_b64_tr_b16 a[36:37], v10 offset:4096
    v_max_f32 v66, 0, v66
    v_max_f32 v67, 0, v67
    v_mfma_f32_16x16x32_bf16 v[116:119], a[4:7], v[132:135], v[116:119]
    ds_read_b64_tr_b16 a[38:39], v10 offset:4352
    v_mul_f32 v72, v56, v72
    v_mul_f32 v73, v56, v73
    v_mfma_f32_16x16x32_bf16 v[104:107], a[8:11], v[128:131], v[104:107]
    ds_read_b64_tr_b16 a[40:41], v5 offset:4096
    v_mul_f32 v74, v56, v74
    v_mul_f32 v75, v56, v75
    v_mfma_f32_16x16x32_bf16 v[120:123], a[8:11], v[132:135], v[120:123]
    ds_read_b64_tr_b16 a[42:43], v5 offset:4352
    buffer_load_dwordx4 v[44:47], v30, s[36:39], s66 offen offset:320 sc1
    v_mfma_f32_16x16x32_bf16 v[108:111], a[12:15], v[128:131], v[108:111]
    ds_read_b64_tr_b16 a[44:45], v6 offset:4096
    v_mul_f32 v64, v64, v72
    v_mul_f32 v65, v65, v73
    v_mfma_f32_16x16x32_bf16 v[124:127], a[12:15], v[132:135], v[124:127]
    ds_read_b64_tr_b16 a[46:47], v6 offset:4352
    v_mul_f32 v66, v66, v74
    v_mul_f32 v67, v67, v75
    s_waitcnt lgkmcnt(8)
    v_mfma_f32_16x16x32_bf16 v[96:99], a[16:19], v[136:139], v[96:99]
    ds_read_b64_tr_b16 a[0:1], v9 offset:6144
    v_cvt_pk_bf16_f32 v72, v64, v65
    v_cvt_pk_bf16_f32 v73, v66, v67
    v_mfma_f32_16x16x32_bf16 v[112:115], a[16:19], v[140:143], v[112:115]
    ds_read_b64_tr_b16 a[2:3], v9 offset:6400
    buffer_load_dwordx4 v[48:51], v30, s[36:39], s65 offen offset:256 sc1
    v_mfma_f32_16x16x32_bf16 v[100:103], a[20:23], v[136:139], v[100:103]
    ds_read_b64_tr_b16 a[4:5], v10 offset:6144
    v_max_f32 v68, 0, v68
    v_max_f32 v69, 0, v69
    v_mfma_f32_16x16x32_bf16 v[116:119], a[20:23], v[140:143], v[116:119]
    ds_read_b64_tr_b16 a[6:7], v10 offset:6400
    v_max_f32 v70, 0, v70
    v_max_f32 v71, 0, v71
    v_mfma_f32_16x16x32_bf16 v[104:107], a[24:27], v[136:139], v[104:107]
    ds_read_b64_tr_b16 a[8:9], v5 offset:6144
    v_mul_f32 v76, v56, v76
    v_mul_f32 v77, v56, v77
    v_mfma_f32_16x16x32_bf16 v[120:123], a[24:27], v[140:143], v[120:123]
    ds_read_b64_tr_b16 a[10:11], v5 offset:6400
    buffer_load_dwordx4 v[52:55], v30, s[36:39], s65 offen offset:320 sc1
    v_mfma_f32_16x16x32_bf16 v[108:111], a[28:31], v[136:139], v[108:111]
    ds_read_b64_tr_b16 a[12:13], v6 offset:6144
    v_mul_f32 v78, v56, v78
    v_mul_f32 v79, v56, v79
    v_mfma_f32_16x16x32_bf16 v[124:127], a[28:31], v[140:143], v[124:127]
    ds_read_b64_tr_b16 a[14:15], v6 offset:6400
    v_mul_f32 v68, v68, v76
    v_mul_f32 v69, v69, v77
    s_waitcnt lgkmcnt(8)
    v_mfma_f32_16x16x32_bf16 v[96:99], a[32:35], v[144:147], v[96:99]
    ds_read_b64_tr_b16 a[16:17], v9 offset:8192
    v_mul_f32 v70, v70, v78
    v_mul_f32 v71, v71, v79
    v_mfma_f32_16x16x32_bf16 v[112:115], a[32:35], v[148:151], v[112:115]
    ds_read_b64_tr_b16 a[18:19], v9 offset:8448
    v_mfma_f32_16x16x32_bf16 v[100:103], a[36:39], v[144:147], v[100:103]
    ds_read_b64_tr_b16 a[20:21], v10 offset:8192
    v_cvt_pk_bf16_f32 v74, v68, v69
    v_cvt_pk_bf16_f32 v75, v70, v71
    v_mfma_f32_16x16x32_bf16 v[116:119], a[36:39], v[148:151], v[116:119]
    ds_read_b64_tr_b16 a[22:23], v10 offset:8448
    buffer_store_dwordx4 v[72:75], v1, s[36:39], s70 offen offset:0 sc1
    v_max_f32 v80, 0, v80
    v_mfma_f32_16x16x32_bf16 v[104:107], a[40:43], v[144:147], v[104:107]
    ds_read_b64_tr_b16 a[24:25], v5 offset:8192
    v_max_f32 v81, 0, v81
    v_max_f32 v82, 0, v82
    v_mfma_f32_16x16x32_bf16 v[120:123], a[40:43], v[148:151], v[120:123]
    ds_read_b64_tr_b16 a[26:27], v5 offset:8448
    s_add_u32 m0, s58, 98304
    s_add_u32 s100, s81, 128
    buffer_load_dwordx4 v18, s[16:19], s100 offen offset:0 lds
    v_mfma_f32_16x16x32_bf16 v[108:111], a[44:47], v[144:147], v[108:111]
    ds_read_b64_tr_b16 a[28:29], v6 offset:8192
    v_max_f32 v83, 0, v83
    v_mul_f32 v88, v58, v88
    v_mfma_f32_16x16x32_bf16 v[124:127], a[44:47], v[148:151], v[124:127]
    ds_read_b64_tr_b16 a[30:31], v6 offset:8448
    v_mul_f32 v89, v58, v89
    v_mul_f32 v90, v58, v90
    s_waitcnt lgkmcnt(8)
    v_mfma_f32_16x16x32_bf16 v[96:99], a[0:3], v[152:155], v[96:99]
    ds_read_b64_tr_b16 a[32:33], v9 offset:10240
    v_mul_f32 v91, v58, v91
    v_mul_f32 v80, v80, v88
    v_mfma_f32_16x16x32_bf16 v[112:115], a[0:3], v[156:159], v[112:115]
    ds_read_b64_tr_b16 a[34:35], v9 offset:10496
    buffer_load_dwordx4 v32, s[16:19], s100 offen offset:1024 lds
    v_mfma_f32_16x16x32_bf16 v[100:103], a[4:7], v[152:155], v[100:103]
    ds_read_b64_tr_b16 a[36:37], v10 offset:10240
    v_mul_f32 v81, v81, v89
    v_mul_f32 v82, v82, v90
    v_mfma_f32_16x16x32_bf16 v[116:119], a[4:7], v[156:159], v[116:119]
    ds_read_b64_tr_b16 a[38:39], v10 offset:10496
    v_mul_f32 v83, v83, v91
    v_cvt_pk_bf16_f32 v88, v80, v81
    v_mfma_f32_16x16x32_bf16 v[104:107], a[8:11], v[152:155], v[104:107]
    ds_read_b64_tr_b16 a[40:41], v5 offset:10240
    v_cvt_pk_bf16_f32 v89, v82, v83
    v_max_f32 v84, 0, v84
    v_mfma_f32_16x16x32_bf16 v[120:123], a[8:11], v[156:159], v[120:123]
    ds_read_b64_tr_b16 a[42:43], v5 offset:10496
    buffer_load_dwordx4 v33, s[16:19], s100 offen offset:2048 lds
    v_mfma_f32_16x16x32_bf16 v[108:111], a[12:15], v[152:155], v[108:111]
    ds_read_b64_tr_b16 a[44:45], v6 offset:10240
    v_max_f32 v85, 0, v85
    v_max_f32 v86, 0, v86
    v_mfma_f32_16x16x32_bf16 v[124:127], a[12:15], v[156:159], v[124:127]
    ds_read_b64_tr_b16 a[46:47], v6 offset:10496
    v_max_f32 v87, 0, v87
    v_mul_f32 v92, v58, v92
    s_waitcnt lgkmcnt(8)
    v_mfma_f32_16x16x32_bf16 v[96:99], a[16:19], v[160:163], v[96:99]
    ds_read_b64_tr_b16 a[0:1], v9 offset:12288
    v_mul_f32 v93, v58, v93
    v_mul_f32 v94, v58, v94
    v_mfma_f32_16x16x32_bf16 v[112:115], a[16:19], v[164:167], v[112:115]
    ds_read_b64_tr_b16 a[2:3], v9 offset:12544
    s_add_u32 m0, s58, 101376
    s_add_u32 s100, s81, 132224
    buffer_load_dwordx4 v18, s[16:19], s100 offen offset:0 lds
    v_mfma_f32_16x16x32_bf16 v[100:103], a[20:23], v[160:163], v[100:103]
    ds_read_b64_tr_b16 a[4:5], v10 offset:12288
    v_mul_f32 v95, v58, v95
    v_mul_f32 v84, v84, v92
    v_mfma_f32_16x16x32_bf16 v[116:119], a[20:23], v[164:167], v[116:119]
    ds_read_b64_tr_b16 a[6:7], v10 offset:12544
    v_mul_f32 v85, v85, v93
    v_mul_f32 v86, v86, v94
    v_mfma_f32_16x16x32_bf16 v[104:107], a[24:27], v[160:163], v[104:107]
    ds_read_b64_tr_b16 a[8:9], v5 offset:12288
    v_mul_f32 v87, v87, v95
    v_cvt_pk_bf16_f32 v90, v84, v85
    v_mfma_f32_16x16x32_bf16 v[120:123], a[24:27], v[164:167], v[120:123]
    ds_read_b64_tr_b16 a[10:11], v5 offset:12544
    buffer_load_dwordx4 v32, s[16:19], s100 offen offset:1024 lds
    v_mfma_f32_16x16x32_bf16 v[108:111], a[28:31], v[160:163], v[108:111]
    ds_read_b64_tr_b16 a[12:13], v6 offset:12288
    v_cvt_pk_bf16_f32 v91, v86, v87
    buffer_store_dwordx4 v[88:91], v60, s[36:39], s70 offen offset:0 sc1
    v_mfma_f32_16x16x32_bf16 v[124:127], a[28:31], v[164:167], v[124:127]
    ds_read_b64_tr_b16 a[14:15], v6 offset:12544
    s_waitcnt vmcnt(7)
    s_waitcnt lgkmcnt(8)
    v_mfma_f32_16x16x32_bf16 v[96:99], a[32:35], v[168:171], v[96:99]
    ds_read_b64_tr_b16 a[16:17], v9 offset:14336
    v_mul_f32 v80, v59, v40
    v_mul_f32 v64, v57, v40
    v_mfma_f32_16x16x32_bf16 v[112:115], a[32:35], v[172:175], v[112:115]
    ds_read_b64_tr_b16 a[18:19], v9 offset:14592
    buffer_load_dwordx4 v33, s[16:19], s100 offen offset:2048 lds
    v_mfma_f32_16x16x32_bf16 v[100:103], a[36:39], v[168:171], v[100:103]
    ds_read_b64_tr_b16 a[20:21], v10 offset:14336
    v_mul_f32 v81, v59, v41
    v_mul_f32 v65, v57, v41
    v_mfma_f32_16x16x32_bf16 v[116:119], a[36:39], v[172:175], v[116:119]
    ds_read_b64_tr_b16 a[22:23], v10 offset:14592
    v_mul_f32 v82, v59, v42
    v_mul_f32 v66, v57, v42
    v_mfma_f32_16x16x32_bf16 v[104:107], a[40:43], v[168:171], v[104:107]
    ds_read_b64_tr_b16 a[24:25], v5 offset:14336
    v_mul_f32 v83, v59, v43
    v_mul_f32 v67, v57, v43
    v_mfma_f32_16x16x32_bf16 v[120:123], a[40:43], v[172:175], v[120:123]
    ds_read_b64_tr_b16 a[26:27], v5 offset:14592
    s_add_u32 m0, s58, 104448
    s_add_u32 s100, s81, 264320
    buffer_load_dwordx4 v18, s[16:19], s100 offen offset:0 lds
    v_mfma_f32_16x16x32_bf16 v[108:111], a[44:47], v[168:171], v[108:111]
    ds_read_b64_tr_b16 a[28:29], v6 offset:14336
    v_mul_f32 v84, v59, v44
    v_mul_f32 v68, v57, v44
    v_mfma_f32_16x16x32_bf16 v[124:127], a[44:47], v[172:175], v[124:127]
    ds_read_b64_tr_b16 a[30:31], v6 offset:14592
    v_mul_f32 v85, v59, v45
    v_mul_f32 v69, v57, v45
    s_waitcnt lgkmcnt(8)
    v_mfma_f32_16x16x32_bf16 v[96:99], a[0:3], v[176:179], v[96:99]
    ds_read_b64_tr_b16 a[32:33], v9 offset:16384
    v_mul_f32 v86, v59, v46
    v_mul_f32 v70, v57, v46
    v_mfma_f32_16x16x32_bf16 v[112:115], a[0:3], v[180:183], v[112:115]
    ds_read_b64_tr_b16 a[34:35], v9 offset:16640
    buffer_load_dwordx4 v32, s[16:19], s100 offen offset:1024 lds
    v_mfma_f32_16x16x32_bf16 v[100:103], a[4:7], v[176:179], v[100:103]
    ds_read_b64_tr_b16 a[36:37], v10 offset:16384
    v_mul_f32 v87, v59, v47
    v_mul_f32 v71, v57, v47
    v_mfma_f32_16x16x32_bf16 v[116:119], a[4:7], v[180:183], v[116:119]
    ds_read_b64_tr_b16 a[38:39], v10 offset:16640
    v_mul_f32 v88, v59, v48
    v_mul_f32 v72, v57, v48
    v_mfma_f32_16x16x32_bf16 v[104:107], a[8:11], v[176:179], v[104:107]
    ds_read_b64_tr_b16 a[40:41], v5 offset:16384
    v_mul_f32 v89, v59, v49
    v_mul_f32 v73, v57, v49
    v_mfma_f32_16x16x32_bf16 v[120:123], a[8:11], v[180:183], v[120:123]
    ds_read_b64_tr_b16 a[42:43], v5 offset:16640
    v_mfma_f32_16x16x32_bf16 v[108:111], a[12:15], v[176:179], v[108:111]
    ds_read_b64_tr_b16 a[44:45], v6 offset:16384
    v_mul_f32 v90, v59, v50
    v_mul_f32 v74, v57, v50
    v_mfma_f32_16x16x32_bf16 v[124:127], a[12:15], v[180:183], v[124:127]
    ds_read_b64_tr_b16 a[46:47], v6 offset:16640
    v_mul_f32 v91, v59, v51
    v_mul_f32 v75, v57, v51
    s_waitcnt lgkmcnt(8)
    v_mfma_f32_16x16x32_bf16 v[96:99], a[16:19], v[184:187], v[96:99]
    ds_read_b64_tr_b16 a[0:1], v9 offset:18432
    v_mul_f32 v92, v59, v52
    v_mul_f32 v76, v57, v52
    v_mfma_f32_16x16x32_bf16 v[112:115], a[16:19], v[188:191], v[112:115]
    ds_read_b64_tr_b16 a[2:3], v9 offset:18688
    v_mfma_f32_16x16x32_bf16 v[100:103], a[20:23], v[184:187], v[100:103]
    ds_read_b64_tr_b16 a[4:5], v10 offset:18432
    v_mul_f32 v93, v59, v53
    v_mul_f32 v77, v57, v53
    v_mfma_f32_16x16x32_bf16 v[116:119], a[20:23], v[188:191], v[116:119]
    ds_read_b64_tr_b16 a[6:7], v10 offset:18688
    v_mul_f32 v94, v59, v54
    v_mul_f32 v78, v57, v54
    v_mfma_f32_16x16x32_bf16 v[104:107], a[24:27], v[184:187], v[104:107]
    ds_read_b64_tr_b16 a[8:9], v5 offset:18432
    v_mul_f32 v95, v59, v55
    v_mul_f32 v79, v57, v55
    v_mfma_f32_16x16x32_bf16 v[120:123], a[24:27], v[188:191], v[120:123]
    ds_read_b64_tr_b16 a[10:11], v5 offset:18688
    v_mfma_f32_16x16x32_bf16 v[108:111], a[28:31], v[184:187], v[108:111]
    ds_read_b64_tr_b16 a[12:13], v6 offset:18432
    v_mfma_f32_16x16x32_bf16 v[124:127], a[28:31], v[188:191], v[124:127]
    ds_read_b64_tr_b16 a[14:15], v6 offset:18688
    s_waitcnt lgkmcnt(8)
    v_mfma_f32_16x16x32_bf16 v[96:99], a[32:35], v[192:195], v[96:99]
    ds_read_b64_tr_b16 a[16:17], v9 offset:20480
    v_mfma_f32_16x16x32_bf16 v[112:115], a[32:35], v[196:199], v[112:115]
    ds_read_b64_tr_b16 a[18:19], v9 offset:20736
    v_mfma_f32_16x16x32_bf16 v[100:103], a[36:39], v[192:195], v[100:103]
    ds_read_b64_tr_b16 a[20:21], v10 offset:20480
    v_mfma_f32_16x16x32_bf16 v[116:119], a[36:39], v[196:199], v[116:119]
    ds_read_b64_tr_b16 a[22:23], v10 offset:20736
    v_mfma_f32_16x16x32_bf16 v[104:107], a[40:43], v[192:195], v[104:107]
    ds_read_b64_tr_b16 a[24:25], v5 offset:20480
    v_mfma_f32_16x16x32_bf16 v[120:123], a[40:43], v[196:199], v[120:123]
    ds_read_b64_tr_b16 a[26:27], v5 offset:20736
    v_mfma_f32_16x16x32_bf16 v[108:111], a[44:47], v[192:195], v[108:111]
    ds_read_b64_tr_b16 a[28:29], v6 offset:20480
    v_mfma_f32_16x16x32_bf16 v[124:127], a[44:47], v[196:199], v[124:127]
    ds_read_b64_tr_b16 a[30:31], v6 offset:20736
    s_waitcnt lgkmcnt(8)
    v_mfma_f32_16x16x32_bf16 v[96:99], a[0:3], v[200:203], v[96:99]
    ds_read_b64_tr_b16 a[32:33], v9 offset:22528
    v_mfma_f32_16x16x32_bf16 v[112:115], a[0:3], v[204:207], v[112:115]
    ds_read_b64_tr_b16 a[34:35], v9 offset:22784
    v_mfma_f32_16x16x32_bf16 v[100:103], a[4:7], v[200:203], v[100:103]
    ds_read_b64_tr_b16 a[36:37], v10 offset:22528
    v_mfma_f32_16x16x32_bf16 v[116:119], a[4:7], v[204:207], v[116:119]
    ds_read_b64_tr_b16 a[38:39], v10 offset:22784
    v_mfma_f32_16x16x32_bf16 v[104:107], a[8:11], v[200:203], v[104:107]
    ds_read_b64_tr_b16 a[40:41], v5 offset:22528
    v_mfma_f32_16x16x32_bf16 v[120:123], a[8:11], v[204:207], v[120:123]
    ds_read_b64_tr_b16 a[42:43], v5 offset:22784
    v_mfma_f32_16x16x32_bf16 v[108:111], a[12:15], v[200:203], v[108:111]
    ds_read_b64_tr_b16 a[44:45], v6 offset:22528
    v_mfma_f32_16x16x32_bf16 v[124:127], a[12:15], v[204:207], v[124:127]
    ds_read_b64_tr_b16 a[46:47], v6 offset:22784
    s_waitcnt lgkmcnt(8)
    v_mfma_f32_16x16x32_bf16 v[96:99], a[16:19], v[208:211], v[96:99]
    ds_read_b64_tr_b16 a[0:1], v9 offset:24576
    v_mfma_f32_16x16x32_bf16 v[112:115], a[16:19], v[212:215], v[112:115]
    ds_read_b64_tr_b16 a[2:3], v9 offset:24832
    v_mfma_f32_16x16x32_bf16 v[100:103], a[20:23], v[208:211], v[100:103]
    ds_read_b64_tr_b16 a[4:5], v10 offset:24576
    v_mfma_f32_16x16x32_bf16 v[116:119], a[20:23], v[212:215], v[116:119]
    ds_read_b64_tr_b16 a[6:7], v10 offset:24832
    v_mfma_f32_16x16x32_bf16 v[104:107], a[24:27], v[208:211], v[104:107]
    ds_read_b64_tr_b16 a[8:9], v5 offset:24576
    v_mfma_f32_16x16x32_bf16 v[120:123], a[24:27], v[212:215], v[120:123]
    ds_read_b64_tr_b16 a[10:11], v5 offset:24832
    v_mfma_f32_16x16x32_bf16 v[108:111], a[28:31], v[208:211], v[108:111]
    ds_read_b64_tr_b16 a[12:13], v6 offset:24576
    v_mfma_f32_16x16x32_bf16 v[124:127], a[28:31], v[212:215], v[124:127]
    ds_read_b64_tr_b16 a[14:15], v6 offset:24832
    s_waitcnt vmcnt(3)
    v_mov_b32 v62, 0
    v_mov_b32 v63, 1
    s_mov_b64 exec, 1
    buffer_store_byte v63, v62, s[36:39], s71 offen offset:0 sc1
    s_mov_b64 exec, -1
    s_waitcnt lgkmcnt(8)
    v_mfma_f32_16x16x32_bf16 v[96:99], a[32:35], v[216:219], v[96:99]
    ds_read_b64_tr_b16 a[16:17], v9 offset:26624
    v_mfma_f32_16x16x32_bf16 v[112:115], a[32:35], v[220:223], v[112:115]
    ds_read_b64_tr_b16 a[18:19], v9 offset:26880
    v_mfma_f32_16x16x32_bf16 v[100:103], a[36:39], v[216:219], v[100:103]
    ds_read_b64_tr_b16 a[20:21], v10 offset:26624
    v_mfma_f32_16x16x32_bf16 v[116:119], a[36:39], v[220:223], v[116:119]
    ds_read_b64_tr_b16 a[22:23], v10 offset:26880
    v_mfma_f32_16x16x32_bf16 v[104:107], a[40:43], v[216:219], v[104:107]
    ds_read_b64_tr_b16 a[24:25], v5 offset:26624
    v_mfma_f32_16x16x32_bf16 v[120:123], a[40:43], v[220:223], v[120:123]
    ds_read_b64_tr_b16 a[26:27], v5 offset:26880
    v_mfma_f32_16x16x32_bf16 v[108:111], a[44:47], v[216:219], v[108:111]
    ds_read_b64_tr_b16 a[28:29], v6 offset:26624
    v_mfma_f32_16x16x32_bf16 v[124:127], a[44:47], v[220:223], v[124:127]
    ds_read_b64_tr_b16 a[30:31], v6 offset:26880
    s_waitcnt lgkmcnt(8)
    v_mfma_f32_16x16x32_bf16 v[96:99], a[0:3], v[224:227], v[96:99]
    ds_read_b64_tr_b16 a[32:33], v9 offset:28672
    v_mfma_f32_16x16x32_bf16 v[112:115], a[0:3], v[228:231], v[112:115]
    ds_read_b64_tr_b16 a[34:35], v9 offset:28928
    v_mfma_f32_16x16x32_bf16 v[100:103], a[4:7], v[224:227], v[100:103]
    ds_read_b64_tr_b16 a[36:37], v10 offset:28672
    v_mfma_f32_16x16x32_bf16 v[116:119], a[4:7], v[228:231], v[116:119]
    ds_read_b64_tr_b16 a[38:39], v10 offset:28928
    v_mfma_f32_16x16x32_bf16 v[104:107], a[8:11], v[224:227], v[104:107]
    ds_read_b64_tr_b16 a[40:41], v5 offset:28672
    v_mfma_f32_16x16x32_bf16 v[120:123], a[8:11], v[228:231], v[120:123]
    ds_read_b64_tr_b16 a[42:43], v5 offset:28928
    v_mfma_f32_16x16x32_bf16 v[108:111], a[12:15], v[224:227], v[108:111]
    ds_read_b64_tr_b16 a[44:45], v6 offset:28672
    v_mfma_f32_16x16x32_bf16 v[124:127], a[12:15], v[228:231], v[124:127]
    ds_read_b64_tr_b16 a[46:47], v6 offset:28928
    s_waitcnt lgkmcnt(8)
    v_mfma_f32_16x16x32_bf16 v[96:99], a[16:19], v[232:235], v[96:99]
    ds_read_b64_tr_b16 a[0:1], v9 offset:30720
    v_mfma_f32_16x16x32_bf16 v[112:115], a[16:19], v[236:239], v[112:115]
    ds_read_b64_tr_b16 a[2:3], v9 offset:30976
    v_mfma_f32_16x16x32_bf16 v[100:103], a[20:23], v[232:235], v[100:103]
    ds_read_b64_tr_b16 a[4:5], v10 offset:30720
    v_mfma_f32_16x16x32_bf16 v[116:119], a[20:23], v[236:239], v[116:119]
    ds_read_b64_tr_b16 a[6:7], v10 offset:30976
    v_mfma_f32_16x16x32_bf16 v[104:107], a[24:27], v[232:235], v[104:107]
    ds_read_b64_tr_b16 a[8:9], v5 offset:30720
    v_mfma_f32_16x16x32_bf16 v[120:123], a[24:27], v[236:239], v[120:123]
    ds_read_b64_tr_b16 a[10:11], v5 offset:30976
    v_mfma_f32_16x16x32_bf16 v[108:111], a[28:31], v[232:235], v[108:111]
    ds_read_b64_tr_b16 a[12:13], v6 offset:30720
    v_mfma_f32_16x16x32_bf16 v[124:127], a[28:31], v[236:239], v[124:127]
    ds_read_b64_tr_b16 a[14:15], v6 offset:30976
    s_waitcnt lgkmcnt(8)
    v_mfma_f32_16x16x32_bf16 v[96:99], a[32:35], v[240:243], v[96:99]
    v_mfma_f32_16x16x32_bf16 v[112:115], a[32:35], v[244:247], v[112:115]
    v_mfma_f32_16x16x32_bf16 v[100:103], a[36:39], v[240:243], v[100:103]
    v_mfma_f32_16x16x32_bf16 v[116:119], a[36:39], v[244:247], v[116:119]
    v_mfma_f32_16x16x32_bf16 v[104:107], a[40:43], v[240:243], v[104:107]
    v_mfma_f32_16x16x32_bf16 v[120:123], a[40:43], v[244:247], v[120:123]
    v_mfma_f32_16x16x32_bf16 v[108:111], a[44:47], v[240:243], v[108:111]
    v_mfma_f32_16x16x32_bf16 v[124:127], a[44:47], v[244:247], v[124:127]
    s_waitcnt lgkmcnt(0)
    v_mfma_f32_16x16x32_bf16 v[96:99], a[0:3], v[248:251], v[96:99]
    v_mfma_f32_16x16x32_bf16 v[112:115], a[0:3], v[252:255], v[112:115]
    v_mfma_f32_16x16x32_bf16 v[100:103], a[4:7], v[248:251], v[100:103]
    v_mfma_f32_16x16x32_bf16 v[116:119], a[4:7], v[252:255], v[116:119]
    v_mfma_f32_16x16x32_bf16 v[104:107], a[8:11], v[248:251], v[104:107]
    v_mfma_f32_16x16x32_bf16 v[120:123], a[8:11], v[252:255], v[120:123]
    v_mfma_f32_16x16x32_bf16 v[108:111], a[12:15], v[248:251], v[108:111]
    v_mfma_f32_16x16x32_bf16 v[124:127], a[12:15], v[252:255], v[124:127]
    s_waitcnt vmcnt(1)
    s_barrier
    ds_read_b64_tr_b16 a[0:1], v7 offset:32768
    ds_read_b64_tr_b16 a[2:3], v7 offset:33024
    ds_read_b64_tr_b16 a[4:5], v8 offset:32768
    ds_read_b64_tr_b16 a[6:7], v8 offset:33024
    ds_read_b64_tr_b16 a[8:9], v7 offset:0
    ds_read_b64_tr_b16 a[10:11], v7 offset:256
    ds_read_b64_tr_b16 a[12:13], v8 offset:0
    ds_read_b64_tr_b16 a[14:15], v8 offset:256
    ds_read_b64_tr_b16 a[16:17], v7 offset:34816
    ds_read_b64_tr_b16 a[18:19], v7 offset:35072
    ds_read_b64_tr_b16 a[20:21], v8 offset:34816
    ds_read_b64_tr_b16 a[22:23], v8 offset:35072
    ds_read_b64_tr_b16 a[24:25], v7 offset:2048
    ds_read_b64_tr_b16 a[26:27], v7 offset:2304
    ds_read_b64_tr_b16 a[28:29], v8 offset:2048
    ds_read_b64_tr_b16 a[30:31], v8 offset:2304
    s_waitcnt lgkmcnt(8)
    v_mfma_f32_16x16x32_bf16 v[64:67], a[0:3], v[128:131], v[64:67]
    ds_read_b64_tr_b16 a[32:33], v7 offset:36864
    v_max_f32 v96, 0, v96
    v_max_f32 v97, 0, v97
    v_mfma_f32_16x16x32_bf16 v[80:83], a[0:3], v[132:135], v[80:83]
    ds_read_b64_tr_b16 a[34:35], v7 offset:37120
    v_mfma_f32_16x16x32_bf16 v[68:71], a[4:7], v[128:131], v[68:71]
    ds_read_b64_tr_b16 a[36:37], v8 offset:36864
    v_max_f32 v98, 0, v98
    v_max_f32 v99, 0, v99
    v_mfma_f32_16x16x32_bf16 v[84:87], a[4:7], v[132:135], v[84:87]
    ds_read_b64_tr_b16 a[38:39], v8 offset:37120
    v_mul_f32 v104, v56, v104
    v_mul_f32 v105, v56, v105
    v_mfma_f32_16x16x32_bf16 v[72:75], a[8:11], v[128:131], v[72:75]
    ds_read_b64_tr_b16 a[40:41], v7 offset:4096
    v_mfma_f32_16x16x32_bf16 v[88:91], a[8:11], v[132:135], v[88:91]
    ds_read_b64_tr_b16 a[42:43], v7 offset:4352
    v_mul_f32 v106, v56, v106
    v_mul_f32 v107, v56, v107
    v_mfma_f32_16x16x32_bf16 v[76:79], a[12:15], v[128:131], v[76:79]
    ds_read_b64_tr_b16 a[44:45], v8 offset:4096
    v_mul_f32 v96, v96, v104
    v_mul_f32 v97, v97, v105
    v_mfma_f32_16x16x32_bf16 v[92:95], a[12:15], v[132:135], v[92:95]
    ds_read_b64_tr_b16 a[46:47], v8 offset:4352
    v_mul_f32 v98, v98, v106
    v_mul_f32 v99, v99, v107
    s_waitcnt lgkmcnt(8)
    v_mfma_f32_16x16x32_bf16 v[64:67], a[16:19], v[136:139], v[64:67]
    ds_read_b64_tr_b16 a[0:1], v7 offset:38912
    v_cvt_pk_bf16_f32 v104, v96, v97
    v_cvt_pk_bf16_f32 v105, v98, v99
    v_mfma_f32_16x16x32_bf16 v[80:83], a[16:19], v[140:143], v[80:83]
    ds_read_b64_tr_b16 a[2:3], v7 offset:39168
    v_max_f32 v100, 0, v100
    v_max_f32 v101, 0, v101
    v_mfma_f32_16x16x32_bf16 v[68:71], a[20:23], v[136:139], v[68:71]
    ds_read_b64_tr_b16 a[4:5], v8 offset:38912
    v_max_f32 v102, 0, v102
    v_max_f32 v103, 0, v103
    v_mfma_f32_16x16x32_bf16 v[84:87], a[20:23], v[140:143], v[84:87]
    ds_read_b64_tr_b16 a[6:7], v8 offset:39168
    v_mul_f32 v108, v56, v108
    v_mul_f32 v109, v56, v109
    v_mfma_f32_16x16x32_bf16 v[72:75], a[24:27], v[136:139], v[72:75]
    ds_read_b64_tr_b16 a[8:9], v7 offset:6144
    v_mul_f32 v110, v56, v110
    v_mul_f32 v111, v56, v111
    v_mfma_f32_16x16x32_bf16 v[88:91], a[24:27], v[140:143], v[88:91]
    ds_read_b64_tr_b16 a[10:11], v7 offset:6400
    v_mul_f32 v100, v100, v108
    v_mul_f32 v101, v101, v109
    v_mfma_f32_16x16x32_bf16 v[76:79], a[28:31], v[136:139], v[76:79]
    ds_read_b64_tr_b16 a[12:13], v8 offset:6144
    v_mul_f32 v102, v102, v110
    v_mul_f32 v103, v103, v111
    v_mfma_f32_16x16x32_bf16 v[92:95], a[28:31], v[140:143], v[92:95]
    ds_read_b64_tr_b16 a[14:15], v8 offset:6400
    v_cvt_pk_bf16_f32 v106, v100, v101
    v_cvt_pk_bf16_f32 v107, v102, v103
    s_waitcnt lgkmcnt(8)
    v_mfma_f32_16x16x32_bf16 v[64:67], a[32:35], v[144:147], v[64:67]
    ds_read_b64_tr_b16 a[16:17], v7 offset:40960
    buffer_store_dwordx4 v[104:107], v1, s[36:39], s70 offen offset:1024 sc1
    v_max_f32 v112, 0, v112
    v_mfma_f32_16x16x32_bf16 v[80:83], a[32:35], v[148:151], v[80:83]
    ds_read_b64_tr_b16 a[18:19], v7 offset:41216
    v_max_f32 v113, 0, v113
    v_max_f32 v114, 0, v114
    v_mfma_f32_16x16x32_bf16 v[68:71], a[36:39], v[144:147], v[68:71]
    ds_read_b64_tr_b16 a[20:21], v8 offset:40960
    v_max_f32 v115, 0, v115
    v_mul_f32 v120, v58, v120
    v_mfma_f32_16x16x32_bf16 v[84:87], a[36:39], v[148:151], v[84:87]
    ds_read_b64_tr_b16 a[22:23], v8 offset:41216
    v_mul_f32 v121, v58, v121
    v_mul_f32 v122, v58, v122
    v_mfma_f32_16x16x32_bf16 v[72:75], a[40:43], v[144:147], v[72:75]
    ds_read_b64_tr_b16 a[24:25], v7 offset:8192
    v_mul_f32 v123, v58, v123
    v_mul_f32 v112, v112, v120
    v_mfma_f32_16x16x32_bf16 v[88:91], a[40:43], v[148:151], v[88:91]
    ds_read_b64_tr_b16 a[26:27], v7 offset:8448
    v_mul_f32 v113, v113, v121
    v_mul_f32 v114, v114, v122
    v_mfma_f32_16x16x32_bf16 v[76:79], a[44:47], v[144:147], v[76:79]
    ds_read_b64_tr_b16 a[28:29], v8 offset:8192
    v_mul_f32 v115, v115, v123
    v_cvt_pk_bf16_f32 v120, v112, v113
    v_mfma_f32_16x16x32_bf16 v[92:95], a[44:47], v[148:151], v[92:95]
    ds_read_b64_tr_b16 a[30:31], v8 offset:8448
    v_cvt_pk_bf16_f32 v121, v114, v115
    v_max_f32 v116, 0, v116
    s_waitcnt lgkmcnt(8)
    v_mfma_f32_16x16x32_bf16 v[64:67], a[0:3], v[152:155], v[64:67]
    ds_read_b64_tr_b16 a[32:33], v7 offset:43008
    v_max_f32 v117, 0, v117
    v_max_f32 v118, 0, v118
    v_mfma_f32_16x16x32_bf16 v[80:83], a[0:3], v[156:159], v[80:83]
    ds_read_b64_tr_b16 a[34:35], v7 offset:43264
    v_max_f32 v119, 0, v119
    v_mul_f32 v124, v58, v124
    v_mfma_f32_16x16x32_bf16 v[68:71], a[4:7], v[152:155], v[68:71]
    ds_read_b64_tr_b16 a[36:37], v8 offset:43008
    v_mul_f32 v125, v58, v125
    v_mul_f32 v126, v58, v126
    v_mfma_f32_16x16x32_bf16 v[84:87], a[4:7], v[156:159], v[84:87]
    ds_read_b64_tr_b16 a[38:39], v8 offset:43264
    v_mul_f32 v127, v58, v127
    v_mul_f32 v116, v116, v124
    v_mfma_f32_16x16x32_bf16 v[72:75], a[8:11], v[152:155], v[72:75]
    ds_read_b64_tr_b16 a[40:41], v7 offset:10240
    v_mul_f32 v117, v117, v125
    v_mul_f32 v118, v118, v126
    v_mfma_f32_16x16x32_bf16 v[88:91], a[8:11], v[156:159], v[88:91]
    ds_read_b64_tr_b16 a[42:43], v7 offset:10496
    v_mul_f32 v119, v119, v127
    v_cvt_pk_bf16_f32 v122, v116, v117
    v_mfma_f32_16x16x32_bf16 v[76:79], a[12:15], v[152:155], v[76:79]
    ds_read_b64_tr_b16 a[44:45], v8 offset:10240
    v_cvt_pk_bf16_f32 v123, v118, v119
    buffer_store_dwordx4 v[120:123], v60, s[36:39], s70 offen offset:1024 sc1
    v_mfma_f32_16x16x32_bf16 v[92:95], a[12:15], v[156:159], v[92:95]
    ds_read_b64_tr_b16 a[46:47], v8 offset:10496
    s_waitcnt lgkmcnt(8)
    v_mfma_f32_16x16x32_bf16 v[64:67], a[16:19], v[160:163], v[64:67]
    ds_read_b64_tr_b16 a[0:1], v7 offset:45056
    v_mfma_f32_16x16x32_bf16 v[80:83], a[16:19], v[164:167], v[80:83]
    ds_read_b64_tr_b16 a[2:3], v7 offset:45312
    v_mfma_f32_16x16x32_bf16 v[68:71], a[20:23], v[160:163], v[68:71]
    ds_read_b64_tr_b16 a[4:5], v8 offset:45056
    v_mfma_f32_16x16x32_bf16 v[84:87], a[20:23], v[164:167], v[84:87]
    ds_read_b64_tr_b16 a[6:7], v8 offset:45312
    v_mfma_f32_16x16x32_bf16 v[72:75], a[24:27], v[160:163], v[72:75]
    ds_read_b64_tr_b16 a[8:9], v7 offset:12288
    v_mfma_f32_16x16x32_bf16 v[88:91], a[24:27], v[164:167], v[88:91]
    ds_read_b64_tr_b16 a[10:11], v7 offset:12544
    v_mfma_f32_16x16x32_bf16 v[76:79], a[28:31], v[160:163], v[76:79]
    ds_read_b64_tr_b16 a[12:13], v8 offset:12288
    v_mfma_f32_16x16x32_bf16 v[92:95], a[28:31], v[164:167], v[92:95]
    ds_read_b64_tr_b16 a[14:15], v8 offset:12544
    s_waitcnt lgkmcnt(8)
    v_mfma_f32_16x16x32_bf16 v[64:67], a[32:35], v[168:171], v[64:67]
    ds_read_b64_tr_b16 a[16:17], v7 offset:47104
    v_mfma_f32_16x16x32_bf16 v[80:83], a[32:35], v[172:175], v[80:83]
    ds_read_b64_tr_b16 a[18:19], v7 offset:47360
    v_mfma_f32_16x16x32_bf16 v[68:71], a[36:39], v[168:171], v[68:71]
    ds_read_b64_tr_b16 a[20:21], v8 offset:47104
    v_mfma_f32_16x16x32_bf16 v[84:87], a[36:39], v[172:175], v[84:87]
    ds_read_b64_tr_b16 a[22:23], v8 offset:47360
    v_mfma_f32_16x16x32_bf16 v[72:75], a[40:43], v[168:171], v[72:75]
    ds_read_b64_tr_b16 a[24:25], v7 offset:14336
    v_mfma_f32_16x16x32_bf16 v[88:91], a[40:43], v[172:175], v[88:91]
    ds_read_b64_tr_b16 a[26:27], v7 offset:14592
    v_mfma_f32_16x16x32_bf16 v[76:79], a[44:47], v[168:171], v[76:79]
    ds_read_b64_tr_b16 a[28:29], v8 offset:14336
    v_mfma_f32_16x16x32_bf16 v[92:95], a[44:47], v[172:175], v[92:95]
    ds_read_b64_tr_b16 a[30:31], v8 offset:14592
    s_waitcnt lgkmcnt(8)
    v_mfma_f32_16x16x32_bf16 v[64:67], a[0:3], v[176:179], v[64:67]
    ds_read_b64_tr_b16 a[32:33], v7 offset:49152
    v_mfma_f32_16x16x32_bf16 v[80:83], a[0:3], v[180:183], v[80:83]
    ds_read_b64_tr_b16 a[34:35], v7 offset:49408
    v_mfma_f32_16x16x32_bf16 v[68:71], a[4:7], v[176:179], v[68:71]
    ds_read_b64_tr_b16 a[36:37], v8 offset:49152
    v_mfma_f32_16x16x32_bf16 v[84:87], a[4:7], v[180:183], v[84:87]
    ds_read_b64_tr_b16 a[38:39], v8 offset:49408
    v_mfma_f32_16x16x32_bf16 v[72:75], a[8:11], v[176:179], v[72:75]
    ds_read_b64_tr_b16 a[40:41], v7 offset:16384
    v_mfma_f32_16x16x32_bf16 v[88:91], a[8:11], v[180:183], v[88:91]
    ds_read_b64_tr_b16 a[42:43], v7 offset:16640
    v_mfma_f32_16x16x32_bf16 v[76:79], a[12:15], v[176:179], v[76:79]
    ds_read_b64_tr_b16 a[44:45], v8 offset:16384
    v_mfma_f32_16x16x32_bf16 v[92:95], a[12:15], v[180:183], v[92:95]
    ds_read_b64_tr_b16 a[46:47], v8 offset:16640
    s_waitcnt lgkmcnt(8)
    v_mfma_f32_16x16x32_bf16 v[64:67], a[16:19], v[184:187], v[64:67]
    ds_read_b64_tr_b16 a[0:1], v7 offset:51200
    v_mfma_f32_16x16x32_bf16 v[80:83], a[16:19], v[188:191], v[80:83]
    ds_read_b64_tr_b16 a[2:3], v7 offset:51456
    v_mfma_f32_16x16x32_bf16 v[68:71], a[20:23], v[184:187], v[68:71]
    ds_read_b64_tr_b16 a[4:5], v8 offset:51200
    v_mfma_f32_16x16x32_bf16 v[84:87], a[20:23], v[188:191], v[84:87]
    ds_read_b64_tr_b16 a[6:7], v8 offset:51456
    v_mfma_f32_16x16x32_bf16 v[72:75], a[24:27], v[184:187], v[72:75]
    ds_read_b64_tr_b16 a[8:9], v7 offset:18432
    v_mfma_f32_16x16x32_bf16 v[88:91], a[24:27], v[188:191], v[88:91]
    ds_read_b64_tr_b16 a[10:11], v7 offset:18688
    v_mfma_f32_16x16x32_bf16 v[76:79], a[28:31], v[184:187], v[76:79]
    ds_read_b64_tr_b16 a[12:13], v8 offset:18432
    v_mfma_f32_16x16x32_bf16 v[92:95], a[28:31], v[188:191], v[92:95]
    ds_read_b64_tr_b16 a[14:15], v8 offset:18688
    buffer_load_dword v44, v39, s[36:39], s95 offen sc1
    s_waitcnt lgkmcnt(8)
    v_mfma_f32_16x16x32_bf16 v[64:67], a[32:35], v[192:195], v[64:67]
    ds_read_b64_tr_b16 a[16:17], v7 offset:53248
    v_mfma_f32_16x16x32_bf16 v[80:83], a[32:35], v[196:199], v[80:83]
    ds_read_b64_tr_b16 a[18:19], v7 offset:53504
    v_mfma_f32_16x16x32_bf16 v[68:71], a[36:39], v[192:195], v[68:71]
    ds_read_b64_tr_b16 a[20:21], v8 offset:53248
    v_mfma_f32_16x16x32_bf16 v[84:87], a[36:39], v[196:199], v[84:87]
    ds_read_b64_tr_b16 a[22:23], v8 offset:53504
    v_mfma_f32_16x16x32_bf16 v[72:75], a[40:43], v[192:195], v[72:75]
    ds_read_b64_tr_b16 a[24:25], v7 offset:20480
    v_mfma_f32_16x16x32_bf16 v[88:91], a[40:43], v[196:199], v[88:91]
    ds_read_b64_tr_b16 a[26:27], v7 offset:20736
    v_mfma_f32_16x16x32_bf16 v[76:79], a[44:47], v[192:195], v[76:79]
    ds_read_b64_tr_b16 a[28:29], v8 offset:20480
    v_mfma_f32_16x16x32_bf16 v[92:95], a[44:47], v[196:199], v[92:95]
    ds_read_b64_tr_b16 a[30:31], v8 offset:20736
    s_waitcnt lgkmcnt(8)
    v_mfma_f32_16x16x32_bf16 v[64:67], a[0:3], v[200:203], v[64:67]
    ds_read_b64_tr_b16 a[32:33], v7 offset:55296
    v_mfma_f32_16x16x32_bf16 v[80:83], a[0:3], v[204:207], v[80:83]
    ds_read_b64_tr_b16 a[34:35], v7 offset:55552
    v_mfma_f32_16x16x32_bf16 v[68:71], a[4:7], v[200:203], v[68:71]
    ds_read_b64_tr_b16 a[36:37], v8 offset:55296
    v_mfma_f32_16x16x32_bf16 v[84:87], a[4:7], v[204:207], v[84:87]
    ds_read_b64_tr_b16 a[38:39], v8 offset:55552
    v_mfma_f32_16x16x32_bf16 v[72:75], a[8:11], v[200:203], v[72:75]
    ds_read_b64_tr_b16 a[40:41], v7 offset:22528
    v_mfma_f32_16x16x32_bf16 v[88:91], a[8:11], v[204:207], v[88:91]
    ds_read_b64_tr_b16 a[42:43], v7 offset:22784
    v_mfma_f32_16x16x32_bf16 v[76:79], a[12:15], v[200:203], v[76:79]
    ds_read_b64_tr_b16 a[44:45], v8 offset:22528
    v_mfma_f32_16x16x32_bf16 v[92:95], a[12:15], v[204:207], v[92:95]
    ds_read_b64_tr_b16 a[46:47], v8 offset:22784
    s_waitcnt lgkmcnt(8)
    v_mfma_f32_16x16x32_bf16 v[64:67], a[16:19], v[208:211], v[64:67]
    ds_read_b64_tr_b16 a[0:1], v7 offset:57344
    v_mfma_f32_16x16x32_bf16 v[80:83], a[16:19], v[212:215], v[80:83]
    ds_read_b64_tr_b16 a[2:3], v7 offset:57600
    v_mfma_f32_16x16x32_bf16 v[68:71], a[20:23], v[208:211], v[68:71]
    ds_read_b64_tr_b16 a[4:5], v8 offset:57344
    v_mfma_f32_16x16x32_bf16 v[84:87], a[20:23], v[212:215], v[84:87]
    ds_read_b64_tr_b16 a[6:7], v8 offset:57600
    v_mfma_f32_16x16x32_bf16 v[72:75], a[24:27], v[208:211], v[72:75]
    ds_read_b64_tr_b16 a[8:9], v7 offset:24576
    v_mfma_f32_16x16x32_bf16 v[88:91], a[24:27], v[212:215], v[88:91]
    ds_read_b64_tr_b16 a[10:11], v7 offset:24832
    v_mfma_f32_16x16x32_bf16 v[76:79], a[28:31], v[208:211], v[76:79]
    ds_read_b64_tr_b16 a[12:13], v8 offset:24576
    v_mfma_f32_16x16x32_bf16 v[92:95], a[28:31], v[212:215], v[92:95]
    ds_read_b64_tr_b16 a[14:15], v8 offset:24832
    s_waitcnt vmcnt(1)
    v_mov_b32 v62, 0
    v_mov_b32 v63, 1
    s_mov_b64 exec, 1
    buffer_store_byte v63, v62, s[36:39], s71 offen offset:16 sc1
    s_mov_b64 exec, -1
    s_waitcnt lgkmcnt(8)
    v_mfma_f32_16x16x32_bf16 v[64:67], a[32:35], v[216:219], v[64:67]
    ds_read_b64_tr_b16 a[16:17], v7 offset:59392
    v_mfma_f32_16x16x32_bf16 v[80:83], a[32:35], v[220:223], v[80:83]
    ds_read_b64_tr_b16 a[18:19], v7 offset:59648
    v_mfma_f32_16x16x32_bf16 v[68:71], a[36:39], v[216:219], v[68:71]
    ds_read_b64_tr_b16 a[20:21], v8 offset:59392
    v_mfma_f32_16x16x32_bf16 v[84:87], a[36:39], v[220:223], v[84:87]
    ds_read_b64_tr_b16 a[22:23], v8 offset:59648
    v_mfma_f32_16x16x32_bf16 v[72:75], a[40:43], v[216:219], v[72:75]
    ds_read_b64_tr_b16 a[24:25], v7 offset:26624
    v_mfma_f32_16x16x32_bf16 v[88:91], a[40:43], v[220:223], v[88:91]
    ds_read_b64_tr_b16 a[26:27], v7 offset:26880
    v_mfma_f32_16x16x32_bf16 v[76:79], a[44:47], v[216:219], v[76:79]
    ds_read_b64_tr_b16 a[28:29], v8 offset:26624
    v_mfma_f32_16x16x32_bf16 v[92:95], a[44:47], v[220:223], v[92:95]
    ds_read_b64_tr_b16 a[30:31], v8 offset:26880
    s_waitcnt vmcnt(1)
    v_and_b32 v44, s85, v44
    v_cmp_ne_u32 vcc, s85, v44
    s_nop 0
    s_cmp_eq_u64 vcc, 0
    s_cbranch_scc1 POLLD_30
    s_mov_b32 s72, 30000
POLL_29:
    buffer_load_dword v63, v39, s[36:39], s95 offen sc1
    s_waitcnt vmcnt(0)
    v_and_b32 v63, s85, v63
    v_cmp_ne_u32 vcc, s85, v63
    s_nop 0
    s_cmp_eq_u64 vcc, 0
    s_cbranch_scc1 POLLD_30
    s_sub_u32 s72, s72, 1
    s_cbranch_scc0 POLL_29
POLLD_30:
    s_waitcnt lgkmcnt(8)
    v_mfma_f32_16x16x32_bf16 v[64:67], a[0:3], v[224:227], v[64:67]
    ds_read_b64_tr_b16 a[32:33], v7 offset:61440
    v_mfma_f32_16x16x32_bf16 v[80:83], a[0:3], v[228:231], v[80:83]
    ds_read_b64_tr_b16 a[34:35], v7 offset:61696
    buffer_load_dwordx4 v[128:131], v1, s[36:39], s40 offen offset:0 sc1
    v_mfma_f32_16x16x32_bf16 v[68:71], a[4:7], v[224:227], v[68:71]
    ds_read_b64_tr_b16 a[36:37], v8 offset:61440
    v_mfma_f32_16x16x32_bf16 v[84:87], a[4:7], v[228:231], v[84:87]
    ds_read_b64_tr_b16 a[38:39], v8 offset:61696
    v_mfma_f32_16x16x32_bf16 v[72:75], a[8:11], v[224:227], v[72:75]
    ds_read_b64_tr_b16 a[40:41], v7 offset:28672
    buffer_load_dwordx4 v[132:135], v1, s[36:39], s41 offen offset:0 sc1
    v_mfma_f32_16x16x32_bf16 v[88:91], a[8:11], v[228:231], v[88:91]
    ds_read_b64_tr_b16 a[42:43], v7 offset:28928
    v_mfma_f32_16x16x32_bf16 v[76:79], a[12:15], v[224:227], v[76:79]
    ds_read_b64_tr_b16 a[44:45], v8 offset:28672
    buffer_load_dwordx4 v[136:139], v1, s[36:39], s42 offen offset:0 sc1
    v_mfma_f32_16x16x32_bf16 v[92:95], a[12:15], v[228:231], v[92:95]
    ds_read_b64_tr_b16 a[46:47], v8 offset:28928
    s_waitcnt lgkmcnt(8)
    v_mfma_f32_16x16x32_bf16 v[64:67], a[16:19], v[232:235], v[64:67]
    ds_read_b64_tr_b16 a[0:1], v7 offset:63488
    v_mfma_f32_16x16x32_bf16 v[80:83], a[16:19], v[236:239], v[80:83]
    ds_read_b64_tr_b16 a[2:3], v7 offset:63744
    buffer_load_dwordx4 v[140:143], v1, s[36:39], s43 offen offset:0 sc1
    v_mfma_f32_16x16x32_bf16 v[68:71], a[20:23], v[232:235], v[68:71]
    ds_read_b64_tr_b16 a[4:5], v8 offset:63488
    v_mfma_f32_16x16x32_bf16 v[84:87], a[20:23], v[236:239], v[84:87]
    ds_read_b64_tr_b16 a[6:7], v8 offset:63744
    v_mfma_f32_16x16x32_bf16 v[72:75], a[24:27], v[232:235], v[72:75]
    ds_read_b64_tr_b16 a[8:9], v7 offset:30720
    buffer_load_dwordx4 v[144:147], v3, s[36:39], s40 offen offset:0 sc1
    v_mfma_f32_16x16x32_bf16 v[88:91], a[24:27], v[236:239], v[88:91]
    ds_read_b64_tr_b16 a[10:11], v7 offset:30976
    v_mfma_f32_16x16x32_bf16 v[76:79], a[28:31], v[232:235], v[76:79]
    ds_read_b64_tr_b16 a[12:13], v8 offset:30720
    buffer_load_dwordx4 v[148:151], v3, s[36:39], s41 offen offset:0 sc1
    v_mfma_f32_16x16x32_bf16 v[92:95], a[28:31], v[236:239], v[92:95]
    ds_read_b64_tr_b16 a[14:15], v8 offset:30976
    s_waitcnt lgkmcnt(8)
    v_mfma_f32_16x16x32_bf16 v[64:67], a[32:35], v[240:243], v[64:67]
    v_mfma_f32_16x16x32_bf16 v[80:83], a[32:35], v[244:247], v[80:83]
    buffer_load_dwordx4 v[152:155], v3, s[36:39], s42 offen offset:0 sc1
    v_mfma_f32_16x16x32_bf16 v[68:71], a[36:39], v[240:243], v[68:71]
    v_mfma_f32_16x16x32_bf16 v[84:87], a[36:39], v[244:247], v[84:87]
    v_mfma_f32_16x16x32_bf16 v[72:75], a[40:43], v[240:243], v[72:75]
    buffer_load_dwordx4 v[156:159], v3, s[36:39], s43 offen offset:0 sc1
    v_mfma_f32_16x16x32_bf16 v[88:91], a[40:43], v[244:247], v[88:91]
    v_mfma_f32_16x16x32_bf16 v[76:79], a[44:47], v[240:243], v[76:79]
    buffer_load_dwordx4 v[160:163], v4, s[36:39], s40 offen offset:0 sc1
    v_mfma_f32_16x16x32_bf16 v[92:95], a[44:47], v[244:247], v[92:95]
    s_waitcnt lgkmcnt(0)
    v_mfma_f32_16x16x32_bf16 v[64:67], a[0:3], v[248:251], v[64:67]
    v_mfma_f32_16x16x32_bf16 v[80:83], a[0:3], v[252:255], v[80:83]
    buffer_load_dwordx4 v[164:167], v4, s[36:39], s41 offen offset:0 sc1
    v_mfma_f32_16x16x32_bf16 v[68:71], a[4:7], v[248:251], v[68:71]
    v_mfma_f32_16x16x32_bf16 v[84:87], a[4:7], v[252:255], v[84:87]
    v_mfma_f32_16x16x32_bf16 v[72:75], a[8:11], v[248:251], v[72:75]
    buffer_load_dwordx4 v[168:171], v4, s[36:39], s42 offen offset:0 sc1
    v_mfma_f32_16x16x32_bf16 v[88:91], a[8:11], v[252:255], v[88:91]
    v_mfma_f32_16x16x32_bf16 v[76:79], a[12:15], v[248:251], v[76:79]
    buffer_load_dwordx4 v[172:175], v4, s[36:39], s43 offen offset:0 sc1
    v_mfma_f32_16x16x32_bf16 v[92:95], a[12:15], v[252:255], v[92:95]
    s_barrier
    v_max_f32 v64, 0, v64
    v_max_f32 v65, 0, v65
    v_max_f32 v66, 0, v66
    v_max_f32 v67, 0, v67
    v_pk_mul_f32 v[72:73], v[56:57], v[72:73] op_sel:[0,0] op_sel_hi:[0,1]
    v_pk_mul_f32 v[74:75], v[56:57], v[74:75] op_sel:[0,0] op_sel_hi:[0,1]
    v_pk_mul_f32 v[64:65], v[64:65], v[72:73] op_sel:[0,0] op_sel_hi:[1,1]
    v_pk_mul_f32 v[66:67], v[66:67], v[74:75] op_sel:[0,0] op_sel_hi:[1,1]
    v_cvt_pk_bf16_f32 v72, v64, v65
    v_cvt_pk_bf16_f32 v73, v66, v67
    buffer_load_dwordx4 v[176:179], v38, s[36:39], s40 offen offset:0 sc1
    v_max_f32 v68, 0, v68
    v_max_f32 v69, 0, v69
    v_max_f32 v70, 0, v70
    v_max_f32 v71, 0, v71
    v_pk_mul_f32 v[76:77], v[56:57], v[76:77] op_sel:[0,0] op_sel_hi:[0,1]
    v_pk_mul_f32 v[78:79], v[56:57], v[78:79] op_sel:[0,0] op_sel_hi:[0,1]
    v_pk_mul_f32 v[68:69], v[68:69], v[76:77] op_sel:[0,0] op_sel_hi:[1,1]
    v_pk_mul_f32 v[70:71], v[70:71], v[78:79] op_sel:[0,0] op_sel_hi:[1,1]
    v_cvt_pk_bf16_f32 v74, v68, v69
    v_cvt_pk_bf16_f32 v75, v70, v71
    buffer_load_dwordx4 v[180:183], v38, s[36:39], s41 offen offset:0 sc1
    buffer_store_dwordx4 v[72:75], v1, s[36:39], s70 offen offset:2048 sc1
    v_max_f32 v80, 0, v80
    v_max_f32 v81, 0, v81
    v_max_f32 v82, 0, v82
    v_max_f32 v83, 0, v83
    v_pk_mul_f32 v[88:89], v[58:59], v[88:89] op_sel:[0,0] op_sel_hi:[0,1]
    v_pk_mul_f32 v[90:91], v[58:59], v[90:91] op_sel:[0,0] op_sel_hi:[0,1]
    v_pk_mul_f32 v[80:81], v[80:81], v[88:89] op_sel:[0,0] op_sel_hi:[1,1]
    v_pk_mul_f32 v[82:83], v[82:83], v[90:91] op_sel:[0,0] op_sel_hi:[1,1]
    v_cvt_pk_bf16_f32 v88, v80, v81
    buffer_load_dwordx4 v[184:187], v38, s[36:39], s42 offen offset:0 sc1
    v_cvt_pk_bf16_f32 v89, v82, v83
    v_max_f32 v84, 0, v84
    v_max_f32 v85, 0, v85
    v_max_f32 v86, 0, v86
    v_max_f32 v87, 0, v87
    v_pk_mul_f32 v[92:93], v[58:59], v[92:93] op_sel:[0,0] op_sel_hi:[0,1]
    v_pk_mul_f32 v[94:95], v[58:59], v[94:95] op_sel:[0,0] op_sel_hi:[0,1]
    v_pk_mul_f32 v[84:85], v[84:85], v[92:93] op_sel:[0,0] op_sel_hi:[1,1]
    v_pk_mul_f32 v[86:87], v[86:87], v[94:95] op_sel:[0,0] op_sel_hi:[1,1]
    v_cvt_pk_bf16_f32 v90, v84, v85
    buffer_load_dwordx4 v[188:191], v38, s[36:39], s43 offen offset:0 sc1
    v_cvt_pk_bf16_f32 v91, v86, v87
    buffer_store_dwordx4 v[88:91], v60, s[36:39], s70 offen offset:2048 sc1
    s_add_u32 s95, s95, 16
    buffer_load_dword v45, v39, s[36:39], s95 offen sc1
    s_add_u32 s61, s58, 98304
    v_add_u32 v61, s61, v1
    v_add_u32 v60, 32768, v61
    s_add_u32 s60, s48, 1
    s_and_b32 s60, s60, 3
    s_lshl_b32 s60, s60, 13
    s_add_u32 s60, s60, 131072
    v_add_u32 v57, s60, v1
    s_add_u32 s60, s48, 2
    s_and_b32 s60, s60, 3
    s_lshl_b32 s60, s60, 13
    s_add_u32 s60, s60, 102400
    v_add_u32 v58, s60, v1
    s_add_u32 s60, s48, 3
    s_and_b32 s60, s60, 3
    s_lshl_b32 s60, s60, 13
    s_add_u32 s60, s60, 98304
    v_add_u32 v59, s60, v1
    s_lshl_b32 s89, s94, 14
    s_cmp_eq_u32 s51, 0
    s_cselect_b32 s44, s36, s28
    s_cselect_b32 s45, s37, s29
    s_cselect_b32 s46, s38, s30
    s_cselect_b32 s47, s39, s31
    s_cselect_b32 s88, 1024, 64
    s_cselect_b32 s61, 10485760, 0
    s_cselect_b32 s62, 11, 7
    s_cselect_b64 vcc, -1, 0
    s_add_u32 s89, s89, s61
    s_lshl_b32 s61, s55, s62
    s_add_u32 s89, s89, s61
    v_cndmask_b32 v56, v37, v1, vcc
    s_add_u32 s68, s69, 49152
    s_add_u32 s66, s59, 1310720
    s_waitcnt vmcnt(0)
    v_and_b32 v45, s85, v45
    v_cmp_ne_u32 vcc, s85, v45
    s_nop 0
    s_cmp_eq_u64 vcc, 0
    s_cbranch_scc1 POLLD_32
    s_mov_b32 s72, 30000
POLL_31:
    buffer_load_dword v63, v39, s[36:39], s95 offen sc1
    s_waitcnt vmcnt(0)
    v_and_b32 v63, s85, v63
    v_cmp_ne_u32 vcc, s85, v63
    s_nop 0
    s_cmp_eq_u64 vcc, 0
    s_cbranch_scc1 POLLD_32
    s_sub_u32 s72, s72, 1
    s_cbranch_scc0 POLL_31
POLLD_32:
    v_mov_b32 v62, 0
    v_mov_b32 v63, 1
    s_mov_b64 exec, 1
    buffer_store_byte v63, v62, s[36:39], s71 offen offset:32 sc1
    s_mov_b64 exec, -1
    v_lshlrev_b32 v40, 16, v20
    v_and_b32 v41, 0xffff0000, v20
    v_lshlrev_b32 v42, 16, v21
    v_and_b32 v43, 0xffff0000, v21
    v_lshlrev_b32 v44, 16, v22
    v_and_b32 v45, 0xffff0000, v22
    v_lshlrev_b32 v46, 16, v23
    v_and_b32 v47, 0xffff0000, v23
    v_lshlrev_b32 v48, 16, v24
    v_and_b32 v49, 0xffff0000, v24
    v_lshlrev_b32 v50, 16, v25
    v_and_b32 v51, 0xffff0000, v25
    v_lshlrev_b32 v52, 16, v26
    v_and_b32 v53, 0xffff0000, v26
    v_lshlrev_b32 v54, 16, v27
    v_and_b32 v55, 0xffff0000, v27
    buffer_load_dwordx4 v[192:195], v1, s[36:39], s40 offen offset:1024 sc1
    buffer_load_dwordx4 v[196:199], v1, s[36:39], s41 offen offset:1024 sc1
    buffer_load_dwordx4 v[200:203], v1, s[36:39], s42 offen offset:1024 sc1
    buffer_load_dwordx4 v[204:207], v1, s[36:39], s43 offen offset:1024 sc1
    buffer_load_dwordx4 v[208:211], v3, s[36:39], s40 offen offset:1024 sc1
    buffer_load_dwordx4 v[212:215], v3, s[36:39], s41 offen offset:1024 sc1
    buffer_load_dwordx4 v[216:219], v3, s[36:39], s42 offen offset:1024 sc1
    buffer_load_dwordx4 v[220:223], v3, s[36:39], s43 offen offset:1024 sc1
    v_mfma_f32_16x16x32_bf16 v[64:67], a[48:51], v[128:131], 0
    v_mfma_f32_16x16x32_bf16 v[68:71], a[52:55], v[128:131], 0
    buffer_load_dwordx4 v[224:227], v4, s[36:39], s40 offen offset:1024 sc1
    v_mfma_f32_16x16x32_bf16 v[72:75], a[56:59], v[128:131], 0
    v_mfma_f32_16x16x32_bf16 v[76:79], a[60:63], v[128:131], 0
    buffer_load_dwordx4 v[228:231], v4, s[36:39], s41 offen offset:1024 sc1
    v_mfma_f32_16x16x32_bf16 v[80:83], a[48:51], v[132:135], 0
    v_mfma_f32_16x16x32_bf16 v[84:87], a[52:55], v[132:135], 0
    buffer_load_dwordx4 v[232:235], v4, s[36:39], s42 offen offset:1024 sc1
    v_mfma_f32_16x16x32_bf16 v[88:91], a[56:59], v[132:135], 0
    v_mfma_f32_16x16x32_bf16 v[92:95], a[60:63], v[132:135], 0
    buffer_load_dwordx4 v[236:239], v4, s[36:39], s43 offen offset:1024 sc1
    v_mfma_f32_16x16x32_bf16 v[96:99], a[48:51], v[136:139], 0
    v_mfma_f32_16x16x32_bf16 v[100:103], a[52:55], v[136:139], 0
    buffer_load_dwordx4 v[240:243], v38, s[36:39], s40 offen offset:1024 sc1
    v_mfma_f32_16x16x32_bf16 v[104:107], a[56:59], v[136:139], 0
    v_mfma_f32_16x16x32_bf16 v[108:111], a[60:63], v[136:139], 0
    buffer_load_dwordx4 v[244:247], v38, s[36:39], s41 offen offset:1024 sc1
    v_mfma_f32_16x16x32_bf16 v[112:115], a[48:51], v[140:143], v[40:43]
    v_mfma_f32_16x16x32_bf16 v[116:119], a[52:55], v[140:143], v[44:47]
    buffer_load_dwordx4 v[248:251], v38, s[36:39], s42 offen offset:1024 sc1
    v_mfma_f32_16x16x32_bf16 v[120:123], a[56:59], v[140:143], v[48:51]
    v_mfma_f32_16x16x32_bf16 v[124:127], a[60:63], v[140:143], v[52:55]
    buffer_load_dwordx4 v[252:255], v38, s[36:39], s43 offen offset:1024 sc1
    v_mfma_f32_16x16x32_bf16 v[64:67], a[64:67], v[144:147], v[64:67]
    v_mfma_f32_16x16x32_bf16 v[68:71], a[68:71], v[144:147], v[68:71]
    v_mfma_f32_16x16x32_bf16 v[72:75], a[72:75], v[144:147], v[72:75]
    v_mfma_f32_16x16x32_bf16 v[76:79], a[76:79], v[144:147], v[76:79]
    v_mfma_f32_16x16x32_bf16 v[80:83], a[64:67], v[148:151], v[80:83]
    v_mfma_f32_16x16x32_bf16 v[84:87], a[68:71], v[148:151], v[84:87]
    v_mfma_f32_16x16x32_bf16 v[88:91], a[72:75], v[148:151], v[88:91]
    v_mfma_f32_16x16x32_bf16 v[92:95], a[76:79], v[148:151], v[92:95]
    v_mfma_f32_16x16x32_bf16 v[96:99], a[64:67], v[152:155], v[96:99]
    v_mfma_f32_16x16x32_bf16 v[100:103], a[68:71], v[152:155], v[100:103]
    v_mfma_f32_16x16x32_bf16 v[104:107], a[72:75], v[152:155], v[104:107]
    v_mfma_f32_16x16x32_bf16 v[108:111], a[76:79], v[152:155], v[108:111]
    v_mfma_f32_16x16x32_bf16 v[112:115], a[64:67], v[156:159], v[112:115]
    v_mfma_f32_16x16x32_bf16 v[116:119], a[68:71], v[156:159], v[116:119]
    v_mfma_f32_16x16x32_bf16 v[120:123], a[72:75], v[156:159], v[120:123]
    v_mfma_f32_16x16x32_bf16 v[124:127], a[76:79], v[156:159], v[124:127]
    v_mfma_f32_16x16x32_bf16 v[64:67], a[80:83], v[160:163], v[64:67]
    v_mfma_f32_16x16x32_bf16 v[68:71], a[84:87], v[160:163], v[68:71]
    v_mfma_f32_16x16x32_bf16 v[72:75], a[88:91], v[160:163], v[72:75]
    v_mfma_f32_16x16x32_bf16 v[76:79], a[92:95], v[160:163], v[76:79]
    v_mfma_f32_16x16x32_bf16 v[80:83], a[80:83], v[164:167], v[80:83]
    v_mfma_f32_16x16x32_bf16 v[84:87], a[84:87], v[164:167], v[84:87]
    v_mfma_f32_16x16x32_bf16 v[88:91], a[88:91], v[164:167], v[88:91]
    v_mfma_f32_16x16x32_bf16 v[92:95], a[92:95], v[164:167], v[92:95]
    v_mfma_f32_16x16x32_bf16 v[96:99], a[80:83], v[168:171], v[96:99]
    v_mfma_f32_16x16x32_bf16 v[100:103], a[84:87], v[168:171], v[100:103]
    v_mfma_f32_16x16x32_bf16 v[104:107], a[88:91], v[168:171], v[104:107]
    v_mfma_f32_16x16x32_bf16 v[108:111], a[92:95], v[168:171], v[108:111]
    v_mfma_f32_16x16x32_bf16 v[112:115], a[80:83], v[172:175], v[112:115]
    v_mfma_f32_16x16x32_bf16 v[116:119], a[84:87], v[172:175], v[116:119]
    v_mfma_f32_16x16x32_bf16 v[120:123], a[88:91], v[172:175], v[120:123]
    v_mfma_f32_16x16x32_bf16 v[124:127], a[92:95], v[172:175], v[124:127]
    s_add_u32 s95, s95, 16
    buffer_load_dword v40, v39, s[36:39], s95 offen sc1
    v_mfma_f32_16x16x32_bf16 v[64:67], a[96:99], v[176:179], v[64:67]
    v_mfma_f32_16x16x32_bf16 v[68:71], a[100:103], v[176:179], v[68:71]
    v_mfma_f32_16x16x32_bf16 v[72:75], a[104:107], v[176:179], v[72:75]
    v_mfma_f32_16x16x32_bf16 v[76:79], a[108:111], v[176:179], v[76:79]
    v_mfma_f32_16x16x32_bf16 v[80:83], a[96:99], v[180:183], v[80:83]
    v_mfma_f32_16x16x32_bf16 v[84:87], a[100:103], v[180:183], v[84:87]
    v_mfma_f32_16x16x32_bf16 v[88:91], a[104:107], v[180:183], v[88:91]
    v_mfma_f32_16x16x32_bf16 v[92:95], a[108:111], v[180:183], v[92:95]
    v_mfma_f32_16x16x32_bf16 v[96:99], a[96:99], v[184:187], v[96:99]
    v_mfma_f32_16x16x32_bf16 v[100:103], a[100:103], v[184:187], v[100:103]
    v_mfma_f32_16x16x32_bf16 v[104:107], a[104:107], v[184:187], v[104:107]
    v_mfma_f32_16x16x32_bf16 v[108:111], a[108:111], v[184:187], v[108:111]
    v_mfma_f32_16x16x32_bf16 v[112:115], a[96:99], v[188:191], v[112:115]
    v_mfma_f32_16x16x32_bf16 v[116:119], a[100:103], v[188:191], v[116:119]
    v_mfma_f32_16x16x32_bf16 v[120:123], a[104:107], v[188:191], v[120:123]
    v_mfma_f32_16x16x32_bf16 v[124:127], a[108:111], v[188:191], v[124:127]
    s_waitcnt vmcnt(16)
    v_mfma_f32_16x16x32_bf16 v[64:67], a[112:115], v[192:195], v[64:67]
    v_mfma_f32_16x16x32_bf16 v[68:71], a[116:119], v[192:195], v[68:71]
    v_mfma_f32_16x16x32_bf16 v[72:75], a[120:123], v[192:195], v[72:75]
    v_mfma_f32_16x16x32_bf16 v[76:79], a[124:127], v[192:195], v[76:79]
    s_waitcnt vmcnt(15)
    v_mfma_f32_16x16x32_bf16 v[80:83], a[112:115], v[196:199], v[80:83]
    v_mfma_f32_16x16x32_bf16 v[84:87], a[116:119], v[196:199], v[84:87]
    v_mfma_f32_16x16x32_bf16 v[88:91], a[120:123], v[196:199], v[88:91]
    v_mfma_f32_16x16x32_bf16 v[92:95], a[124:127], v[196:199], v[92:95]
    s_waitcnt vmcnt(14)
    v_mfma_f32_16x16x32_bf16 v[96:99], a[112:115], v[200:203], v[96:99]
    v_mfma_f32_16x16x32_bf16 v[100:103], a[116:119], v[200:203], v[100:103]
    v_mfma_f32_16x16x32_bf16 v[104:107], a[120:123], v[200:203], v[104:107]
    v_mfma_f32_16x16x32_bf16 v[108:111], a[124:127], v[200:203], v[108:111]
    s_waitcnt vmcnt(13)
    v_mfma_f32_16x16x32_bf16 v[112:115], a[112:115], v[204:207], v[112:115]
    v_mfma_f32_16x16x32_bf16 v[116:119], a[116:119], v[204:207], v[116:119]
    v_mfma_f32_16x16x32_bf16 v[120:123], a[120:123], v[204:207], v[120:123]
    v_mfma_f32_16x16x32_bf16 v[124:127], a[124:127], v[204:207], v[124:127]
    s_waitcnt vmcnt(0)
    v_and_b32 v40, s85, v40
    v_cmp_ne_u32 vcc, s85, v40
    s_nop 0
    s_cmp_eq_u64 vcc, 0
    s_cbranch_scc1 POLLD_34
    s_mov_b32 s72, 30000
POLL_33:
    buffer_load_dword v63, v39, s[36:39], s95 offen sc1
    s_waitcnt vmcnt(0)
    v_and_b32 v63, s85, v63
    v_cmp_ne_u32 vcc, s85, v63
    s_nop 0
    s_cmp_eq_u64 vcc, 0
    s_cbranch_scc1 POLLD_34
    s_sub_u32 s72, s72, 1
    s_cbranch_scc0 POLL_33
POLLD_34:
    v_mfma_f32_16x16x32_bf16 v[64:67], a[128:131], v[208:211], v[64:67]
    v_mfma_f32_16x16x32_bf16 v[68:71], a[132:135], v[208:211], v[68:71]
    buffer_load_dwordx4 v[128:131], v1, s[36:39], s40 offen offset:2048 sc1
    v_mfma_f32_16x16x32_bf16 v[72:75], a[136:139], v[208:211], v[72:75]
    v_mfma_f32_16x16x32_bf16 v[76:79], a[140:143], v[208:211], v[76:79]
    buffer_load_dwordx4 v[132:135], v3, s[36:39], s40 offen offset:2048 sc1
    v_mfma_f32_16x16x32_bf16 v[80:83], a[128:131], v[212:215], v[80:83]
    v_mfma_f32_16x16x32_bf16 v[84:87], a[132:135], v[212:215], v[84:87]
    buffer_load_dwordx4 v[136:139], v4, s[36:39], s40 offen offset:2048 sc1
    v_mfma_f32_16x16x32_bf16 v[88:91], a[136:139], v[212:215], v[88:91]
    v_mfma_f32_16x16x32_bf16 v[92:95], a[140:143], v[212:215], v[92:95]
    buffer_load_dwordx4 v[144:147], v1, s[36:39], s41 offen offset:2048 sc1
    v_mfma_f32_16x16x32_bf16 v[96:99], a[128:131], v[216:219], v[96:99]
    v_mfma_f32_16x16x32_bf16 v[100:103], a[132:135], v[216:219], v[100:103]
    buffer_load_dwordx4 v[148:151], v3, s[36:39], s41 offen offset:2048 sc1
    v_mfma_f32_16x16x32_bf16 v[104:107], a[136:139], v[216:219], v[104:107]
    v_mfma_f32_16x16x32_bf16 v[108:111], a[140:143], v[216:219], v[108:111]
    buffer_load_dwordx4 v[152:155], v4, s[36:39], s41 offen offset:2048 sc1
    v_mfma_f32_16x16x32_bf16 v[112:115], a[128:131], v[220:223], v[112:115]
    v_mfma_f32_16x16x32_bf16 v[116:119], a[132:135], v[220:223], v[116:119]
    buffer_load_dwordx4 v[160:163], v1, s[36:39], s42 offen offset:2048 sc1
    v_mfma_f32_16x16x32_bf16 v[120:123], a[136:139], v[220:223], v[120:123]
    v_mfma_f32_16x16x32_bf16 v[124:127], a[140:143], v[220:223], v[124:127]
    buffer_load_dwordx4 v[164:167], v3, s[36:39], s42 offen offset:2048 sc1
    v_mfma_f32_16x16x32_bf16 v[64:67], a[144:147], v[224:227], v[64:67]
    v_mfma_f32_16x16x32_bf16 v[68:71], a[148:151], v[224:227], v[68:71]
    buffer_load_dwordx4 v[168:171], v4, s[36:39], s42 offen offset:2048 sc1
    v_mfma_f32_16x16x32_bf16 v[72:75], a[152:155], v[224:227], v[72:75]
    v_mfma_f32_16x16x32_bf16 v[76:79], a[156:159], v[224:227], v[76:79]
    buffer_load_dwordx4 v[176:179], v1, s[36:39], s43 offen offset:2048 sc1
    v_mfma_f32_16x16x32_bf16 v[80:83], a[144:147], v[228:231], v[80:83]
    v_mfma_f32_16x16x32_bf16 v[84:87], a[148:151], v[228:231], v[84:87]
    buffer_load_dwordx4 v[180:183], v3, s[36:39], s43 offen offset:2048 sc1
    v_mfma_f32_16x16x32_bf16 v[88:91], a[152:155], v[228:231], v[88:91]
    v_mfma_f32_16x16x32_bf16 v[92:95], a[156:159], v[228:231], v[92:95]
    buffer_load_dwordx4 v[184:187], v4, s[36:39], s43 offen offset:2048 sc1
    v_mfma_f32_16x16x32_bf16 v[96:99], a[144:147], v[232:235], v[96:99]
    v_mfma_f32_16x16x32_bf16 v[100:103], a[148:151], v[232:235], v[100:103]
    v_mfma_f32_16x16x32_bf16 v[104:107], a[152:155], v[232:235], v[104:107]
    v_mfma_f32_16x16x32_bf16 v[108:111], a[156:159], v[232:235], v[108:111]
    v_mfma_f32_16x16x32_bf16 v[112:115], a[144:147], v[236:239], v[112:115]
    v_mfma_f32_16x16x32_bf16 v[116:119], a[148:151], v[236:239], v[116:119]
    v_mfma_f32_16x16x32_bf16 v[120:123], a[152:155], v[236:239], v[120:123]
    v_mfma_f32_16x16x32_bf16 v[124:127], a[156:159], v[236:239], v[124:127]
    v_mfma_f32_16x16x32_bf16 v[64:67], a[160:163], v[240:243], v[64:67]
    v_mfma_f32_16x16x32_bf16 v[68:71], a[164:167], v[240:243], v[68:71]
    v_mfma_f32_16x16x32_bf16 v[72:75], a[168:171], v[240:243], v[72:75]
    v_mfma_f32_16x16x32_bf16 v[76:79], a[172:175], v[240:243], v[76:79]
    v_mfma_f32_16x16x32_bf16 v[80:83], a[160:163], v[244:247], v[80:83]
    v_mfma_f32_16x16x32_bf16 v[84:87], a[164:167], v[244:247], v[84:87]
    v_mfma_f32_16x16x32_bf16 v[88:91], a[168:171], v[244:247], v[88:91]
    v_mfma_f32_16x16x32_bf16 v[92:95], a[172:175], v[244:247], v[92:95]
    v_mfma_f32_16x16x32_bf16 v[96:99], a[160:163], v[248:251], v[96:99]
    v_mfma_f32_16x16x32_bf16 v[100:103], a[164:167], v[248:251], v[100:103]
    v_mfma_f32_16x16x32_bf16 v[104:107], a[168:171], v[248:251], v[104:107]
    v_mfma_f32_16x16x32_bf16 v[108:111], a[172:175], v[248:251], v[108:111]
    v_mfma_f32_16x16x32_bf16 v[112:115], a[160:163], v[252:255], v[112:115]
    v_mfma_f32_16x16x32_bf16 v[116:119], a[164:167], v[252:255], v[116:119]
    v_mfma_f32_16x16x32_bf16 v[120:123], a[168:171], v[252:255], v[120:123]
    v_mfma_f32_16x16x32_bf16 v[124:127], a[172:175], v[252:255], v[124:127]
    s_waitcnt vmcnt(11)
    v_mfma_f32_16x16x32_bf16 v[64:67], a[176:179], v[128:131], v[64:67]
    v_mfma_f32_16x16x32_bf16 v[68:71], a[180:183], v[128:131], v[68:71]
    v_mfma_f32_16x16x32_bf16 v[72:75], a[184:187], v[128:131], v[72:75]
    v_mfma_f32_16x16x32_bf16 v[76:79], a[188:191], v[128:131], v[76:79]
    s_waitcnt vmcnt(10)
    v_mfma_f32_16x16x32_bf16 v[64:67], a[192:195], v[132:135], v[64:67]
    v_mfma_f32_16x16x32_bf16 v[68:71], a[196:199], v[132:135], v[68:71]
    v_mfma_f32_16x16x32_bf16 v[72:75], a[200:203], v[132:135], v[72:75]
    v_mfma_f32_16x16x32_bf16 v[76:79], a[204:207], v[132:135], v[76:79]
    s_waitcnt vmcnt(9)
    v_mfma_f32_16x16x32_bf16 v[64:67], a[208:211], v[136:139], v[64:67]
    v_mfma_f32_16x16x32_bf16 v[68:71], a[212:215], v[136:139], v[68:71]
    v_mfma_f32_16x16x32_bf16 v[72:75], a[216:219], v[136:139], v[72:75]
    v_mfma_f32_16x16x32_bf16 v[76:79], a[220:223], v[136:139], v[76:79]
    s_waitcnt vmcnt(8)
    v_mfma_f32_16x16x32_bf16 v[80:83], a[176:179], v[144:147], v[80:83]
    v_mfma_f32_16x16x32_bf16 v[84:87], a[180:183], v[144:147], v[84:87]
    v_mfma_f32_16x16x32_bf16 v[88:91], a[184:187], v[144:147], v[88:91]
    v_mfma_f32_16x16x32_bf16 v[92:95], a[188:191], v[144:147], v[92:95]
    s_waitcnt vmcnt(7)
    v_mfma_f32_16x16x32_bf16 v[80:83], a[192:195], v[148:151], v[80:83]
    v_mfma_f32_16x16x32_bf16 v[84:87], a[196:199], v[148:151], v[84:87]
    v_mfma_f32_16x16x32_bf16 v[88:91], a[200:203], v[148:151], v[88:91]
    v_mfma_f32_16x16x32_bf16 v[92:95], a[204:207], v[148:151], v[92:95]
    ds_write_b128 v61, v[64:67] offset:0
    ds_write_b128 v61, v[68:71] offset:1024
    s_waitcnt vmcnt(6)
    v_mfma_f32_16x16x32_bf16 v[80:83], a[208:211], v[152:155], v[80:83]
    v_mfma_f32_16x16x32_bf16 v[84:87], a[212:215], v[152:155], v[84:87]
    v_mfma_f32_16x16x32_bf16 v[88:91], a[216:219], v[152:155], v[88:91]
    v_mfma_f32_16x16x32_bf16 v[92:95], a[220:223], v[152:155], v[92:95]
    ds_write_b128 v61, v[72:75] offset:2048
    ds_write_b128 v61, v[76:79] offset:3072
    s_waitcnt vmcnt(5)
    v_mfma_f32_16x16x32_bf16 v[96:99], a[176:179], v[160:163], v[96:99]
    v_mfma_f32_16x16x32_bf16 v[100:103], a[180:183], v[160:163], v[100:103]
    v_mfma_f32_16x16x32_bf16 v[104:107], a[184:187], v[160:163], v[104:107]
    v_mfma_f32_16x16x32_bf16 v[108:111], a[188:191], v[160:163], v[108:111]
    s_waitcnt vmcnt(4)
    v_mfma_f32_16x16x32_bf16 v[96:99], a[192:195], v[164:167], v[96:99]
    v_mfma_f32_16x16x32_bf16 v[100:103], a[196:199], v[164:167], v[100:103]
    v_mfma_f32_16x16x32_bf16 v[104:107], a[200:203], v[164:167], v[104:107]
    v_mfma_f32_16x16x32_bf16 v[108:111], a[204:207], v[164:167], v[108:111]
    ds_write_b128 v61, v[80:83] offset:4096
    ds_write_b128 v61, v[84:87] offset:5120
    s_waitcnt vmcnt(3)
    v_mfma_f32_16x16x32_bf16 v[96:99], a[208:211], v[168:171], v[96:99]
    v_mfma_f32_16x16x32_bf16 v[100:103], a[212:215], v[168:171], v[100:103]
    v_mfma_f32_16x16x32_bf16 v[104:107], a[216:219], v[168:171], v[104:107]
    v_mfma_f32_16x16x32_bf16 v[108:111], a[220:223], v[168:171], v[108:111]
    ds_write_b128 v61, v[88:91] offset:6144
    ds_write_b128 v61, v[92:95] offset:7168
    s_waitcnt vmcnt(2)
    v_mfma_f32_16x16x32_bf16 v[112:115], a[176:179], v[176:179], v[112:115]
    v_mfma_f32_16x16x32_bf16 v[116:119], a[180:183], v[176:179], v[116:119]
    v_mfma_f32_16x16x32_bf16 v[120:123], a[184:187], v[176:179], v[120:123]
    v_mfma_f32_16x16x32_bf16 v[124:127], a[188:191], v[176:179], v[124:127]
    s_waitcnt vmcnt(1)
    v_mfma_f32_16x16x32_bf16 v[112:115], a[192:195], v[180:183], v[112:115]
    v_mfma_f32_16x16x32_bf16 v[116:119], a[196:199], v[180:183], v[116:119]
    v_mfma_f32_16x16x32_bf16 v[120:123], a[200:203], v[180:183], v[120:123]
    v_mfma_f32_16x16x32_bf16 v[124:127], a[204:207], v[180:183], v[124:127]
    ds_write_b128 v60, v[96:99] offset:0
    ds_write_b128 v60, v[100:103] offset:1024
    s_waitcnt vmcnt(0)
    v_mfma_f32_16x16x32_bf16 v[112:115], a[208:211], v[184:187], v[112:115]
    v_mfma_f32_16x16x32_bf16 v[116:119], a[212:215], v[184:187], v[116:119]
    v_mfma_f32_16x16x32_bf16 v[120:123], a[216:219], v[184:187], v[120:123]
    v_mfma_f32_16x16x32_bf16 v[124:127], a[220:223], v[184:187], v[124:127]
    ds_write_b128 v60, v[104:107] offset:2048
    ds_write_b128 v60, v[108:111] offset:3072
    s_waitcnt lgkmcnt(0)
    s_barrier
    ds_read_b128 v[128:131], v57 offset:0
    ds_read_b128 v[132:135], v57 offset:1024
    ds_read_b128 v[136:139], v57 offset:2048
    ds_read_b128 v[140:143], v57 offset:3072
    ds_read_b128 v[144:147], v58 offset:0
    ds_read_b128 v[148:151], v58 offset:1024
    ds_read_b128 v[152:155], v58 offset:2048
    ds_read_b128 v[156:159], v58 offset:3072
    ds_read_b128 v[160:163], v59 offset:0
    ds_read_b128 v[164:167], v59 offset:1024
    ds_read_b128 v[168:171], v59 offset:2048
    ds_read_b128 v[172:175], v59 offset:3072
    s_waitcnt lgkmcnt(8)
    v_pk_add_f32 v[112:113], v[112:113], v[128:129] op_sel:[0,0] op_sel_hi:[1,1]
    v_pk_add_f32 v[114:115], v[114:115], v[130:131] op_sel:[0,0] op_sel_hi:[1,1]
    v_pk_add_f32 v[116:117], v[116:117], v[132:133] op_sel:[0,0] op_sel_hi:[1,1]
    v_pk_add_f32 v[118:119], v[118:119], v[134:135] op_sel:[0,0] op_sel_hi:[1,1]
    v_pk_add_f32 v[120:121], v[120:121], v[136:137] op_sel:[0,0] op_sel_hi:[1,1]
    v_pk_add_f32 v[122:123], v[122:123], v[138:139] op_sel:[0,0] op_sel_hi:[1,1]
    v_pk_add_f32 v[124:125], v[124:125], v[140:141] op_sel:[0,0] op_sel_hi:[1,1]
    v_pk_add_f32 v[126:127], v[126:127], v[142:143] op_sel:[0,0] op_sel_hi:[1,1]
    s_waitcnt lgkmcnt(4)
    v_pk_add_f32 v[112:113], v[112:113], v[144:145] op_sel:[0,0] op_sel_hi:[1,1]
    v_pk_add_f32 v[114:115], v[114:115], v[146:147] op_sel:[0,0] op_sel_hi:[1,1]
    v_pk_add_f32 v[116:117], v[116:117], v[148:149] op_sel:[0,0] op_sel_hi:[1,1]
    v_pk_add_f32 v[118:119], v[118:119], v[150:151] op_sel:[0,0] op_sel_hi:[1,1]
    v_pk_add_f32 v[120:121], v[120:121], v[152:153] op_sel:[0,0] op_sel_hi:[1,1]
    v_pk_add_f32 v[122:123], v[122:123], v[154:155] op_sel:[0,0] op_sel_hi:[1,1]
    v_pk_add_f32 v[124:125], v[124:125], v[156:157] op_sel:[0,0] op_sel_hi:[1,1]
    v_pk_add_f32 v[126:127], v[126:127], v[158:159] op_sel:[0,0] op_sel_hi:[1,1]
    s_waitcnt lgkmcnt(0)
    v_pk_add_f32 v[112:113], v[112:113], v[160:161] op_sel:[0,0] op_sel_hi:[1,1]
    v_cvt_pk_bf16_f32 v20, v112, v113
    v_pk_add_f32 v[114:115], v[114:115], v[162:163] op_sel:[0,0] op_sel_hi:[1,1]
    v_cvt_pk_bf16_f32 v21, v114, v115
    v_pk_add_f32 v[116:117], v[116:117], v[164:165] op_sel:[0,0] op_sel_hi:[1,1]
    v_cvt_pk_bf16_f32 v22, v116, v117
    v_pk_add_f32 v[118:119], v[118:119], v[166:167] op_sel:[0,0] op_sel_hi:[1,1]
    v_cvt_pk_bf16_f32 v23, v118, v119
    buffer_store_dwordx4 v[20:23], v56, s[44:47], s89 offen sc1
    s_add_u32 s89, s89, s88
    v_pk_add_f32 v[120:121], v[120:121], v[168:169] op_sel:[0,0] op_sel_hi:[1,1]
    v_cvt_pk_bf16_f32 v24, v120, v121
    v_pk_add_f32 v[122:123], v[122:123], v[170:171] op_sel:[0,0] op_sel_hi:[1,1]
    v_cvt_pk_bf16_f32 v25, v122, v123
    v_pk_add_f32 v[124:125], v[124:125], v[172:173] op_sel:[0,0] op_sel_hi:[1,1]
    v_cvt_pk_bf16_f32 v26, v124, v125
    v_pk_add_f32 v[126:127], v[126:127], v[174:175] op_sel:[0,0] op_sel_hi:[1,1]
    v_cvt_pk_bf16_f32 v27, v126, v127
    buffer_store_dwordx4 v[24:27], v56, s[44:47], s89 offen sc1
L_FIN:
    s_waitcnt vmcnt(2) lgkmcnt(0)
L_END:
    s_endpgm
.section .rodata,"a"
.p2align 6
.amdhsa_kernel interleave_layers__linear_attn_block__glu_gated_reglu__prompt_kernel
  .amdhsa_next_free_vgpr 512
  .amdhsa_next_free_sgpr 102
  .amdhsa_accum_offset 256
  .amdhsa_group_segment_fixed_size 0
  .amdhsa_kernarg_size 80
  .amdhsa_user_sgpr_count 2
  .amdhsa_user_sgpr_kernarg_segment_ptr 1
  .amdhsa_system_sgpr_workgroup_id_x 1
.end_amdhsa_kernel
```
